```python
import torch

def _softmax(x, axis=-1):
    return torch.softmax(x, dim=axis)

def _gelu(x):
    return torch.nn.functional.gelu(x, approximate='tanh')

def _silu(x):
    return torch.nn.functional.silu(x)

def _sigmoid(x):
    return torch.sigmoid(x)

def _layernorm(x, axis=-1, eps=1e-05):
    m = x.mean(dim=axis, keepdim=True)
    v = x.var(dim=axis, keepdim=True, unbiased=False)
    return (x - m) / torch.sqrt(v + eps)

def _scatter_add(tgt, idx, src, axis=0):
    return tgt.clone().index_add_(axis, idx, src)

def _segment_sum(src, seg, n):
    out = torch.zeros((n,) + src.shape[1:], dtype=src.dtype)
    return out.index_add_(0, seg, src)

def _pad(x, pw):
    flat = tuple((v for pair in reversed(pw) for v in pair))
    return torch.nn.functional.pad(x, flat)
kernel_name = 'adaLN_cond__grouped_kv_mqa__mixer_s_mlp__prompt'

def setup_inputs():

    _w = lambda a: (lambda t: t.to(torch.bfloat16) if t.is_floating_point() else t)(torch.as_tensor(a))

    def _A_setup():
        B, S, D, H = (1, 2048, 640, 32)
        Dh = D // H
        return {'x': _w((lambda *s: torch.randn(*s, dtype=torch.bfloat16) * 0.05)(B, S, D)), 'wq': _w((lambda *s: torch.randn(*s, dtype=torch.bfloat16) * 0.05)(D, H * Dh)), 'wk': _w((lambda *s: torch.randn(*s, dtype=torch.bfloat16) * 0.05)(D, Dh)), 'wv': _w((lambda *s: torch.randn(*s, dtype=torch.bfloat16) * 0.05)(D, Dh)), 'wo': _w((lambda *s: torch.randn(*s, dtype=torch.bfloat16) * 0.05)(H * Dh, D))}
    _A_in = _A_setup()

    def _B_setup():
        B, S, D, F = (1, 2048, 640, 1728)
        return {'x': _w((lambda *s: torch.randn(*s, dtype=torch.bfloat16) * 0.05)(B, S, D)), 'w1': _w((lambda *s: torch.randn(*s, dtype=torch.bfloat16) * 12.8)(D, D) * D ** (-0.5)), 'w2': _w((lambda *s: torch.randn(*s, dtype=torch.bfloat16) * 12.8)(D, D) * D ** (-0.5)), 'w3': _w((lambda *s: torch.randn(*s, dtype=torch.bfloat16) * 12.8)(D, F) * D ** (-0.5)), 'w4': _w((lambda *s: torch.randn(*s, dtype=torch.bfloat16) * 12.8)(F, D) * F ** (-0.5))}
    _B_in = _B_setup()
    return {'A_x': _A_in['x'], 'A_wq': _A_in['wq'], 'A_wk': _A_in['wk'], 'A_wv': _A_in['wv'], 'A_wo': _A_in['wo'], 'B_x': _B_in['x'], 'B_w1': _B_in['w1'], 'B_w2': _B_in['w2'], 'B_w3': _B_in['w3'], 'B_w4': _B_in['w4'], 'c': _w((lambda *s: torch.randn(*s, dtype=torch.bfloat16) * 0.1)(1, 640) * 8.0), 'w_mod': _w((lambda *s: torch.randn(*s, dtype=torch.bfloat16) * 0.1)(640, 6 * 640) * 640 ** (-0.5) * 8.0)}

def reference(A_x, A_wq, A_wk, A_wv, A_wo, B_x, B_w1, B_w2, B_w3, B_w4, c, w_mod):

    def _A_ref(x, wq, wk, wv, wo):
        B, S, D = x.shape
        H = 32
        Dh = D // H
        q = (lambda x, *d: x.permute(*d))((x @ wq).reshape(B, S, H, Dh), 0, 2, 1, 3)
        k = x @ wk
        v = x @ wv
        scores = torch.einsum('bhqd,bkd->bhqk', q, k) * Dh ** (-0.5)
        p = _softmax(scores, axis=-1)
        o = torch.einsum('bhqk,bkd->bhqd', p, v)
        return (lambda x, *d: x.permute(*d))(o, 0, 2, 1, 3).reshape(B, S, H * Dh) @ wo

    def _B_ref(x, w1, w2, w3, w4):
        B, S, D = x.shape
        h = _gelu(_layernorm(x, axis=-1) @ w1)
        c = D // 4
        g0 = _pad(h[:, :, 0 * c:1 * c], ((0, 0), (1, 0), (0, 0)))[:, :S, :]
        g1 = _pad(h[:, :, 1 * c:2 * c], ((0, 0), (0, 1), (0, 0)))[:, 1:, :]
        g2 = _pad(h[:, :, 2 * c:3 * c], ((0, 0), (2, 0), (0, 0)))[:, :S, :]
        g3 = _pad(h[:, :, 3 * c:], ((0, 0), (0, 2), (0, 0)))[:, 2:, :]
        hs = torch.concatenate([g0, g1, g2, g3], axis=-1) @ w2
        x1 = x + hs
        h2 = _gelu(_layernorm(x1, axis=-1) @ w3) @ w4
        return x1 + h2
    x = A_x
    mod = (_silu(c) @ w_mod).reshape(c.shape[0], 6, 1, -1)
    sa, ca, ga, sb, cb, gb = (mod[:, 0].clone(), mod[:, 1].clone(), mod[:, 2].clone(), mod[:, 3].clone(), mod[:, 4].clone(), mod[:, 5].clone())
    h = _layernorm(x, axis=-1) * (1 + ca) + sa
    x = x + ga * _A_ref(h, A_wq, A_wk, A_wv, A_wo)
    h = _layernorm(x, axis=-1) * (1 + cb) + sb
    x = x + gb * _B_ref(h, B_w1, B_w2, B_w3, B_w4)
    return x
```

```asm
; @launch grid=(256,1,1) block=(256,1,1) lds=163840
.amdgcn_target "amdgcn-amd-amdhsa--gfx950"
.text
.globl adaLN_cond__grouped_kv_mqa__mixer_s_mlp__prompt_kernel
.p2align 8
.type adaLN_cond__grouped_kv_mqa__mixer_s_mlp__prompt_kernel,@function
adaLN_cond__grouped_kv_mqa__mixer_s_mlp__prompt_kernel:
    s_cmp_ge_u32 s2, 256
    s_cbranch_scc1 L_end
    s_nop 0
    s_load_dwordx16 s[32:47], s[0:1], 0
    s_load_dwordx8 s[48:55], s[0:1], 64
    s_load_dwordx4 s[56:59], s[0:1], 96
    s_load_dwordx2 s[60:61], s[0:1], 112
    v_lshrrev_b32 v1, 6, v0
    v_and_b32 v0, 63, v0
    v_readfirstlane_b32 s22, v1
    v_and_b32 v1, 15, v0
    v_lshrrev_b32 v2, 4, v0
    v_lshlrev_b32 v3, 4, v0
    s_mov_b32 s25, s2
    s_and_b32 s62, s2, 7
    s_lshr_b32 s63, s2, 3
    s_and_b32 s23, s63, 7
    s_lshr_b32 s63, s63, 3
    s_lshl_b32 s62, s62, 2
    s_add_u32 s24, s62, s63
    s_lshl_b32 s26, s24, 6
    s_lshl_b32 s27, s24, 2
    s_add_u32 s27, s27, s22
    s_mov_b32 s28, 0
    s_cmp_lg_u32 s22, 0
    s_cbranch_scc1 L_cp_1
    s_getpc_b64 s[64:65]
L_pcref:
    s_lshr_b32 s66, s2, 3
    s_lshl_b32 s66, s66, 11
    v_lshlrev_b32 v4, 7, v0
    v_add_u32 v4, s66, v4
    v_cmp_gt_u32 vcc, L_code_end-L_pcref-4, v4
    s_and_b64 vcc, vcc, 0xffff
    s_and_saveexec_b64 s[66:67], vcc
    s_cbranch_execz L_cp_1_x
    global_load_dword a252, v4, s[64:65]
L_cp_1_x:
    s_mov_b64 exec, s[66:67]
L_cp_1:
    s_waitcnt lgkmcnt(0)
    s_mov_b32 s4, s60
    s_mov_b32 s5, s61
    s_mov_b32 s6, 67108864
    s_mov_b32 s7, 0x20000
    s_mov_b32 s16, s58
    s_mov_b32 s17, s59
    s_mov_b32 s18, 256
    s_mov_b32 s19, 0x20000
    s_lshl_b32 s62, s2, 2
    s_add_u32 s62, s62, s22
    s_cmp_lg_u32 s62, 0
    s_cbranch_scc1 L_non_2
    s_memrealtime s[20:21]
    s_waitcnt lgkmcnt(0)
    s_or_b32 s20, s20, 1
    v_mov_b32 v254, s20
    v_mov_b32 v255, s21
    v_mov_b32 v252, 0
    s_mov_b64 exec, 1
    buffer_store_dwordx2 v[254:255], v252, s[16:19], 0 offen sc1
    s_mov_b64 exec, -1
L_non_2:
    s_sub_u32 s62, s23, 2
    s_and_b32 s63, s24, 3
    s_lshl_b32 s63, s63, 1
    s_lshr_b32 s64, s62, 1
    s_add_u32 s63, s63, s64
    s_lshl_b32 s63, s63, 3
    s_lshr_b32 s64, s24, 2
    s_add_u32 s63, s63, s64
    s_lshl_b32 s81, s63, 1
    s_and_b32 s64, s62, 1
    s_add_u32 s81, s81, s64
    s_cmp_lt_u32 s63, 20
    s_cselect_b32 s80, 1, 2
    s_cmp_lt_u32 s63, 60
    s_cselect_b32 s80, s80, 0
    s_cmp_lt_u32 s62, 4
    s_cselect_b32 s80, s80, 0
    s_mov_b32 s8, s54
    s_mov_b32 s9, s55
    s_mov_b32 s10, 4915200
    s_mov_b32 s11, 0x20000
    s_and_b32 s62, s24, 3
    s_lshl_b32 s62, s62, 3
    s_add_u32 s62, s62, s23
    s_lshl_b32 s62, s62, 2
    s_add_u32 s62, s62, s22
    s_mul_i32 s62, s62, 15
    v_add_u32_e64 v84, s62, v0
    v_mul_u32_u24 v85, 6554, v84
    v_lshrrev_b32_e64 v85, 22, v85
    v_mul_u32_u24 v86, 640, v85
    v_sub_u32_e64 v86, v84, v86
    v_mul_u32_u24 v86, 7680, v86
    v_lshlrev_b32 v85, 10, v85
    v_add_u32 v86, v86, v85
    s_lshr_b32 s62, s24, 2
    s_lshl_b32 s62, s62, 7
    v_cmp_gt_u32 vcc, 15, v0
    s_and_saveexec_b64 s[68:69], vcc
    buffer_load_dword a255, v86, s[8:11], s62 offen
    s_mov_b64 exec, s[68:69]
    s_mov_b32 s16, s32
    s_mov_b32 s17, s33
    s_nop 0
    s_mov_b32 s18, 2621440
    s_mov_b32 s19, 0x20000
    v_lshlrev_b32_e64 v90, 7, v0
    s_lshl_b32 s62, s23, 2
    s_add_u32 s62, s62, s22
    s_mul_i32 s62, s62, 2560
    s_mul_i32 s63, s24, 81920
    s_add_u32 s62, s62, s63
    v_cmp_gt_u32 vcc, 20, v0
    s_and_saveexec_b64 s[68:69], vcc
    buffer_load_dword a255, v90, s[16:19], s62 offen
    s_mov_b64 exec, s[68:69]
    s_cmp_lg_u32 s80, 1
    s_cbranch_scc1 L_np_3
    s_mov_b32 s12, s52
    s_mov_b32 s13, s53
    s_mov_b32 s14, 1280
    s_mov_b32 s15, 0x20000
    s_mul_i32 s66, s22, 320
    v_lshlrev_b32_e64 v230, 3, v0
    buffer_load_dwordx2 v[232:233], v230, s[12:15], s66 offen
    s_mov_b32 s8, s54
    s_mov_b32 s9, s55
    s_mov_b32 s10, 4915200
    s_mov_b32 s11, 0x20000
    v_lshrrev_b32_e64 v228, 2, v0
    v_mul_u32_u24 v228, 7680, v228
    v_and_b32_e64 v229, 3, v0
    v_lshl_add_u32 v228, v229, 4, v228
    s_mul_i32 s63, s22, 1228800
    s_lshl_b32 s64, s81, 6
    s_add_u32 s63, s63, s64
    s_mul_i32 s65, s22, 10240
    s_add_u32 s65, s65, 102400
    s_mov_b32 m0, s65
    s_nop 0
    s_add_u32 s65, s65, 1024
    buffer_load_dwordx4 v228, s[8:11], s63 offen lds
    s_add_u32 s63, s63, 122880
    s_mov_b32 m0, s65
    s_nop 0
    s_add_u32 s65, s65, 1024
    buffer_load_dwordx4 v228, s[8:11], s63 offen lds
    s_add_u32 s63, s63, 122880
    s_mov_b32 m0, s65
    s_nop 0
    s_add_u32 s65, s65, 1024
    buffer_load_dwordx4 v228, s[8:11], s63 offen lds
    s_add_u32 s63, s63, 122880
    s_mov_b32 m0, s65
    s_nop 0
    s_add_u32 s65, s65, 1024
    buffer_load_dwordx4 v228, s[8:11], s63 offen lds
    s_add_u32 s63, s63, 122880
    s_mov_b32 m0, s65
    s_nop 0
    s_add_u32 s65, s65, 1024
    buffer_load_dwordx4 v228, s[8:11], s63 offen lds
    s_add_u32 s63, s63, 122880
    s_mov_b32 m0, s65
    s_nop 0
    s_add_u32 s65, s65, 1024
    buffer_load_dwordx4 v228, s[8:11], s63 offen lds
    s_add_u32 s63, s63, 122880
    s_mov_b32 m0, s65
    s_nop 0
    s_add_u32 s65, s65, 1024
    buffer_load_dwordx4 v228, s[8:11], s63 offen lds
    s_add_u32 s63, s63, 122880
    s_mov_b32 m0, s65
    s_nop 0
    s_add_u32 s65, s65, 1024
    buffer_load_dwordx4 v228, s[8:11], s63 offen lds
    s_add_u32 s63, s63, 122880
    s_mov_b32 m0, s65
    s_nop 0
    s_add_u32 s65, s65, 1024
    buffer_load_dwordx4 v228, s[8:11], s63 offen lds
    s_add_u32 s63, s63, 122880
    s_mov_b32 m0, s65
    s_nop 0
    s_add_u32 s65, s65, 1024
    buffer_load_dwordx4 v228, s[8:11], s63 offen lds
    s_add_u32 s63, s63, 122880
    s_mov_b32 s16, s58
    s_mov_b32 s17, s59
    s_mov_b32 s18, 256
    s_mov_b32 s19, 0x20000
    v_mov_b32_e64 v241, 0
    buffer_load_dwordx2 v[242:243], v241, s[16:19], 0 offen sc1
    s_waitcnt vmcnt(11)
    v_lshlrev_b32 v234, 16, v232
    v_and_b32 v235, 0xffff0000, v232
    v_lshlrev_b32_e64 v236, 16, v233
    v_and_b32 v237, 0xffff0000, v233
    v_mul_f32 v231, 0xbfb8aa3b, v234
    v_exp_f32 v231, v231
    s_nop 0
    v_add_f32 v231, 1.0, v231
    v_rcp_f32 v231, v231
    s_nop 0
    v_mul_f32 v234, v234, v231
    v_mul_f32 v231, 0xbfb8aa3b, v235
    v_exp_f32 v231, v231
    s_nop 0
    v_add_f32 v231, 1.0, v231
    v_rcp_f32 v231, v231
    s_nop 0
    v_mul_f32 v235, v235, v231
    v_mul_f32 v231, 0xbfb8aa3b, v236
    v_exp_f32 v231, v231
    s_nop 0
    v_add_f32 v231, 1.0, v231
    v_rcp_f32 v231, v231
    s_nop 0
    v_mul_f32 v236, v236, v231
    v_mul_f32 v231, 0xbfb8aa3b, v237
    v_exp_f32 v231, v231
    s_nop 0
    v_add_f32 v231, 1.0, v231
    v_rcp_f32 v231, v231
    s_nop 0
    v_mul_f32 v237, v237, v231
    v_cvt_pk_bf16_f32 v232, v234, v235
    v_cvt_pk_bf16_f32 v233, v236, v237
    s_mul_i32 s66, s22, 320
    s_add_u32 s66, s66, 143360
    v_lshlrev_b32 v230, 3, v0
    v_add_u32 v230, s66, v230
    s_mov_b32 exec_hi, 0xff
    ds_write_b64 v230, v[232:233]
    s_mov_b32 exec_hi, -1
    v_lshrrev_b32 v92, 2, v1
    v_lshl_add_u32 v92, v2, 2, v92
    v_lshlrev_b32 v92, 6, v92
    v_and_b32 v93, 3, v1
    v_lshl_add_u32 v92, v93, 3, v92
    s_mul_i32 s62, s22, 10240
    s_add_u32 s62, s62, 102400
    v_add_u32 v92, s62, v92
    v_lshlrev_b32 v93, 3, v2
    v_add_u32 v93, s66, v93
    s_waitcnt vmcnt(1) lgkmcnt(0)
    ds_read_b64 v[136:137], v93 offset:0
    ds_read_b64 v[138:139], v93 offset:32
    ds_read_b64 v[140:141], v93 offset:64
    ds_read_b64 v[142:143], v93 offset:96
    ds_read_b64 v[144:145], v93 offset:128
    ds_read_b64 v[146:147], v93 offset:160
    ds_read_b64 v[148:149], v93 offset:192
    ds_read_b64 v[150:151], v93 offset:224
    ds_read_b64 v[152:153], v93 offset:256
    ds_read_b64 v[154:155], v93 offset:288
    ds_read_b64_tr_b16 v[96:97], v92 offset:0
    ds_read_b64_tr_b16 v[98:99], v92 offset:1024
    ds_read_b64_tr_b16 v[100:101], v92 offset:32
    ds_read_b64_tr_b16 v[102:103], v92 offset:1056
    ds_read_b64_tr_b16 v[104:105], v92 offset:2048
    ds_read_b64_tr_b16 v[106:107], v92 offset:3072
    ds_read_b64_tr_b16 v[108:109], v92 offset:2080
    ds_read_b64_tr_b16 v[110:111], v92 offset:3104
    ds_read_b64_tr_b16 v[112:113], v92 offset:4096
    ds_read_b64_tr_b16 v[114:115], v92 offset:5120
    ds_read_b64_tr_b16 v[116:117], v92 offset:4128
    ds_read_b64_tr_b16 v[118:119], v92 offset:5152
    ds_read_b64_tr_b16 v[120:121], v92 offset:6144
    ds_read_b64_tr_b16 v[122:123], v92 offset:7168
    ds_read_b64_tr_b16 v[124:125], v92 offset:6176
    ds_read_b64_tr_b16 v[126:127], v92 offset:7200
    ds_read_b64_tr_b16 v[128:129], v92 offset:8192
    ds_read_b64_tr_b16 v[130:131], v92 offset:9216
    ds_read_b64_tr_b16 v[132:133], v92 offset:8224
    ds_read_b64_tr_b16 v[134:135], v92 offset:9248
    s_waitcnt lgkmcnt(0)
    s_nop 0
    v_mfma_f32_16x16x32_bf16 v[156:159], v[96:99], v[136:139], 0
    v_mfma_f32_16x16x32_bf16 v[160:163], v[100:103], v[136:139], 0
    v_mfma_f32_16x16x32_bf16 v[156:159], v[104:107], v[140:143], v[156:159]
    v_mfma_f32_16x16x32_bf16 v[160:163], v[108:111], v[140:143], v[160:163]
    v_mfma_f32_16x16x32_bf16 v[156:159], v[112:115], v[144:147], v[156:159]
    v_mfma_f32_16x16x32_bf16 v[160:163], v[116:119], v[144:147], v[160:163]
    v_mfma_f32_16x16x32_bf16 v[156:159], v[120:123], v[148:151], v[156:159]
    v_mfma_f32_16x16x32_bf16 v[160:163], v[124:127], v[148:151], v[160:163]
    v_mfma_f32_16x16x32_bf16 v[156:159], v[128:131], v[152:155], v[156:159]
    v_mfma_f32_16x16x32_bf16 v[160:163], v[132:135], v[152:155], v[160:163]
    s_lshl_b32 s62, s22, 7
    s_add_u32 s62, s62, 161088
    v_lshlrev_b32 v92, 4, v2
    v_add_u32 v92, s62, v92
    v_cmp_eq_u32 vcc, 0, v1
    s_and_saveexec_b64 s[66:67], vcc
    s_nop 0
    ds_write_b128 v92, v[156:159]
    ds_write_b128 v92, v[160:163] offset:64
    s_mov_b64 exec, s[66:67]
    s_waitcnt lgkmcnt(0)
    s_barrier
    s_cmp_lg_u32 s22, 0
    s_cbranch_scc1 L_gd_5
    v_lshlrev_b32 v92, 4, v0
    v_and_b32 v92, 0x7f, v92
    v_add_u32 v92, 161088, v92
    ds_read_b128 v[96:99], v92
    ds_read_b128 v[100:103], v92 offset:128
    ds_read_b128 v[104:107], v92 offset:256
    ds_read_b128 v[108:111], v92 offset:384
    s_waitcnt vmcnt(0)
    s_mov_b32 s62, 400000
L_tag_6:
    v_readfirstlane_b32 s20, v242
    v_readfirstlane_b32 s21, v243
    s_cmp_lg_u32 s20, 0
    s_cbranch_scc1 L_tagok_7
    s_mov_b32 s16, s58
    s_mov_b32 s17, s59
    s_nop 0
    s_mov_b32 s18, 256
    s_mov_b32 s19, 0x20000
    v_mov_b32_e64 v241, 0
    buffer_load_dwordx2 v[242:243], v241, s[16:19], 0 offen sc1
    s_waitcnt vmcnt(0)
    s_sub_u32 s62, s62, 1
    s_cmp_lg_u32 s62, 0
    s_cbranch_scc1 L_tag_6
    s_mov_b32 s28, 1
    s_branch L_fail
L_tagok_7:
    s_waitcnt lgkmcnt(0)
    v_add_f32 v96, v96, v100
    v_add_f32 v104, v104, v108
    v_add_f32 v96, v96, v104
    v_add_f32 v97, v97, v101
    v_add_f32 v105, v105, v109
    v_add_f32 v97, v97, v105
    v_add_f32 v98, v98, v102
    v_add_f32 v106, v106, v110
    v_add_f32 v98, v98, v106
    v_add_f32 v99, v99, v103
    v_add_f32 v107, v107, v111
    v_add_f32_e64 v99, v99, v107
    v_cvt_pk_bf16_f32 v160, v96, v97
    v_cvt_pk_bf16_f32 v161, v98, v99
    v_mov_b32 v162, s20
    v_mov_b32_e64 v163, s21
    s_lshl_b32 s62, s81, 7
    s_mov_b64 exec, 0xff
    buffer_store_dwordx4 v[160:163], v3, s[4:7], s62 offen offset:0 sc1
    s_mov_b64 exec, -1
L_gd_5:
    s_mov_b32 s16, s32
    s_mov_b32 s17, s33
    s_nop 0
    s_mov_b32 s18, 2621440
    s_mov_b32 s19, 0x20000
    s_branch L_npj_4
L_np_3:
    s_mov_b32 s16, s58
    s_mov_b32 s17, s59
    s_nop 0
    s_mov_b32 s18, 256
    s_mov_b32 s19, 0x20000
    v_mov_b32_e64 v241, 0
    buffer_load_dwordx2 v[242:243], v241, s[16:19], 0 offen sc1
    s_mov_b32 s16, s32
    s_mov_b32 s17, s33
    s_mov_b32 s18, 2621440
    s_mov_b32 s19, 0x20000
L_npj_4:
    s_lshl_b32 s62, s27, 4
    v_add_u32 v88, 0, v2
    v_xor_b32 v89, v88, v1
    v_add_u32 v88, s62, v88
    v_mul_u32_u24 v88, 1280, v88
    v_lshl_add_u32 v84, v89, 4, v88
    v_add_u32 v88, 4, v2
    v_xor_b32 v89, v88, v1
    v_add_u32_e64 v88, s62, v88
    v_mul_u32_u24 v88, 1280, v88
    v_lshl_add_u32 v85, v89, 4, v88
    v_add_u32 v88, 8, v2
    v_xor_b32 v89, v88, v1
    v_add_u32_e64 v88, s62, v88
    v_mul_u32_u24 v88, 1280, v88
    v_lshl_add_u32 v86, v89, 4, v88
    v_add_u32 v88, 12, v2
    v_xor_b32 v89, v88, v1
    v_add_u32_e64 v88, s62, v88
    v_mul_u32_u24 v88, 1280, v88
    v_lshl_add_u32 v87, v89, 4, v88
    s_mul_i32 s63, s22, 20480
    s_mov_b32 s64, 0
    s_mov_b32 m0, s63
    s_add_u32 s63, s63, 1024
    buffer_load_dwordx4 v84, s[16:19], s64 offen lds
    s_mov_b32 m0, s63
    s_nop 0
    s_add_u32 s63, s63, 1024
    buffer_load_dwordx4 v85, s[16:19], s64 offen lds
    s_mov_b32 m0, s63
    s_nop 0
    s_add_u32 s63, s63, 1024
    buffer_load_dwordx4 v86, s[16:19], s64 offen lds
    s_mov_b32 m0, s63
    s_nop 0
    s_add_u32 s63, s63, 1024
    buffer_load_dwordx4 v87, s[16:19], s64 offen lds
    s_mov_b32 s64, 256
    s_mov_b32 m0, s63
    s_nop 0
    s_add_u32 s63, s63, 1024
    buffer_load_dwordx4 v84, s[16:19], s64 offen lds
    s_mov_b32 m0, s63
    s_nop 0
    s_add_u32 s63, s63, 1024
    buffer_load_dwordx4 v85, s[16:19], s64 offen lds
    s_mov_b32 m0, s63
    s_nop 0
    s_add_u32 s63, s63, 1024
    buffer_load_dwordx4 v86, s[16:19], s64 offen lds
    s_mov_b32 m0, s63
    s_nop 0
    s_add_u32 s63, s63, 1024
    buffer_load_dwordx4 v87, s[16:19], s64 offen lds
    s_mov_b32 s64, 512
    s_mov_b32 m0, s63
    s_nop 0
    s_add_u32 s63, s63, 1024
    buffer_load_dwordx4 v84, s[16:19], s64 offen lds
    s_mov_b32 m0, s63
    s_nop 0
    s_add_u32 s63, s63, 1024
    buffer_load_dwordx4 v85, s[16:19], s64 offen lds
    s_mov_b32 m0, s63
    s_nop 0
    s_add_u32 s63, s63, 1024
    buffer_load_dwordx4 v86, s[16:19], s64 offen lds
    s_mov_b32 m0, s63
    s_nop 0
    s_add_u32 s63, s63, 1024
    buffer_load_dwordx4 v87, s[16:19], s64 offen lds
    s_mov_b32 s64, 768
    s_mov_b32 m0, s63
    s_nop 0
    s_add_u32 s63, s63, 1024
    buffer_load_dwordx4 v84, s[16:19], s64 offen lds
    s_mov_b32 m0, s63
    s_nop 0
    s_add_u32 s63, s63, 1024
    buffer_load_dwordx4 v85, s[16:19], s64 offen lds
    s_mov_b32 m0, s63
    s_nop 0
    s_add_u32 s63, s63, 1024
    buffer_load_dwordx4 v86, s[16:19], s64 offen lds
    s_mov_b32 m0, s63
    s_nop 0
    s_add_u32 s63, s63, 1024
    buffer_load_dwordx4 v87, s[16:19], s64 offen lds
    s_mov_b32 s64, 1024
    s_mov_b32 m0, s63
    s_nop 0
    s_add_u32 s63, s63, 1024
    buffer_load_dwordx4 v84, s[16:19], s64 offen lds
    s_mov_b32 m0, s63
    s_nop 0
    s_add_u32 s63, s63, 1024
    buffer_load_dwordx4 v85, s[16:19], s64 offen lds
    s_mov_b32 m0, s63
    s_nop 0
    s_add_u32 s63, s63, 1024
    buffer_load_dwordx4 v86, s[16:19], s64 offen lds
    s_mov_b32 m0, s63
    s_nop 0
    s_add_u32 s63, s63, 1024
    buffer_load_dwordx4 v87, s[16:19], s64 offen lds
    s_cmp_ge_u32 s23, 2
    s_cbranch_scc1 L_nk_8
    s_cmp_eq_u32 s23, 0
    s_cselect_b32 s8, s36, s38
    s_cselect_b32 s9, s37, s39
    s_nop 0
    s_mov_b32 s10, 25600
    s_mov_b32 s11, 0x20000
    s_mul_i32 s62, s22, 7168
    s_add_u32 s63, s62, 102400
    s_mov_b32 m0, s63
    s_nop 0
    s_add_u32 s63, s63, 1024
    buffer_load_dwordx4 v3, s[8:11], s62 offen lds
    s_add_u32 s62, s62, 1024
    s_mov_b32 m0, s63
    s_nop 0
    s_add_u32 s63, s63, 1024
    buffer_load_dwordx4 v3, s[8:11], s62 offen lds
    s_add_u32 s62, s62, 1024
    s_mov_b32 m0, s63
    s_nop 0
    s_add_u32 s63, s63, 1024
    buffer_load_dwordx4 v3, s[8:11], s62 offen lds
    s_add_u32 s62, s62, 1024
    s_mov_b32 m0, s63
    s_nop 0
    s_add_u32 s63, s63, 1024
    buffer_load_dwordx4 v3, s[8:11], s62 offen lds
    s_add_u32 s62, s62, 1024
    s_mov_b32 m0, s63
    s_nop 0
    s_add_u32 s63, s63, 1024
    buffer_load_dwordx4 v3, s[8:11], s62 offen lds
    s_add_u32 s62, s62, 1024
    s_mov_b32 m0, s63
    s_nop 0
    s_add_u32 s63, s63, 1024
    buffer_load_dwordx4 v3, s[8:11], s62 offen lds
    s_add_u32 s62, s62, 1024
    s_mov_b32 m0, s63
    s_nop 0
    s_add_u32 s63, s63, 1024
    buffer_load_dwordx4 v3, s[8:11], s62 offen lds
    s_add_u32 s62, s62, 1024
L_nk_8:
    s_mov_b32 s12, s34
    s_mov_b32 s13, s35
    s_mov_b32 s14, 819200
    s_mov_b32 s15, 0x20000
    s_and_b32 s62, s24, 3
    s_lshl_b32 s62, s62, 3
    s_add_u32 s62, s62, s23
    s_lshl_b32 s62, s62, 2
    s_add_u32 s62, s62, s22
    s_mul_i32 s62, s62, 6400
    v_cmp_gt_u32 vcc, 50, v0
    s_and_saveexec_b64 s[68:69], vcc
    buffer_load_dword a255, v90, s[12:15], s62 offen
    s_mov_b64 exec, s[68:69]
    s_mul_i32 s62, s22, 20480
    v_lshlrev_b32 v244, 8, v1
    v_add_u32 v244, s62, v244
    v_and_b32_e64 v245, 1, v2
    v_lshl_add_u32 v244, v245, 3, v244
    v_lshrrev_b32 v245, 1, v2
    v_add_u32 v246, 0, v245
    v_xor_b32_e64 v246, v246, v1
    v_lshl_add_u32 v92, v246, 4, v244
    v_add_u32 v246, 2, v245
    v_xor_b32 v246, v246, v1
    v_lshl_add_u32 v93, v246, 4, v244
    v_add_u32 v246, 4, v245
    v_xor_b32 v246, v246, v1
    v_lshl_add_u32 v94, v246, 4, v244
    v_add_u32 v246, 6, v245
    v_xor_b32 v246, v246, v1
    v_lshl_add_u32 v95, v246, 4, v244
    v_add_u32 v246, 8, v245
    v_xor_b32 v246, v246, v1
    v_lshl_add_u32 v96, v246, 4, v244
    v_add_u32 v246, 10, v245
    v_xor_b32 v246, v246, v1
    v_lshl_add_u32 v97, v246, 4, v244
    v_add_u32 v246, 12, v245
    v_xor_b32 v246, v246, v1
    v_lshl_add_u32 v98, v246, 4, v244
    v_add_u32 v246, 14, v245
    v_xor_b32 v246, v246, v1
    v_lshl_add_u32 v99, v246, 4, v244
    s_mul_i32 s63, s23, 10
    s_add_u32 s64, s63, 0
    v_add_u32 v246, s64, v245
    v_lshrrev_b32 v247, 4, v246
    v_and_b32 v246, 15, v246
    v_xor_b32 v246, v246, v1
    v_lshl_add_u32 v246, v246, 4, v244
    v_lshl_add_u32 v100, v247, 12, v246
    s_add_u32 s64, s63, 2
    v_add_u32 v246, s64, v245
    v_lshrrev_b32 v247, 4, v246
    v_and_b32 v246, 15, v246
    v_xor_b32_e64 v246, v246, v1
    v_lshl_add_u32 v246, v246, 4, v244
    v_lshl_add_u32 v101, v247, 12, v246
    s_add_u32 s64, s63, 4
    v_add_u32 v246, s64, v245
    v_lshrrev_b32 v247, 4, v246
    v_and_b32 v246, 15, v246
    v_xor_b32_e64 v246, v246, v1
    v_lshl_add_u32 v246, v246, 4, v244
    v_lshl_add_u32 v102, v247, 12, v246
    s_add_u32 s64, s63, 6
    v_add_u32 v246, s64, v245
    v_lshrrev_b32 v247, 4, v246
    v_and_b32 v246, 15, v246
    v_xor_b32_e64 v246, v246, v1
    v_lshl_add_u32 v246, v246, 4, v244
    v_lshl_add_u32 v103, v247, 12, v246
    s_add_u32 s64, s63, 8
    v_add_u32 v246, s64, v245
    v_lshrrev_b32 v247, 4, v246
    v_and_b32 v246, 15, v246
    v_xor_b32_e64 v246, v246, v1
    v_lshl_add_u32 v246, v246, 4, v244
    v_lshl_add_u32 v104, v247, 12, v246
    s_cmp_lt_u32 s23, 2
    s_cbranch_scc1 L_xw_9
    s_waitcnt vmcnt(1)
    s_branch L_xw_10
L_xw_9:
    s_waitcnt vmcnt(8)
L_xw_10:
    s_nop 0
    ds_read_b64 v[4:5], v92 offset:0
    ds_read_b64 v[6:7], v93 offset:0
    ds_read_b64 v[8:9], v94 offset:0
    ds_read_b64 v[10:11], v95 offset:0
    ds_read_b64 v[12:13], v96 offset:0
    ds_read_b64 v[14:15], v97 offset:0
    ds_read_b64 v[16:17], v98 offset:0
    ds_read_b64 v[18:19], v99 offset:0
    ds_read_b64 v[20:21], v92 offset:4096
    ds_read_b64 v[22:23], v93 offset:4096
    ds_read_b64 v[24:25], v94 offset:4096
    ds_read_b64 v[26:27], v95 offset:4096
    ds_read_b64 v[28:29], v96 offset:4096
    ds_read_b64 v[30:31], v97 offset:4096
    ds_read_b64 v[32:33], v98 offset:4096
    ds_read_b64 v[34:35], v99 offset:4096
    ds_read_b64 v[36:37], v92 offset:8192
    ds_read_b64 v[38:39], v93 offset:8192
    ds_read_b64 v[40:41], v94 offset:8192
    ds_read_b64 v[42:43], v95 offset:8192
    ds_read_b64 v[44:45], v96 offset:8192
    ds_read_b64 v[46:47], v97 offset:8192
    ds_read_b64 v[48:49], v98 offset:8192
    ds_read_b64 v[50:51], v99 offset:8192
    ds_read_b64 v[52:53], v92 offset:12288
    ds_read_b64 v[54:55], v93 offset:12288
    ds_read_b64 v[56:57], v94 offset:12288
    ds_read_b64 v[58:59], v95 offset:12288
    ds_read_b64 v[60:61], v96 offset:12288
    ds_read_b64 v[62:63], v97 offset:12288
    ds_read_b64 v[64:65], v98 offset:12288
    ds_read_b64 v[66:67], v99 offset:12288
    ds_read_b64 v[68:69], v92 offset:16384
    ds_read_b64 v[70:71], v93 offset:16384
    ds_read_b64 v[72:73], v94 offset:16384
    ds_read_b64 v[74:75], v95 offset:16384
    ds_read_b64 v[76:77], v96 offset:16384
    ds_read_b64 v[78:79], v97 offset:16384
    ds_read_b64 v[80:81], v98 offset:16384
    ds_read_b64 v[82:83], v99 offset:16384
    ds_read_b64 v[108:109], v100
    ds_read_b64 v[110:111], v101
    ds_read_b64 v[112:113], v102
    ds_read_b64 v[114:115], v103
    ds_read_b64 v[116:117], v104
    s_mov_b32 s62, 400000
L_tag_11:
    v_readfirstlane_b32 s20, v242
    v_readfirstlane_b32 s21, v243
    s_cmp_lg_u32 s20, 0
    s_cbranch_scc1 L_tagok_12
    s_mov_b32 s16, s58
    s_mov_b32 s17, s59
    s_mov_b32 s18, 256
    s_mov_b32 s19, 0x20000
    v_mov_b32_e64 v241, 0
    buffer_load_dwordx2 v[242:243], v241, s[16:19], 0 offen sc1
    s_waitcnt vmcnt(0)
    s_sub_u32 s62, s62, 1
    s_cmp_lg_u32 s62, 0
    s_cbranch_scc1 L_tag_11
    s_mov_b32 s28, 1
    s_branch L_fail
L_tagok_12:
    s_waitcnt lgkmcnt(0)
    s_nop 0
    v_accvgpr_write_b32 a0, v108
    v_accvgpr_write_b32 a1, v109
    v_accvgpr_write_b32 a2, v110
    v_accvgpr_write_b32 a3, v111
    v_accvgpr_write_b32 a4, v112
    v_accvgpr_write_b32 a5, v113
    v_accvgpr_write_b32 a6, v114
    v_accvgpr_write_b32 a7, v115
    v_accvgpr_write_b32 a8, v116
    v_accvgpr_write_b32 a9, v117
    s_barrier
    s_mov_b32 s8, s34
    s_mov_b32 s9, s35
    s_nop 0
    s_mov_b32 s10, 819200
    s_mov_b32 s11, 0x20000
    v_mul_u32_u24 v239, 205, v0
    v_lshrrev_b32 v239, 11, v239
    v_mul_u32_u24 v238, 10, v239
    v_sub_u32_e64 v238, v0, v238
    v_mul_u32_u24 v239, 1280, v239
    v_lshl_add_u32 v239, v238, 4, v239
    s_mul_i32 s74, s23, 160
    s_mul_i32 s75, s22, 7680
    s_add_u32 s74, s74, s75
    s_nop 0
    s_mul_i32 s75, s22, 960
    s_sub_u32 m0, s75, 3840
    s_sub_u32 s74, s74, 30720
    s_cmp_lg_u32 s22, 3
    s_cbranch_scc1 L_tlb_13
    v_lshlrev_b32_e64 v91, 20, v0
    s_mov_b64 exec, 0x7ffffff
    buffer_load_dword a254, v91, s[4:7], 0 offen
    s_mov_b64 exec, 7
    s_mov_b32 s12, s40
    s_mov_b32 s13, s41
    s_nop 0
    s_mov_b32 s14, 819200
    s_mov_b32 s15, 0x20000
    buffer_load_dword a254, v91, s[12:15], 0 offen
    s_mov_b32 s12, s44
    s_mov_b32 s13, s45
    s_mov_b32 s14, 819200
    s_mov_b32 s15, 0x20000
    buffer_load_dword a254, v91, s[12:15], 0 offen
    s_mov_b32 s12, s46
    s_mov_b32 s13, s47
    s_mov_b32 s14, 819200
    s_mov_b32 s15, 0x20000
    buffer_load_dword a254, v91, s[12:15], 0 offen
    s_mov_b32 s12, s48
    s_mov_b32 s13, s49
    s_mov_b32 s14, 2211840
    s_mov_b32 s15, 0x20000
    buffer_load_dword a254, v91, s[12:15], 0 offen
    s_mov_b32 s12, s50
    s_mov_b32 s13, s51
    s_mov_b32 s14, 2211840
    s_mov_b32 s15, 0x20000
    buffer_load_dword a254, v91, s[12:15], 0 offen
    s_mov_b32 s12, s56
    s_mov_b32 s13, s57
    s_mov_b32 s14, 2621440
    s_mov_b32 s15, 0x20000
    buffer_load_dword a254, v91, s[12:15], 0 offen
    s_mov_b64 exec, -1
L_tlb_13:
    s_nop 0
    v_mov_b32 v244, 0x3f803f80
    v_mov_b32 v245, 0x3f803f80
    v_mov_b32 v246, 0x3f803f80
    v_mov_b32 v247, 0x3f803f80
    s_nop 1
    s_nop 0
    v_mfma_f32_16x16x32_bf16 v[248:251], v[244:247], v[4:7], 0
    v_mfma_f32_16x16x32_bf16 v[252:255], v[4:7], v[4:7], 0
    s_add_u32 m0, m0, 3840
    s_add_u32 s74, s74, 30720
    buffer_load_dwordx4 v239, s[8:11], s74 offen lds
    v_mfma_f32_16x16x32_bf16 v[248:251], v[244:247], v[8:11], v[248:251]
    v_mfma_f32_16x16x32_bf16 v[252:255], v[8:11], v[8:11], v[252:255]
    v_mfma_f32_16x16x32_bf16 v[248:251], v[244:247], v[12:15], v[248:251]
    v_mfma_f32_16x16x32_bf16 v[252:255], v[12:15], v[12:15], v[252:255]
    s_add_u32 m0, m0, 3840
    s_add_u32 s74, s74, 30720
    buffer_load_dwordx4 v239, s[8:11], s74 offen lds
    v_mfma_f32_16x16x32_bf16 v[248:251], v[244:247], v[16:19], v[248:251]
    v_mfma_f32_16x16x32_bf16 v[252:255], v[16:19], v[16:19], v[252:255]
    v_mfma_f32_16x16x32_bf16 v[248:251], v[244:247], v[20:23], v[248:251]
    v_mfma_f32_16x16x32_bf16 v[252:255], v[20:23], v[20:23], v[252:255]
    s_add_u32 m0, m0, 3840
    s_add_u32 s74, s74, 30720
    buffer_load_dwordx4 v239, s[8:11], s74 offen lds
    v_mfma_f32_16x16x32_bf16 v[248:251], v[244:247], v[24:27], v[248:251]
    v_mfma_f32_16x16x32_bf16 v[252:255], v[24:27], v[24:27], v[252:255]
    v_mfma_f32_16x16x32_bf16 v[248:251], v[244:247], v[28:31], v[248:251]
    v_mfma_f32_16x16x32_bf16 v[252:255], v[28:31], v[28:31], v[252:255]
    s_add_u32 m0, m0, 3840
    s_add_u32 s74, s74, 30720
    buffer_load_dwordx4 v239, s[8:11], s74 offen lds
    v_mfma_f32_16x16x32_bf16 v[248:251], v[244:247], v[32:35], v[248:251]
    v_mfma_f32_16x16x32_bf16 v[252:255], v[32:35], v[32:35], v[252:255]
    v_mfma_f32_16x16x32_bf16 v[248:251], v[244:247], v[36:39], v[248:251]
    v_mfma_f32_16x16x32_bf16 v[252:255], v[36:39], v[36:39], v[252:255]
    s_add_u32 m0, m0, 3840
    s_add_u32 s74, s74, 30720
    buffer_load_dwordx4 v239, s[8:11], s74 offen lds
    v_mfma_f32_16x16x32_bf16 v[248:251], v[244:247], v[40:43], v[248:251]
    v_mfma_f32_16x16x32_bf16 v[252:255], v[40:43], v[40:43], v[252:255]
    v_mfma_f32_16x16x32_bf16 v[248:251], v[244:247], v[44:47], v[248:251]
    v_mfma_f32_16x16x32_bf16 v[252:255], v[44:47], v[44:47], v[252:255]
    s_add_u32 m0, m0, 3840
    s_add_u32 s74, s74, 30720
    buffer_load_dwordx4 v239, s[8:11], s74 offen lds
    v_mfma_f32_16x16x32_bf16 v[248:251], v[244:247], v[48:51], v[248:251]
    v_mfma_f32_16x16x32_bf16 v[252:255], v[48:51], v[48:51], v[252:255]
    v_mfma_f32_16x16x32_bf16 v[248:251], v[244:247], v[52:55], v[248:251]
    v_mfma_f32_16x16x32_bf16 v[252:255], v[52:55], v[52:55], v[252:255]
    s_add_u32 m0, m0, 3840
    s_add_u32 s74, s74, 30720
    buffer_load_dwordx4 v239, s[8:11], s74 offen lds
    v_mfma_f32_16x16x32_bf16 v[248:251], v[244:247], v[56:59], v[248:251]
    v_mfma_f32_16x16x32_bf16 v[252:255], v[56:59], v[56:59], v[252:255]
    v_mfma_f32_16x16x32_bf16 v[248:251], v[244:247], v[60:63], v[248:251]
    v_mfma_f32_16x16x32_bf16 v[252:255], v[60:63], v[60:63], v[252:255]
    s_add_u32 m0, m0, 3840
    s_add_u32 s74, s74, 30720
    buffer_load_dwordx4 v239, s[8:11], s74 offen lds
    v_mfma_f32_16x16x32_bf16 v[248:251], v[244:247], v[64:67], v[248:251]
    v_mfma_f32_16x16x32_bf16 v[252:255], v[64:67], v[64:67], v[252:255]
    v_mfma_f32_16x16x32_bf16 v[248:251], v[244:247], v[68:71], v[248:251]
    v_mfma_f32_16x16x32_bf16 v[252:255], v[68:71], v[68:71], v[252:255]
    s_add_u32 m0, m0, 3840
    s_add_u32 s74, s74, 30720
    buffer_load_dwordx4 v239, s[8:11], s74 offen lds
    v_mfma_f32_16x16x32_bf16 v[248:251], v[244:247], v[72:75], v[248:251]
    v_mfma_f32_16x16x32_bf16 v[252:255], v[72:75], v[72:75], v[252:255]
    v_mfma_f32_16x16x32_bf16 v[248:251], v[244:247], v[76:79], v[248:251]
    v_mfma_f32_16x16x32_bf16 v[252:255], v[76:79], v[76:79], v[252:255]
    s_add_u32 m0, m0, 3840
    s_add_u32 s74, s74, 30720
    buffer_load_dwordx4 v239, s[8:11], s74 offen lds
    v_mfma_f32_16x16x32_bf16 v[248:251], v[244:247], v[80:83], v[248:251]
    v_mfma_f32_16x16x32_bf16 v[252:255], v[80:83], v[80:83], v[252:255]
    v_and_b32 v86, 3, v1
    v_cmp_eq_u32 vcc, 1, v86
    s_nop 5
    v_cndmask_b32 v87, v252, v253, vcc
    v_cmp_eq_u32 vcc, 2, v86
    s_nop 1
    v_cndmask_b32 v87, v87, v254, vcc
    v_cmp_eq_u32 vcc, 3, v86
    s_nop 1
    v_cndmask_b32 v87, v87, v255, vcc
    v_lshrrev_b32_e64 v86, 2, v1
    v_lshl_add_u32 v86, v86, 4, v1
    v_lshlrev_b32_e64 v86, 2, v86
    ds_bpermute_b32 v87, v86, v87
    v_mul_f32 v84, 0.0015625, v248
    s_waitcnt lgkmcnt(0)
    s_nop 0
    v_mul_f32 v87, 0.0015625, v87
    v_fma_f32 v87, -v84, v84, v87
    v_max_f32_e64 v87, 0, v87
    v_add_f32 v87, 0x3727c5ac, v87
    v_rsq_f32 v85, v87
    s_nop 0
    v_mul_f32 v84, v84, v85
    v_sub_f32 v244, 0, v84
    v_mov_b32 v245, v244
    v_mov_b32 v246, v85
    v_mov_b32 v247, v85
    v_lshlrev_b32 v84, 16, v4
    v_and_b32 v85, 0xffff0000, v4
    v_lshlrev_b32_e64 v86, 16, v5
    v_and_b32 v87, 0xffff0000, v5
    v_lshlrev_b32_e64 v88, 16, v6
    v_and_b32 v89, 0xffff0000, v6
    v_lshlrev_b32_e64 v90, 16, v7
    v_and_b32 v91, 0xffff0000, v7
    v_pk_fma_f32 v[84:85], v[84:85], v[246:247], v[244:245]
    v_pk_fma_f32 v[86:87], v[86:87], v[246:247], v[244:245]
    v_pk_fma_f32 v[88:89], v[88:89], v[246:247], v[244:245]
    v_pk_fma_f32 v[90:91], v[90:91], v[246:247], v[244:245]
    s_add_u32 m0, m0, 3840
    s_add_u32 s74, s74, 30720
    buffer_load_dwordx4 v239, s[8:11], s74 offen lds
    v_lshlrev_b32_e64 v92, 16, v8
    v_and_b32 v93, 0xffff0000, v8
    v_lshlrev_b32_e64 v94, 16, v9
    v_and_b32 v95, 0xffff0000, v9
    v_lshlrev_b32_e64 v96, 16, v10
    v_and_b32 v97, 0xffff0000, v10
    v_lshlrev_b32_e64 v98, 16, v11
    v_and_b32 v99, 0xffff0000, v11
    v_pk_fma_f32 v[92:93], v[92:93], v[246:247], v[244:245]
    v_pk_fma_f32 v[94:95], v[94:95], v[246:247], v[244:245]
    v_pk_fma_f32 v[96:97], v[96:97], v[246:247], v[244:245]
    v_pk_fma_f32 v[98:99], v[98:99], v[246:247], v[244:245]
    s_add_u32 m0, m0, 3840
    s_add_u32 s74, s74, 30720
    buffer_load_dwordx4 v239, s[8:11], s74 offen lds
    v_lshlrev_b32_e64 v100, 16, v12
    v_and_b32 v101, 0xffff0000, v12
    v_lshlrev_b32_e64 v102, 16, v13
    v_and_b32 v103, 0xffff0000, v13
    v_lshlrev_b32_e64 v104, 16, v14
    v_and_b32 v105, 0xffff0000, v14
    v_lshlrev_b32_e64 v106, 16, v15
    v_and_b32 v107, 0xffff0000, v15
    v_pk_fma_f32 v[100:101], v[100:101], v[246:247], v[244:245]
    v_pk_fma_f32 v[102:103], v[102:103], v[246:247], v[244:245]
    v_pk_fma_f32 v[104:105], v[104:105], v[246:247], v[244:245]
    v_pk_fma_f32 v[106:107], v[106:107], v[246:247], v[244:245]
    s_add_u32 m0, m0, 3840
    s_add_u32 s74, s74, 30720
    buffer_load_dwordx4 v239, s[8:11], s74 offen lds
    v_lshlrev_b32_e64 v108, 16, v16
    v_and_b32 v109, 0xffff0000, v16
    v_lshlrev_b32_e64 v110, 16, v17
    v_and_b32 v111, 0xffff0000, v17
    v_lshlrev_b32_e64 v112, 16, v18
    v_and_b32 v113, 0xffff0000, v18
    v_lshlrev_b32_e64 v114, 16, v19
    v_and_b32 v115, 0xffff0000, v19
    v_pk_fma_f32 v[108:109], v[108:109], v[246:247], v[244:245]
    v_pk_fma_f32 v[110:111], v[110:111], v[246:247], v[244:245]
    v_pk_fma_f32 v[112:113], v[112:113], v[246:247], v[244:245]
    v_pk_fma_f32 v[114:115], v[114:115], v[246:247], v[244:245]
    s_add_u32 m0, m0, 3840
    s_add_u32 s74, s74, 30720
    buffer_load_dwordx4 v239, s[8:11], s74 offen lds
    v_lshlrev_b32_e64 v116, 16, v20
    v_and_b32 v117, 0xffff0000, v20
    v_lshlrev_b32_e64 v118, 16, v21
    v_and_b32 v119, 0xffff0000, v21
    v_lshlrev_b32_e64 v120, 16, v22
    v_and_b32 v121, 0xffff0000, v22
    v_lshlrev_b32_e64 v122, 16, v23
    v_and_b32 v123, 0xffff0000, v23
    v_pk_fma_f32 v[116:117], v[116:117], v[246:247], v[244:245]
    v_pk_fma_f32 v[118:119], v[118:119], v[246:247], v[244:245]
    v_pk_fma_f32 v[120:121], v[120:121], v[246:247], v[244:245]
    v_pk_fma_f32 v[122:123], v[122:123], v[246:247], v[244:245]
    s_add_u32 m0, m0, 3840
    s_add_u32 s74, s74, 30720
    buffer_load_dwordx4 v239, s[8:11], s74 offen lds
    v_lshlrev_b32_e64 v124, 16, v24
    v_and_b32 v125, 0xffff0000, v24
    v_lshlrev_b32_e64 v126, 16, v25
    v_and_b32 v127, 0xffff0000, v25
    v_lshlrev_b32_e64 v128, 16, v26
    v_and_b32 v129, 0xffff0000, v26
    v_lshlrev_b32_e64 v130, 16, v27
    v_and_b32 v131, 0xffff0000, v27
    v_pk_fma_f32 v[124:125], v[124:125], v[246:247], v[244:245]
    v_pk_fma_f32 v[126:127], v[126:127], v[246:247], v[244:245]
    v_pk_fma_f32 v[128:129], v[128:129], v[246:247], v[244:245]
    v_pk_fma_f32 v[130:131], v[130:131], v[246:247], v[244:245]
    s_add_u32 m0, m0, 3840
    s_add_u32 s74, s74, 30720
    buffer_load_dwordx4 v239, s[8:11], s74 offen lds
    v_lshlrev_b32_e64 v132, 16, v28
    v_and_b32 v133, 0xffff0000, v28
    v_lshlrev_b32_e64 v134, 16, v29
    v_and_b32 v135, 0xffff0000, v29
    v_lshlrev_b32_e64 v136, 16, v30
    v_and_b32 v137, 0xffff0000, v30
    v_lshlrev_b32_e64 v138, 16, v31
    v_and_b32 v139, 0xffff0000, v31
    v_pk_fma_f32 v[132:133], v[132:133], v[246:247], v[244:245]
    v_pk_fma_f32 v[134:135], v[134:135], v[246:247], v[244:245]
    v_pk_fma_f32 v[136:137], v[136:137], v[246:247], v[244:245]
    v_pk_fma_f32 v[138:139], v[138:139], v[246:247], v[244:245]
    s_add_u32 m0, m0, 3840
    s_add_u32 s74, s74, 30720
    buffer_load_dwordx4 v239, s[8:11], s74 offen lds
    v_lshlrev_b32_e64 v140, 16, v32
    v_and_b32 v141, 0xffff0000, v32
    v_lshlrev_b32_e64 v142, 16, v33
    v_and_b32 v143, 0xffff0000, v33
    v_lshlrev_b32_e64 v144, 16, v34
    v_and_b32 v145, 0xffff0000, v34
    v_lshlrev_b32_e64 v146, 16, v35
    v_and_b32 v147, 0xffff0000, v35
    v_pk_fma_f32 v[140:141], v[140:141], v[246:247], v[244:245]
    v_pk_fma_f32 v[142:143], v[142:143], v[246:247], v[244:245]
    v_pk_fma_f32 v[144:145], v[144:145], v[246:247], v[244:245]
    v_pk_fma_f32 v[146:147], v[146:147], v[246:247], v[244:245]
    s_add_u32 m0, m0, 3840
    s_add_u32 s74, s74, 30720
    buffer_load_dwordx4 v239, s[8:11], s74 offen lds
    v_lshlrev_b32_e64 v148, 16, v36
    v_and_b32 v149, 0xffff0000, v36
    v_lshlrev_b32_e64 v150, 16, v37
    v_and_b32 v151, 0xffff0000, v37
    v_lshlrev_b32_e64 v152, 16, v38
    v_and_b32 v153, 0xffff0000, v38
    v_lshlrev_b32_e64 v154, 16, v39
    v_and_b32 v155, 0xffff0000, v39
    v_pk_fma_f32 v[148:149], v[148:149], v[246:247], v[244:245]
    v_pk_fma_f32 v[150:151], v[150:151], v[246:247], v[244:245]
    v_pk_fma_f32 v[152:153], v[152:153], v[246:247], v[244:245]
    v_pk_fma_f32 v[154:155], v[154:155], v[246:247], v[244:245]
    s_add_u32 m0, m0, 3840
    s_add_u32 s74, s74, 30720
    buffer_load_dwordx4 v239, s[8:11], s74 offen lds
    v_lshlrev_b32_e64 v156, 16, v40
    v_and_b32 v157, 0xffff0000, v40
    v_lshlrev_b32_e64 v158, 16, v41
    v_and_b32 v159, 0xffff0000, v41
    v_lshlrev_b32_e64 v160, 16, v42
    v_and_b32 v161, 0xffff0000, v42
    v_lshlrev_b32_e64 v162, 16, v43
    v_and_b32 v163, 0xffff0000, v43
    v_pk_fma_f32 v[156:157], v[156:157], v[246:247], v[244:245]
    v_pk_fma_f32 v[158:159], v[158:159], v[246:247], v[244:245]
    v_pk_fma_f32 v[160:161], v[160:161], v[246:247], v[244:245]
    v_pk_fma_f32 v[162:163], v[162:163], v[246:247], v[244:245]
    s_add_u32 m0, m0, 3840
    s_add_u32 s74, s74, 30720
    buffer_load_dwordx4 v239, s[8:11], s74 offen lds
    v_lshlrev_b32_e64 v164, 16, v44
    v_and_b32 v165, 0xffff0000, v44
    v_lshlrev_b32_e64 v166, 16, v45
    v_and_b32 v167, 0xffff0000, v45
    v_lshlrev_b32_e64 v168, 16, v46
    v_and_b32 v169, 0xffff0000, v46
    v_lshlrev_b32_e64 v170, 16, v47
    v_and_b32 v171, 0xffff0000, v47
    v_pk_fma_f32 v[164:165], v[164:165], v[246:247], v[244:245]
    v_pk_fma_f32 v[166:167], v[166:167], v[246:247], v[244:245]
    v_pk_fma_f32 v[168:169], v[168:169], v[246:247], v[244:245]
    v_pk_fma_f32 v[170:171], v[170:171], v[246:247], v[244:245]
    s_add_u32 m0, m0, 3840
    s_add_u32 s74, s74, 30720
    buffer_load_dwordx4 v239, s[8:11], s74 offen lds
    v_lshlrev_b32_e64 v172, 16, v48
    v_and_b32 v173, 0xffff0000, v48
    v_lshlrev_b32_e64 v174, 16, v49
    v_and_b32 v175, 0xffff0000, v49
    v_lshlrev_b32_e64 v176, 16, v50
    v_and_b32 v177, 0xffff0000, v50
    v_lshlrev_b32_e64 v178, 16, v51
    v_and_b32 v179, 0xffff0000, v51
    v_pk_fma_f32 v[172:173], v[172:173], v[246:247], v[244:245]
    v_pk_fma_f32 v[174:175], v[174:175], v[246:247], v[244:245]
    v_pk_fma_f32 v[176:177], v[176:177], v[246:247], v[244:245]
    v_pk_fma_f32 v[178:179], v[178:179], v[246:247], v[244:245]
    s_add_u32 m0, m0, 3840
    s_add_u32 s74, s74, 30720
    buffer_load_dwordx4 v239, s[8:11], s74 offen lds
    v_lshlrev_b32_e64 v180, 16, v52
    v_and_b32 v181, 0xffff0000, v52
    v_lshlrev_b32_e64 v182, 16, v53
    v_and_b32 v183, 0xffff0000, v53
    v_lshlrev_b32_e64 v184, 16, v54
    v_and_b32 v185, 0xffff0000, v54
    v_lshlrev_b32_e64 v186, 16, v55
    v_and_b32 v187, 0xffff0000, v55
    v_pk_fma_f32 v[180:181], v[180:181], v[246:247], v[244:245]
    v_pk_fma_f32 v[182:183], v[182:183], v[246:247], v[244:245]
    v_pk_fma_f32 v[184:185], v[184:185], v[246:247], v[244:245]
    v_pk_fma_f32 v[186:187], v[186:187], v[246:247], v[244:245]
    s_add_u32 m0, m0, 3840
    s_add_u32 s74, s74, 30720
    buffer_load_dwordx4 v239, s[8:11], s74 offen lds
    v_lshlrev_b32_e64 v188, 16, v56
    v_and_b32 v189, 0xffff0000, v56
    v_lshlrev_b32_e64 v190, 16, v57
    v_and_b32 v191, 0xffff0000, v57
    v_lshlrev_b32_e64 v192, 16, v58
    v_and_b32 v193, 0xffff0000, v58
    v_lshlrev_b32_e64 v194, 16, v59
    v_and_b32 v195, 0xffff0000, v59
    v_pk_fma_f32 v[188:189], v[188:189], v[246:247], v[244:245]
    v_pk_fma_f32 v[190:191], v[190:191], v[246:247], v[244:245]
    v_pk_fma_f32 v[192:193], v[192:193], v[246:247], v[244:245]
    v_pk_fma_f32 v[194:195], v[194:195], v[246:247], v[244:245]
    s_add_u32 m0, m0, 3840
    s_add_u32 s74, s74, 30720
    buffer_load_dwordx4 v239, s[8:11], s74 offen lds
    v_lshlrev_b32_e64 v196, 16, v60
    v_and_b32 v197, 0xffff0000, v60
    v_lshlrev_b32_e64 v198, 16, v61
    v_and_b32 v199, 0xffff0000, v61
    v_lshlrev_b32_e64 v200, 16, v62
    v_and_b32 v201, 0xffff0000, v62
    v_lshlrev_b32_e64 v202, 16, v63
    v_and_b32 v203, 0xffff0000, v63
    v_pk_fma_f32 v[196:197], v[196:197], v[246:247], v[244:245]
    v_pk_fma_f32 v[198:199], v[198:199], v[246:247], v[244:245]
    v_pk_fma_f32 v[200:201], v[200:201], v[246:247], v[244:245]
    v_pk_fma_f32 v[202:203], v[202:203], v[246:247], v[244:245]
    s_add_u32 m0, m0, 3840
    s_add_u32 s74, s74, 30720
    buffer_load_dwordx4 v239, s[8:11], s74 offen lds
    v_lshlrev_b32_e64 v204, 16, v64
    v_and_b32 v205, 0xffff0000, v64
    v_lshlrev_b32_e64 v206, 16, v65
    v_and_b32 v207, 0xffff0000, v65
    v_lshlrev_b32_e64 v208, 16, v66
    v_and_b32 v209, 0xffff0000, v66
    v_lshlrev_b32_e64 v210, 16, v67
    v_and_b32 v211, 0xffff0000, v67
    v_pk_fma_f32 v[204:205], v[204:205], v[246:247], v[244:245]
    v_pk_fma_f32 v[206:207], v[206:207], v[246:247], v[244:245]
    v_pk_fma_f32 v[208:209], v[208:209], v[246:247], v[244:245]
    v_pk_fma_f32 v[210:211], v[210:211], v[246:247], v[244:245]
    s_add_u32 m0, m0, 3840
    s_add_u32 s74, s74, 30720
    buffer_load_dwordx4 v239, s[8:11], s74 offen lds
    v_lshlrev_b32_e64 v212, 16, v68
    v_and_b32 v213, 0xffff0000, v68
    v_lshlrev_b32_e64 v214, 16, v69
    v_and_b32 v215, 0xffff0000, v69
    v_lshlrev_b32_e64 v216, 16, v70
    v_and_b32 v217, 0xffff0000, v70
    v_lshlrev_b32_e64 v218, 16, v71
    v_and_b32 v219, 0xffff0000, v71
    v_pk_fma_f32 v[212:213], v[212:213], v[246:247], v[244:245]
    v_pk_fma_f32 v[214:215], v[214:215], v[246:247], v[244:245]
    v_pk_fma_f32 v[216:217], v[216:217], v[246:247], v[244:245]
    v_pk_fma_f32 v[218:219], v[218:219], v[246:247], v[244:245]
    s_cmp_ge_u32 s22, 3
    s_cbranch_scc1 L_wq_14
    s_cmp_eq_u32 s22, 2
    s_nop 0
    s_mov_b32 s76, 0x0fffffff
    s_cselect_b32 exec_hi, 0xff, s76
    s_add_u32 m0, m0, 3840
    s_add_u32 s74, s74, 30720
    buffer_load_dwordx4 v239, s[8:11], s74 offen lds
    s_mov_b32 exec_hi, -1
L_wq_14:
    v_lshlrev_b32 v220, 16, v72
    v_and_b32 v221, 0xffff0000, v72
    v_lshlrev_b32_e64 v222, 16, v73
    v_and_b32 v223, 0xffff0000, v73
    v_lshlrev_b32_e64 v224, 16, v74
    v_and_b32 v225, 0xffff0000, v74
    v_lshlrev_b32_e64 v226, 16, v75
    v_and_b32 v227, 0xffff0000, v75
    v_pk_fma_f32 v[220:221], v[220:221], v[246:247], v[244:245]
    v_pk_fma_f32 v[222:223], v[222:223], v[246:247], v[244:245]
    v_pk_fma_f32 v[224:225], v[224:225], v[246:247], v[244:245]
    v_pk_fma_f32 v[226:227], v[226:227], v[246:247], v[244:245]
    v_lshlrev_b32_e64 v228, 16, v76
    v_and_b32 v229, 0xffff0000, v76
    v_lshlrev_b32_e64 v230, 16, v77
    v_and_b32 v231, 0xffff0000, v77
    v_lshlrev_b32_e64 v232, 16, v78
    v_and_b32 v233, 0xffff0000, v78
    v_lshlrev_b32_e64 v234, 16, v79
    v_and_b32 v235, 0xffff0000, v79
    v_pk_fma_f32 v[228:229], v[228:229], v[246:247], v[244:245]
    v_pk_fma_f32 v[230:231], v[230:231], v[246:247], v[244:245]
    v_pk_fma_f32 v[232:233], v[232:233], v[246:247], v[244:245]
    v_pk_fma_f32 v[234:235], v[234:235], v[246:247], v[244:245]
    v_lshlrev_b32_e64 v236, 16, v80
    v_and_b32 v237, 0xffff0000, v80
    v_lshlrev_b32_e64 v238, 16, v81
    v_and_b32 v239, 0xffff0000, v81
    v_lshlrev_b32_e64 v240, 16, v82
    v_and_b32 v241, 0xffff0000, v82
    v_lshlrev_b32_e64 v242, 16, v83
    v_and_b32 v243, 0xffff0000, v83
    v_pk_fma_f32 v[236:237], v[236:237], v[246:247], v[244:245]
    v_pk_fma_f32 v[238:239], v[238:239], v[246:247], v[244:245]
    v_pk_fma_f32 v[240:241], v[240:241], v[246:247], v[244:245]
    v_pk_fma_f32 v[242:243], v[242:243], v[246:247], v[244:245]
    s_mul_i32 s63, s22, 1280
    v_add_u32_e64 v246, s63, v3
    v_add_u32 v247, 1024, v246
    v_cmp_gt_u32 vcc, 16, v0
    s_nop 1
    v_cndmask_b32_e64 v247, v246, v247, vcc
    s_mov_b32 s62, 400000
L_mp_15:
    buffer_load_dwordx4 v[248:251], v246, s[4:7], 0 offen offset:0 sc1
    buffer_load_dwordx4 v[252:255], v247, s[4:7], 0 offen offset:0 sc1
    s_waitcnt vmcnt(0)
    v_cmp_ne_u32 vcc, s20, v250
    s_mov_b64 s[64:65], vcc
    v_cmp_ne_u32 vcc, s21, v251
    s_or_b64 s[64:65], s[64:65], vcc
    v_cmp_ne_u32 vcc, s20, v254
    s_or_b64 s[64:65], s[64:65], vcc
    v_cmp_ne_u32 vcc, s21, v255
    s_or_b64 s[64:65], s[64:65], vcc
    s_cmp_eq_u64 s[64:65], 0
    s_cbranch_scc1 L_mpok_16
    s_sub_u32 s62, s62, 1
    s_cmp_lg_u32 s62, 0
    s_cbranch_scc1 L_mp_15
    s_mov_b32 s28, 2
    s_branch L_fail
L_mpok_16:
    v_and_b32 v251, 0xffff0000, v249
    v_lshlrev_b32_e64 v250, 16, v249
    v_and_b32 v249, 0xffff0000, v248
    v_lshlrev_b32_e64 v248, 16, v248
    v_and_b32 v255, 0xffff0000, v253
    v_lshlrev_b32_e64 v254, 16, v253
    v_and_b32 v253, 0xffff0000, v252
    v_lshlrev_b32 v252, 16, v252
    s_cmp_lt_u32 s22, 2
    s_cbranch_scc1 L_a_17
    v_add_f32 v248, 1.0, v248
    v_add_f32 v249, 1.0, v249
    v_add_f32 v250, 1.0, v250
    v_add_f32_e64 v251, 1.0, v251
    v_cvt_pk_bf16_f32 v248, v248, v249
    v_cvt_pk_bf16_f32 v250, v250, v251
    v_and_b32 v249, 0xffff0000, v248
    v_lshlrev_b32_e64 v248, 16, v248
    v_and_b32 v251, 0xffff0000, v250
    v_lshlrev_b32 v250, 16, v250
    v_add_f32 v252, 1.0, v252
    v_add_f32 v253, 1.0, v253
    v_add_f32 v254, 1.0, v254
    v_add_f32_e64 v255, 1.0, v255
    v_cvt_pk_bf16_f32 v252, v252, v253
    v_cvt_pk_bf16_f32 v254, v254, v255
    v_and_b32 v253, 0xffff0000, v252
    v_lshlrev_b32_e64 v252, 16, v252
    v_and_b32 v255, 0xffff0000, v254
    v_lshlrev_b32_e64 v254, 16, v254
L_a_17:
    v_add_u32 v246, 144640, v246
    v_add_u32 v247, 144640, v247
    ds_write_b128 v246, v[248:251]
    ds_write_b128 v247, v[252:255]
    s_waitcnt lgkmcnt(0)
    s_barrier
    v_lshlrev_b32_e64 v244, 4, v2
    v_add_u32 v244, 144640, v244
    ds_read_b128 v[52:55], v244 offset:2560
    ds_read_b128 v[60:63], v244 offset:0
    ds_read_b128 v[56:59], v244 offset:2624
    ds_read_b128 v[64:67], v244 offset:64
    ds_read_b128 v[68:71], v244 offset:2688
    ds_read_b128 v[76:79], v244 offset:128
    ds_read_b128 v[72:75], v244 offset:2752
    ds_read_b128 v[80:83], v244 offset:192
    s_waitcnt lgkmcnt(4)
    s_nop 0
    v_pk_fma_f32 v[84:85], v[84:85], v[52:53], v[60:61]
    v_pk_fma_f32 v[86:87], v[86:87], v[54:55], v[62:63]
    v_pk_fma_f32 v[88:89], v[88:89], v[56:57], v[64:65]
    v_pk_fma_f32 v[90:91], v[90:91], v[58:59], v[66:67]
    v_cvt_pk_bf16_f32 v4, v84, v85
    v_cvt_pk_bf16_f32 v5, v86, v87
    v_cvt_pk_bf16_f32 v6, v88, v89
    v_cvt_pk_bf16_f32 v7, v90, v91
    ds_read_b128 v[52:55], v244 offset:2816
    ds_read_b128 v[60:63], v244 offset:256
    ds_read_b128 v[56:59], v244 offset:2880
    ds_read_b128 v[64:67], v244 offset:320
    s_waitcnt lgkmcnt(4)
    s_nop 0
    v_pk_fma_f32 v[92:93], v[92:93], v[68:69], v[76:77]
    v_pk_fma_f32 v[94:95], v[94:95], v[70:71], v[78:79]
    v_pk_fma_f32 v[96:97], v[96:97], v[72:73], v[80:81]
    v_pk_fma_f32 v[98:99], v[98:99], v[74:75], v[82:83]
    v_cvt_pk_bf16_f32 v8, v92, v93
    v_cvt_pk_bf16_f32 v9, v94, v95
    v_cvt_pk_bf16_f32 v10, v96, v97
    v_cvt_pk_bf16_f32 v11, v98, v99
    ds_read_b128 v[68:71], v244 offset:2944
    ds_read_b128 v[76:79], v244 offset:384
    ds_read_b128 v[72:75], v244 offset:3008
    ds_read_b128 v[80:83], v244 offset:448
    s_waitcnt lgkmcnt(4)
    s_nop 0
    v_pk_fma_f32 v[100:101], v[100:101], v[52:53], v[60:61]
    v_pk_fma_f32 v[102:103], v[102:103], v[54:55], v[62:63]
    v_pk_fma_f32 v[104:105], v[104:105], v[56:57], v[64:65]
    v_pk_fma_f32 v[106:107], v[106:107], v[58:59], v[66:67]
    v_cvt_pk_bf16_f32 v12, v100, v101
    v_cvt_pk_bf16_f32 v13, v102, v103
    v_cvt_pk_bf16_f32 v14, v104, v105
    v_cvt_pk_bf16_f32 v15, v106, v107
    ds_read_b128 v[52:55], v244 offset:3072
    ds_read_b128 v[60:63], v244 offset:512
    ds_read_b128 v[56:59], v244 offset:3136
    ds_read_b128 v[64:67], v244 offset:576
    s_waitcnt lgkmcnt(4)
    s_nop 0
    v_pk_fma_f32 v[108:109], v[108:109], v[68:69], v[76:77]
    v_pk_fma_f32 v[110:111], v[110:111], v[70:71], v[78:79]
    v_pk_fma_f32 v[112:113], v[112:113], v[72:73], v[80:81]
    v_pk_fma_f32 v[114:115], v[114:115], v[74:75], v[82:83]
    v_cvt_pk_bf16_f32 v16, v108, v109
    v_cvt_pk_bf16_f32 v17, v110, v111
    v_cvt_pk_bf16_f32 v18, v112, v113
    v_cvt_pk_bf16_f32 v19, v114, v115
    ds_read_b128 v[68:71], v244 offset:3200
    ds_read_b128 v[76:79], v244 offset:640
    ds_read_b128 v[72:75], v244 offset:3264
    ds_read_b128 v[80:83], v244 offset:704
    s_waitcnt lgkmcnt(4)
    s_nop 0
    v_pk_fma_f32 v[116:117], v[116:117], v[52:53], v[60:61]
    v_pk_fma_f32 v[118:119], v[118:119], v[54:55], v[62:63]
    v_pk_fma_f32 v[120:121], v[120:121], v[56:57], v[64:65]
    v_pk_fma_f32 v[122:123], v[122:123], v[58:59], v[66:67]
    v_cvt_pk_bf16_f32 v20, v116, v117
    v_cvt_pk_bf16_f32 v21, v118, v119
    v_cvt_pk_bf16_f32 v22, v120, v121
    v_cvt_pk_bf16_f32 v23, v122, v123
    ds_read_b128 v[52:55], v244 offset:3328
    ds_read_b128 v[60:63], v244 offset:768
    ds_read_b128 v[56:59], v244 offset:3392
    ds_read_b128 v[64:67], v244 offset:832
    s_waitcnt lgkmcnt(4)
    s_nop 0
    v_pk_fma_f32 v[124:125], v[124:125], v[68:69], v[76:77]
    v_pk_fma_f32 v[126:127], v[126:127], v[70:71], v[78:79]
    v_pk_fma_f32 v[128:129], v[128:129], v[72:73], v[80:81]
    v_pk_fma_f32 v[130:131], v[130:131], v[74:75], v[82:83]
    v_cvt_pk_bf16_f32 v24, v124, v125
    v_cvt_pk_bf16_f32 v25, v126, v127
    v_cvt_pk_bf16_f32 v26, v128, v129
    v_cvt_pk_bf16_f32 v27, v130, v131
    ds_read_b128 v[68:71], v244 offset:3456
    ds_read_b128 v[76:79], v244 offset:896
    ds_read_b128 v[72:75], v244 offset:3520
    ds_read_b128 v[80:83], v244 offset:960
    s_waitcnt lgkmcnt(4)
    s_nop 0
    v_pk_fma_f32 v[132:133], v[132:133], v[52:53], v[60:61]
    v_pk_fma_f32 v[134:135], v[134:135], v[54:55], v[62:63]
    v_pk_fma_f32 v[136:137], v[136:137], v[56:57], v[64:65]
    v_pk_fma_f32 v[138:139], v[138:139], v[58:59], v[66:67]
    v_cvt_pk_bf16_f32 v28, v132, v133
    v_cvt_pk_bf16_f32 v29, v134, v135
    v_cvt_pk_bf16_f32 v30, v136, v137
    v_cvt_pk_bf16_f32 v31, v138, v139
    ds_read_b128 v[52:55], v244 offset:3584
    ds_read_b128 v[60:63], v244 offset:1024
    ds_read_b128 v[56:59], v244 offset:3648
    ds_read_b128 v[64:67], v244 offset:1088
    s_waitcnt lgkmcnt(4)
    s_nop 0
    v_pk_fma_f32 v[140:141], v[140:141], v[68:69], v[76:77]
    v_pk_fma_f32 v[142:143], v[142:143], v[70:71], v[78:79]
    v_pk_fma_f32 v[144:145], v[144:145], v[72:73], v[80:81]
    v_pk_fma_f32 v[146:147], v[146:147], v[74:75], v[82:83]
    v_cvt_pk_bf16_f32 v32, v140, v141
    v_cvt_pk_bf16_f32 v33, v142, v143
    v_cvt_pk_bf16_f32 v34, v144, v145
    v_cvt_pk_bf16_f32 v35, v146, v147
    ds_read_b128 v[68:71], v244 offset:3712
    ds_read_b128 v[76:79], v244 offset:1152
    ds_read_b128 v[72:75], v244 offset:3776
    ds_read_b128 v[80:83], v244 offset:1216
    s_waitcnt lgkmcnt(4)
    s_nop 0
    v_pk_fma_f32 v[148:149], v[148:149], v[52:53], v[60:61]
    v_pk_fma_f32 v[150:151], v[150:151], v[54:55], v[62:63]
    v_pk_fma_f32 v[152:153], v[152:153], v[56:57], v[64:65]
    v_pk_fma_f32 v[154:155], v[154:155], v[58:59], v[66:67]
    v_cvt_pk_bf16_f32 v36, v148, v149
    v_cvt_pk_bf16_f32 v37, v150, v151
    v_cvt_pk_bf16_f32 v38, v152, v153
    v_cvt_pk_bf16_f32 v39, v154, v155
    ds_read_b128 v[52:55], v244 offset:3840
    ds_read_b128 v[60:63], v244 offset:1280
    ds_read_b128 v[56:59], v244 offset:3904
    ds_read_b128 v[64:67], v244 offset:1344
    s_waitcnt lgkmcnt(4)
    s_nop 0
    v_pk_fma_f32 v[156:157], v[156:157], v[68:69], v[76:77]
    v_pk_fma_f32 v[158:159], v[158:159], v[70:71], v[78:79]
    v_pk_fma_f32 v[160:161], v[160:161], v[72:73], v[80:81]
    v_pk_fma_f32 v[162:163], v[162:163], v[74:75], v[82:83]
    v_cvt_pk_bf16_f32 v40, v156, v157
    v_cvt_pk_bf16_f32 v41, v158, v159
    v_cvt_pk_bf16_f32 v42, v160, v161
    v_cvt_pk_bf16_f32 v43, v162, v163
    ds_read_b128 v[68:71], v244 offset:3968
    ds_read_b128 v[76:79], v244 offset:1408
    ds_read_b128 v[72:75], v244 offset:4032
    ds_read_b128 v[80:83], v244 offset:1472
    s_waitcnt lgkmcnt(4)
    s_nop 0
    v_pk_fma_f32 v[164:165], v[164:165], v[52:53], v[60:61]
    v_pk_fma_f32 v[166:167], v[166:167], v[54:55], v[62:63]
    v_pk_fma_f32 v[168:169], v[168:169], v[56:57], v[64:65]
    v_pk_fma_f32 v[170:171], v[170:171], v[58:59], v[66:67]
    v_cvt_pk_bf16_f32 v44, v164, v165
    v_cvt_pk_bf16_f32 v45, v166, v167
    v_cvt_pk_bf16_f32 v46, v168, v169
    v_cvt_pk_bf16_f32 v47, v170, v171
    ds_read_b128 v[84:87], v244 offset:4096
    ds_read_b128 v[92:95], v244 offset:1536
    ds_read_b128 v[88:91], v244 offset:4160
    ds_read_b128 v[96:99], v244 offset:1600
    s_waitcnt lgkmcnt(4)
    s_nop 0
    v_pk_fma_f32 v[172:173], v[172:173], v[68:69], v[76:77]
    v_pk_fma_f32 v[174:175], v[174:175], v[70:71], v[78:79]
    v_pk_fma_f32 v[176:177], v[176:177], v[72:73], v[80:81]
    v_pk_fma_f32 v[178:179], v[178:179], v[74:75], v[82:83]
    v_cvt_pk_bf16_f32 v48, v172, v173
    v_cvt_pk_bf16_f32 v49, v174, v175
    v_cvt_pk_bf16_f32 v50, v176, v177
    v_cvt_pk_bf16_f32 v51, v178, v179
    ds_read_b128 v[100:103], v244 offset:4224
    ds_read_b128 v[108:111], v244 offset:1664
    ds_read_b128 v[104:107], v244 offset:4288
    ds_read_b128 v[112:115], v244 offset:1728
    s_waitcnt lgkmcnt(4)
    s_nop 0
    v_pk_fma_f32 v[180:181], v[180:181], v[84:85], v[92:93]
    v_pk_fma_f32 v[182:183], v[182:183], v[86:87], v[94:95]
    v_pk_fma_f32 v[184:185], v[184:185], v[88:89], v[96:97]
    v_pk_fma_f32 v[186:187], v[186:187], v[90:91], v[98:99]
    v_cvt_pk_bf16_f32 v52, v180, v181
    v_cvt_pk_bf16_f32 v53, v182, v183
    v_cvt_pk_bf16_f32 v54, v184, v185
    v_cvt_pk_bf16_f32 v55, v186, v187
    ds_read_b128 v[84:87], v244 offset:4352
    ds_read_b128 v[92:95], v244 offset:1792
    ds_read_b128 v[88:91], v244 offset:4416
    ds_read_b128 v[96:99], v244 offset:1856
    s_waitcnt lgkmcnt(4)
    s_nop 0
    v_pk_fma_f32 v[188:189], v[188:189], v[100:101], v[108:109]
    v_pk_fma_f32 v[190:191], v[190:191], v[102:103], v[110:111]
    v_pk_fma_f32 v[192:193], v[192:193], v[104:105], v[112:113]
    v_pk_fma_f32 v[194:195], v[194:195], v[106:107], v[114:115]
    v_cvt_pk_bf16_f32 v56, v188, v189
    v_cvt_pk_bf16_f32 v57, v190, v191
    v_cvt_pk_bf16_f32 v58, v192, v193
    v_cvt_pk_bf16_f32 v59, v194, v195
    ds_read_b128 v[100:103], v244 offset:4480
    ds_read_b128 v[108:111], v244 offset:1920
    ds_read_b128 v[104:107], v244 offset:4544
    ds_read_b128 v[112:115], v244 offset:1984
    s_waitcnt lgkmcnt(4)
    s_nop 0
    v_pk_fma_f32 v[196:197], v[196:197], v[84:85], v[92:93]
    v_pk_fma_f32 v[198:199], v[198:199], v[86:87], v[94:95]
    v_pk_fma_f32 v[200:201], v[200:201], v[88:89], v[96:97]
    v_pk_fma_f32 v[202:203], v[202:203], v[90:91], v[98:99]
    v_cvt_pk_bf16_f32 v60, v196, v197
    v_cvt_pk_bf16_f32 v61, v198, v199
    v_cvt_pk_bf16_f32 v62, v200, v201
    v_cvt_pk_bf16_f32 v63, v202, v203
    ds_read_b128 v[84:87], v244 offset:4608
    ds_read_b128 v[92:95], v244 offset:2048
    ds_read_b128 v[88:91], v244 offset:4672
    ds_read_b128 v[96:99], v244 offset:2112
    s_waitcnt lgkmcnt(4)
    s_nop 0
    v_pk_fma_f32 v[204:205], v[204:205], v[100:101], v[108:109]
    v_pk_fma_f32 v[206:207], v[206:207], v[102:103], v[110:111]
    v_pk_fma_f32 v[208:209], v[208:209], v[104:105], v[112:113]
    v_pk_fma_f32 v[210:211], v[210:211], v[106:107], v[114:115]
    v_cvt_pk_bf16_f32 v64, v204, v205
    v_cvt_pk_bf16_f32 v65, v206, v207
    v_cvt_pk_bf16_f32 v66, v208, v209
    v_cvt_pk_bf16_f32 v67, v210, v211
    ds_read_b128 v[100:103], v244 offset:4736
    ds_read_b128 v[108:111], v244 offset:2176
    ds_read_b128 v[104:107], v244 offset:4800
    ds_read_b128 v[112:115], v244 offset:2240
    s_waitcnt lgkmcnt(4)
    s_nop 0
    v_pk_fma_f32 v[212:213], v[212:213], v[84:85], v[92:93]
    v_pk_fma_f32 v[214:215], v[214:215], v[86:87], v[94:95]
    v_pk_fma_f32 v[216:217], v[216:217], v[88:89], v[96:97]
    v_pk_fma_f32 v[218:219], v[218:219], v[90:91], v[98:99]
    v_cvt_pk_bf16_f32 v68, v212, v213
    v_cvt_pk_bf16_f32 v69, v214, v215
    v_cvt_pk_bf16_f32 v70, v216, v217
    v_cvt_pk_bf16_f32 v71, v218, v219
    ds_read_b128 v[84:87], v244 offset:4864
    ds_read_b128 v[92:95], v244 offset:2304
    ds_read_b128 v[88:91], v244 offset:4928
    ds_read_b128 v[96:99], v244 offset:2368
    s_waitcnt lgkmcnt(4)
    s_nop 0
    v_pk_fma_f32 v[220:221], v[220:221], v[100:101], v[108:109]
    v_pk_fma_f32 v[222:223], v[222:223], v[102:103], v[110:111]
    v_pk_fma_f32 v[224:225], v[224:225], v[104:105], v[112:113]
    v_pk_fma_f32 v[226:227], v[226:227], v[106:107], v[114:115]
    v_cvt_pk_bf16_f32 v72, v220, v221
    v_cvt_pk_bf16_f32 v73, v222, v223
    v_cvt_pk_bf16_f32 v74, v224, v225
    v_cvt_pk_bf16_f32 v75, v226, v227
    ds_read_b128 v[100:103], v244 offset:4992
    ds_read_b128 v[108:111], v244 offset:2432
    ds_read_b128 v[104:107], v244 offset:5056
    ds_read_b128 v[112:115], v244 offset:2496
    s_waitcnt lgkmcnt(4)
    s_nop 0
    v_pk_fma_f32 v[228:229], v[228:229], v[84:85], v[92:93]
    v_pk_fma_f32 v[230:231], v[230:231], v[86:87], v[94:95]
    v_pk_fma_f32 v[232:233], v[232:233], v[88:89], v[96:97]
    v_pk_fma_f32 v[234:235], v[234:235], v[90:91], v[98:99]
    v_cvt_pk_bf16_f32 v76, v228, v229
    v_cvt_pk_bf16_f32 v77, v230, v231
    v_cvt_pk_bf16_f32 v78, v232, v233
    v_cvt_pk_bf16_f32 v79, v234, v235
    s_waitcnt lgkmcnt(0)
    s_nop 0
    v_pk_fma_f32 v[236:237], v[236:237], v[100:101], v[108:109]
    v_pk_fma_f32 v[238:239], v[238:239], v[102:103], v[110:111]
    v_pk_fma_f32 v[240:241], v[240:241], v[104:105], v[112:113]
    v_pk_fma_f32 v[242:243], v[242:243], v[106:107], v[114:115]
    v_cvt_pk_bf16_f32 v80, v236, v237
    v_cvt_pk_bf16_f32 v81, v238, v239
    v_cvt_pk_bf16_f32 v82, v240, v241
    v_cvt_pk_bf16_f32 v83, v242, v243
    s_cmp_lg_u32 s80, 2
    s_cbranch_scc1 L_dg_18
    s_mov_b32 s12, s52
    s_mov_b32 s13, s53
    s_mov_b32 s14, 1280
    s_mov_b32 s15, 0x20000
    s_mul_i32 s66, s22, 320
    v_lshlrev_b32_e64 v230, 3, v0
    buffer_load_dwordx2 a[250:251], v230, s[12:15], s66 offen
    s_mov_b32 s8, s54
    s_mov_b32 s9, s55
    s_mov_b32 s10, 4915200
    s_mov_b32 s11, 0x20000
    v_lshrrev_b32_e64 v228, 2, v0
    v_mul_u32_u24 v228, 7680, v228
    v_and_b32_e64 v229, 3, v0
    v_lshl_add_u32 v228, v229, 4, v228
    s_mul_i32 s63, s22, 1228800
    s_lshl_b32 s64, s81, 6
    s_add_u32 s63, s63, s64
    s_mul_i32 s65, s22, 10240
    s_add_u32 s65, s65, 102400
    s_mov_b32 m0, s65
    s_nop 0
    s_add_u32 s65, s65, 1024
    buffer_load_dwordx4 v228, s[8:11], s63 offen lds
    s_add_u32 s63, s63, 122880
    s_mov_b32 m0, s65
    s_nop 0
    s_add_u32 s65, s65, 1024
    buffer_load_dwordx4 v228, s[8:11], s63 offen lds
    s_add_u32 s63, s63, 122880
    s_mov_b32 m0, s65
    s_nop 0
    s_add_u32 s65, s65, 1024
    buffer_load_dwordx4 v228, s[8:11], s63 offen lds
    s_add_u32 s63, s63, 122880
    s_mov_b32 m0, s65
    s_nop 0
    s_add_u32 s65, s65, 1024
    buffer_load_dwordx4 v228, s[8:11], s63 offen lds
    s_add_u32 s63, s63, 122880
    s_mov_b32 m0, s65
    s_nop 0
    s_add_u32 s65, s65, 1024
    buffer_load_dwordx4 v228, s[8:11], s63 offen lds
    s_add_u32 s63, s63, 122880
    s_mov_b32 m0, s65
    s_nop 0
    s_add_u32 s65, s65, 1024
    buffer_load_dwordx4 v228, s[8:11], s63 offen lds
    s_add_u32 s63, s63, 122880
    s_mov_b32 m0, s65
    s_nop 0
    s_add_u32 s65, s65, 1024
    buffer_load_dwordx4 v228, s[8:11], s63 offen lds
    s_add_u32 s63, s63, 122880
    s_mov_b32 m0, s65
    s_nop 0
    s_add_u32 s65, s65, 1024
    buffer_load_dwordx4 v228, s[8:11], s63 offen lds
    s_add_u32 s63, s63, 122880
    s_mov_b32 m0, s65
    s_nop 0
    s_add_u32 s65, s65, 1024
    buffer_load_dwordx4 v228, s[8:11], s63 offen lds
    s_add_u32 s63, s63, 122880
    s_mov_b32 m0, s65
    s_nop 0
    s_add_u32 s65, s65, 1024
    buffer_load_dwordx4 v228, s[8:11], s63 offen lds
    s_add_u32 s63, s63, 122880
L_dg_18:
    s_cmp_ge_u32 s23, 2
    s_cbranch_scc1 L_kvend_19
    v_lshrrev_b32_e64 v84, 2, v1
    v_lshl_add_u32 v84, v2, 2, v84
    v_mul_u32_u24 v84, 40, v84
    v_and_b32 v85, 3, v1
    v_lshl_add_u32 v84, v85, 3, v84
    v_add_u32 v84, 102400, v84
    s_cmp_eq_u32 s23, 1
    s_cbranch_scc1 L_v_20
    ds_read_b64_tr_b16 v[132:133], v84 offset:0
    ds_read_b64_tr_b16 v[134:135], v84 offset:640
    ds_read_b64_tr_b16 v[136:137], v84 offset:32
    ds_read_b64_tr_b16 v[138:139], v84 offset:672
    ds_read_b64_tr_b16 v[140:141], v84 offset:1280
    ds_read_b64_tr_b16 v[142:143], v84 offset:1920
    ds_read_b64_tr_b16 v[144:145], v84 offset:1312
    ds_read_b64_tr_b16 v[146:147], v84 offset:1952
    ds_read_b64_tr_b16 v[148:149], v84 offset:2560
    ds_read_b64_tr_b16 v[150:151], v84 offset:3200
    ds_read_b64_tr_b16 v[152:153], v84 offset:2592
    ds_read_b64_tr_b16 v[154:155], v84 offset:3232
    ds_read_b64_tr_b16 v[156:157], v84 offset:3840
    ds_read_b64_tr_b16 v[158:159], v84 offset:4480
    ds_read_b64_tr_b16 v[160:161], v84 offset:3872
    ds_read_b64_tr_b16 v[162:163], v84 offset:4512
    s_waitcnt lgkmcnt(12)
    s_nop 0
    v_mfma_f32_16x16x32_bf16 v[108:111], v[132:135], v[4:7], 0
    v_mfma_f32_16x16x32_bf16 v[112:115], v[136:139], v[4:7], 0
    ds_read_b64_tr_b16 v[132:133], v84 offset:5120
    ds_read_b64_tr_b16 v[134:135], v84 offset:5760
    ds_read_b64_tr_b16 v[136:137], v84 offset:5152
    ds_read_b64_tr_b16 v[138:139], v84 offset:5792
    s_waitcnt lgkmcnt(12)
    s_nop 0
    v_mfma_f32_16x16x32_bf16 v[108:111], v[140:143], v[8:11], v[108:111]
    v_mfma_f32_16x16x32_bf16 v[112:115], v[144:147], v[8:11], v[112:115]
    ds_read_b64_tr_b16 v[140:141], v84 offset:6400
    ds_read_b64_tr_b16 v[142:143], v84 offset:7040
    ds_read_b64_tr_b16 v[144:145], v84 offset:6432
    ds_read_b64_tr_b16 v[146:147], v84 offset:7072
    s_waitcnt lgkmcnt(12)
    s_nop 0
    v_mfma_f32_16x16x32_bf16 v[108:111], v[148:151], v[12:15], v[108:111]
    v_mfma_f32_16x16x32_bf16 v[112:115], v[152:155], v[12:15], v[112:115]
    ds_read_b64_tr_b16 v[148:149], v84 offset:7680
    ds_read_b64_tr_b16 v[150:151], v84 offset:8320
    ds_read_b64_tr_b16 v[152:153], v84 offset:7712
    ds_read_b64_tr_b16 v[154:155], v84 offset:8352
    s_waitcnt lgkmcnt(12)
    s_nop 0
    v_mfma_f32_16x16x32_bf16 v[108:111], v[156:159], v[16:19], v[108:111]
    v_mfma_f32_16x16x32_bf16 v[112:115], v[160:163], v[16:19], v[112:115]
    ds_read_b64_tr_b16 v[156:157], v84 offset:8960
    ds_read_b64_tr_b16 v[158:159], v84 offset:9600
    ds_read_b64_tr_b16 v[160:161], v84 offset:8992
    ds_read_b64_tr_b16 v[162:163], v84 offset:9632
    s_waitcnt lgkmcnt(12)
    s_nop 0
    v_mfma_f32_16x16x32_bf16 v[108:111], v[132:135], v[20:23], v[108:111]
    v_mfma_f32_16x16x32_bf16 v[112:115], v[136:139], v[20:23], v[112:115]
    ds_read_b64_tr_b16 v[132:133], v84 offset:10240
    ds_read_b64_tr_b16 v[134:135], v84 offset:10880
    ds_read_b64_tr_b16 v[136:137], v84 offset:10272
    ds_read_b64_tr_b16 v[138:139], v84 offset:10912
    s_waitcnt lgkmcnt(12)
    s_nop 0
    v_mfma_f32_16x16x32_bf16 v[108:111], v[140:143], v[24:27], v[108:111]
    v_mfma_f32_16x16x32_bf16 v[112:115], v[144:147], v[24:27], v[112:115]
    ds_read_b64_tr_b16 v[140:141], v84 offset:11520
    ds_read_b64_tr_b16 v[142:143], v84 offset:12160
    ds_read_b64_tr_b16 v[144:145], v84 offset:11552
    ds_read_b64_tr_b16 v[146:147], v84 offset:12192
    s_waitcnt lgkmcnt(12)
    s_nop 0
    v_mfma_f32_16x16x32_bf16 v[108:111], v[148:151], v[28:31], v[108:111]
    v_mfma_f32_16x16x32_bf16 v[112:115], v[152:155], v[28:31], v[112:115]
    ds_read_b64_tr_b16 v[148:149], v84 offset:12800
    ds_read_b64_tr_b16 v[150:151], v84 offset:13440
    ds_read_b64_tr_b16 v[152:153], v84 offset:12832
    ds_read_b64_tr_b16 v[154:155], v84 offset:13472
    s_waitcnt lgkmcnt(12)
    s_nop 0
    v_mfma_f32_16x16x32_bf16 v[108:111], v[156:159], v[32:35], v[108:111]
    v_mfma_f32_16x16x32_bf16 v[112:115], v[160:163], v[32:35], v[112:115]
    ds_read_b64_tr_b16 v[156:157], v84 offset:14080
    ds_read_b64_tr_b16 v[158:159], v84 offset:14720
    ds_read_b64_tr_b16 v[160:161], v84 offset:14112
    ds_read_b64_tr_b16 v[162:163], v84 offset:14752
    s_waitcnt lgkmcnt(12)
    s_nop 0
    v_mfma_f32_16x16x32_bf16 v[108:111], v[132:135], v[36:39], v[108:111]
    v_mfma_f32_16x16x32_bf16 v[112:115], v[136:139], v[36:39], v[112:115]
    ds_read_b64_tr_b16 v[132:133], v84 offset:15360
    ds_read_b64_tr_b16 v[134:135], v84 offset:16000
    ds_read_b64_tr_b16 v[136:137], v84 offset:15392
    ds_read_b64_tr_b16 v[138:139], v84 offset:16032
    s_waitcnt lgkmcnt(12)
    s_nop 0
    v_mfma_f32_16x16x32_bf16 v[108:111], v[140:143], v[40:43], v[108:111]
    v_mfma_f32_16x16x32_bf16 v[112:115], v[144:147], v[40:43], v[112:115]
    ds_read_b64_tr_b16 v[140:141], v84 offset:16640
    ds_read_b64_tr_b16 v[142:143], v84 offset:17280
    ds_read_b64_tr_b16 v[144:145], v84 offset:16672
    ds_read_b64_tr_b16 v[146:147], v84 offset:17312
    s_waitcnt lgkmcnt(12)
    s_nop 0
    v_mfma_f32_16x16x32_bf16 v[108:111], v[148:151], v[44:47], v[108:111]
    v_mfma_f32_16x16x32_bf16 v[112:115], v[152:155], v[44:47], v[112:115]
    ds_read_b64_tr_b16 v[148:149], v84 offset:17920
    ds_read_b64_tr_b16 v[150:151], v84 offset:18560
    ds_read_b64_tr_b16 v[152:153], v84 offset:17952
    ds_read_b64_tr_b16 v[154:155], v84 offset:18592
    s_waitcnt lgkmcnt(12)
    s_nop 0
    v_mfma_f32_16x16x32_bf16 v[108:111], v[156:159], v[48:51], v[108:111]
    v_mfma_f32_16x16x32_bf16 v[112:115], v[160:163], v[48:51], v[112:115]
    ds_read_b64_tr_b16 v[156:157], v84 offset:19200
    ds_read_b64_tr_b16 v[158:159], v84 offset:19840
    ds_read_b64_tr_b16 v[160:161], v84 offset:19232
    ds_read_b64_tr_b16 v[162:163], v84 offset:19872
    s_waitcnt lgkmcnt(12)
    s_nop 0
    v_mfma_f32_16x16x32_bf16 v[108:111], v[132:135], v[52:55], v[108:111]
    v_mfma_f32_16x16x32_bf16 v[112:115], v[136:139], v[52:55], v[112:115]
    ds_read_b64_tr_b16 v[132:133], v84 offset:20480
    ds_read_b64_tr_b16 v[134:135], v84 offset:21120
    ds_read_b64_tr_b16 v[136:137], v84 offset:20512
    ds_read_b64_tr_b16 v[138:139], v84 offset:21152
    s_waitcnt lgkmcnt(12)
    s_nop 0
    v_mfma_f32_16x16x32_bf16 v[108:111], v[140:143], v[56:59], v[108:111]
    v_mfma_f32_16x16x32_bf16 v[112:115], v[144:147], v[56:59], v[112:115]
    ds_read_b64_tr_b16 v[140:141], v84 offset:21760
    ds_read_b64_tr_b16 v[142:143], v84 offset:22400
    ds_read_b64_tr_b16 v[144:145], v84 offset:21792
    ds_read_b64_tr_b16 v[146:147], v84 offset:22432
    s_waitcnt lgkmcnt(12)
    s_nop 0
    v_mfma_f32_16x16x32_bf16 v[108:111], v[148:151], v[60:63], v[108:111]
    v_mfma_f32_16x16x32_bf16 v[112:115], v[152:155], v[60:63], v[112:115]
    ds_read_b64_tr_b16 v[148:149], v84 offset:23040
    ds_read_b64_tr_b16 v[150:151], v84 offset:23680
    ds_read_b64_tr_b16 v[152:153], v84 offset:23072
    ds_read_b64_tr_b16 v[154:155], v84 offset:23712
    s_waitcnt lgkmcnt(12)
    s_nop 0
    v_mfma_f32_16x16x32_bf16 v[108:111], v[156:159], v[64:67], v[108:111]
    v_mfma_f32_16x16x32_bf16 v[112:115], v[160:163], v[64:67], v[112:115]
    ds_read_b64_tr_b16 v[156:157], v84 offset:24320
    ds_read_b64_tr_b16 v[158:159], v84 offset:24960
    ds_read_b64_tr_b16 v[160:161], v84 offset:24352
    ds_read_b64_tr_b16 v[162:163], v84 offset:24992
    s_waitcnt lgkmcnt(12)
    s_nop 0
    v_mfma_f32_16x16x32_bf16 v[108:111], v[132:135], v[68:71], v[108:111]
    v_mfma_f32_16x16x32_bf16 v[112:115], v[136:139], v[68:71], v[112:115]
    s_waitcnt lgkmcnt(8)
    s_nop 0
    v_mfma_f32_16x16x32_bf16 v[108:111], v[140:143], v[72:75], v[108:111]
    v_mfma_f32_16x16x32_bf16 v[112:115], v[144:147], v[72:75], v[112:115]
    s_waitcnt lgkmcnt(4)
    s_nop 0
    v_mfma_f32_16x16x32_bf16 v[108:111], v[148:151], v[76:79], v[108:111]
    v_mfma_f32_16x16x32_bf16 v[112:115], v[152:155], v[76:79], v[112:115]
    s_waitcnt lgkmcnt(0)
    s_nop 0
    v_mfma_f32_16x16x32_bf16 v[108:111], v[156:159], v[80:83], v[108:111]
    v_mfma_f32_16x16x32_bf16 v[112:115], v[160:163], v[80:83], v[112:115]
    s_nop 6
    v_mul_f32 v116, v108, v108
    v_fmac_f32 v116, v109, v109
    v_fmac_f32 v116, v110, v110
    v_fmac_f32 v116, v111, v111
    v_mul_f32 v117, v112, v112
    v_fmac_f32 v117, v113, v113
    v_fmac_f32 v117, v114, v114
    v_fmac_f32 v117, v115, v115
    v_cmp_eq_u32 vcc, 0, v2
    s_nop 1
    v_cndmask_b32 v117, 0, v117, vcc
    v_add_f32 v116, v116, v117
    v_mov_b32 v118, v116
    s_nop 1
    v_permlane16_swap_b32 v116, v118
    v_add_f32 v116, v116, v118
    v_mov_b32 v118, v116
    s_nop 1
    v_permlane32_swap_b32 v116, v118
    v_add_f32 v116, v116, v118
    s_nop 1
    v_mov_b32_dpp v118, v116 row_ror:8 row_mask:0xf bank_mask:0xf
    v_max_f32 v116, v116, v118
    s_nop 1
    v_mov_b32_dpp v118, v116 row_ror:4 row_mask:0xf bank_mask:0xf
    v_max_f32 v116, v116, v118
    s_nop 1
    v_mov_b32_dpp v118, v116 row_ror:2 row_mask:0xf bank_mask:0xf
    v_max_f32 v116, v116, v118
    s_nop 1
    v_mov_b32_dpp v118, v116 row_ror:1 row_mask:0xf bank_mask:0xf
    v_max_f32 v116, v116, v118
    s_lshl_b32 s62, s22, 2
    s_add_u32 s62, s62, 161024
    v_mov_b32_e64 v118, s62
    ds_write_b32 v118, v116
    v_cvt_pk_bf16_f32 v120, v108, v109
    v_cvt_pk_bf16_f32 v121, v110, v111
    v_cvt_pk_bf16_f32 v122, v112, v113
    v_cvt_pk_bf16_f32 v123, v114, v115
    s_lshr_b32 s62, s27, 1
    s_nop 0
    s_mul_i32 s62, s62, 3328
    s_add_u32 s62, s62, 1048576
    s_and_b32 s63, s27, 1
    s_lshl_b32 s63, s63, 4
    v_add_u32 v124, s63, v1
    v_lshrrev_b32 v125, 1, v2
    v_lshl_add_u32 v125, v125, 5, v124
    v_lshlrev_b32 v125, 4, v125
    v_and_b32 v126, 1, v2
    v_lshl_add_u32 v125, v126, 3, v125
    buffer_store_dwordx2 v[120:121], v125, s[4:7], s62 offen sc1
    v_lshlrev_b32_e64 v124, 3, v124
    v_cmp_eq_u32 vcc, 0, v2
    s_and_saveexec_b64 s[66:67], vcc
    buffer_store_dwordx2 v[122:123], v124, s[4:7], s62 offen offset:1024 sc1
    s_mov_b64 exec, s[66:67]
    s_branch L_kvpub_21
L_v_20:
    ds_read_b64_tr_b16 v[132:133], v84 offset:0
    ds_read_b64_tr_b16 v[134:135], v84 offset:640
    ds_read_b64_tr_b16 v[136:137], v84 offset:32
    ds_read_b64_tr_b16 v[138:139], v84 offset:672
    ds_read_b64_tr_b16 v[140:141], v84 offset:1280
    ds_read_b64_tr_b16 v[142:143], v84 offset:1920
    ds_read_b64_tr_b16 v[144:145], v84 offset:1312
    ds_read_b64_tr_b16 v[146:147], v84 offset:1952
    ds_read_b64_tr_b16 v[148:149], v84 offset:2560
    ds_read_b64_tr_b16 v[150:151], v84 offset:3200
    ds_read_b64_tr_b16 v[152:153], v84 offset:2592
    ds_read_b64_tr_b16 v[154:155], v84 offset:3232
    ds_read_b64_tr_b16 v[156:157], v84 offset:3840
    ds_read_b64_tr_b16 v[158:159], v84 offset:4480
    ds_read_b64_tr_b16 v[160:161], v84 offset:3872
    ds_read_b64_tr_b16 v[162:163], v84 offset:4512
    s_waitcnt lgkmcnt(12)
    s_nop 0
    v_mfma_f32_16x16x32_bf16 v[108:111], v[4:7], v[132:135], 0
    v_mfma_f32_16x16x32_bf16 v[112:115], v[4:7], v[136:139], 0
    ds_read_b64_tr_b16 v[132:133], v84 offset:5120
    ds_read_b64_tr_b16 v[134:135], v84 offset:5760
    ds_read_b64_tr_b16 v[136:137], v84 offset:5152
    ds_read_b64_tr_b16 v[138:139], v84 offset:5792
    s_waitcnt lgkmcnt(12)
    s_nop 0
    v_mfma_f32_16x16x32_bf16 v[108:111], v[8:11], v[140:143], v[108:111]
    v_mfma_f32_16x16x32_bf16 v[112:115], v[8:11], v[144:147], v[112:115]
    ds_read_b64_tr_b16 v[140:141], v84 offset:6400
    ds_read_b64_tr_b16 v[142:143], v84 offset:7040
    ds_read_b64_tr_b16 v[144:145], v84 offset:6432
    ds_read_b64_tr_b16 v[146:147], v84 offset:7072
    s_waitcnt lgkmcnt(12)
    s_nop 0
    v_mfma_f32_16x16x32_bf16 v[108:111], v[12:15], v[148:151], v[108:111]
    v_mfma_f32_16x16x32_bf16 v[112:115], v[12:15], v[152:155], v[112:115]
    ds_read_b64_tr_b16 v[148:149], v84 offset:7680
    ds_read_b64_tr_b16 v[150:151], v84 offset:8320
    ds_read_b64_tr_b16 v[152:153], v84 offset:7712
    ds_read_b64_tr_b16 v[154:155], v84 offset:8352
    s_waitcnt lgkmcnt(12)
    s_nop 0
    v_mfma_f32_16x16x32_bf16 v[108:111], v[16:19], v[156:159], v[108:111]
    v_mfma_f32_16x16x32_bf16 v[112:115], v[16:19], v[160:163], v[112:115]
    ds_read_b64_tr_b16 v[156:157], v84 offset:8960
    ds_read_b64_tr_b16 v[158:159], v84 offset:9600
    ds_read_b64_tr_b16 v[160:161], v84 offset:8992
    ds_read_b64_tr_b16 v[162:163], v84 offset:9632
    s_waitcnt lgkmcnt(12)
    s_nop 0
    v_mfma_f32_16x16x32_bf16 v[108:111], v[20:23], v[132:135], v[108:111]
    v_mfma_f32_16x16x32_bf16 v[112:115], v[20:23], v[136:139], v[112:115]
    ds_read_b64_tr_b16 v[132:133], v84 offset:10240
    ds_read_b64_tr_b16 v[134:135], v84 offset:10880
    ds_read_b64_tr_b16 v[136:137], v84 offset:10272
    ds_read_b64_tr_b16 v[138:139], v84 offset:10912
    s_waitcnt lgkmcnt(12)
    s_nop 0
    v_mfma_f32_16x16x32_bf16 v[108:111], v[24:27], v[140:143], v[108:111]
    v_mfma_f32_16x16x32_bf16 v[112:115], v[24:27], v[144:147], v[112:115]
    ds_read_b64_tr_b16 v[140:141], v84 offset:11520
    ds_read_b64_tr_b16 v[142:143], v84 offset:12160
    ds_read_b64_tr_b16 v[144:145], v84 offset:11552
    ds_read_b64_tr_b16 v[146:147], v84 offset:12192
    s_waitcnt lgkmcnt(12)
    s_nop 0
    v_mfma_f32_16x16x32_bf16 v[108:111], v[28:31], v[148:151], v[108:111]
    v_mfma_f32_16x16x32_bf16 v[112:115], v[28:31], v[152:155], v[112:115]
    ds_read_b64_tr_b16 v[148:149], v84 offset:12800
    ds_read_b64_tr_b16 v[150:151], v84 offset:13440
    ds_read_b64_tr_b16 v[152:153], v84 offset:12832
    ds_read_b64_tr_b16 v[154:155], v84 offset:13472
    s_waitcnt lgkmcnt(12)
    s_nop 0
    v_mfma_f32_16x16x32_bf16 v[108:111], v[32:35], v[156:159], v[108:111]
    v_mfma_f32_16x16x32_bf16 v[112:115], v[32:35], v[160:163], v[112:115]
    ds_read_b64_tr_b16 v[156:157], v84 offset:14080
    ds_read_b64_tr_b16 v[158:159], v84 offset:14720
    ds_read_b64_tr_b16 v[160:161], v84 offset:14112
    ds_read_b64_tr_b16 v[162:163], v84 offset:14752
    s_waitcnt lgkmcnt(12)
    s_nop 0
    v_mfma_f32_16x16x32_bf16 v[108:111], v[36:39], v[132:135], v[108:111]
    v_mfma_f32_16x16x32_bf16 v[112:115], v[36:39], v[136:139], v[112:115]
    ds_read_b64_tr_b16 v[132:133], v84 offset:15360
    ds_read_b64_tr_b16 v[134:135], v84 offset:16000
    ds_read_b64_tr_b16 v[136:137], v84 offset:15392
    ds_read_b64_tr_b16 v[138:139], v84 offset:16032
    s_waitcnt lgkmcnt(12)
    s_nop 0
    v_mfma_f32_16x16x32_bf16 v[108:111], v[40:43], v[140:143], v[108:111]
    v_mfma_f32_16x16x32_bf16 v[112:115], v[40:43], v[144:147], v[112:115]
    ds_read_b64_tr_b16 v[140:141], v84 offset:16640
    ds_read_b64_tr_b16 v[142:143], v84 offset:17280
    ds_read_b64_tr_b16 v[144:145], v84 offset:16672
    ds_read_b64_tr_b16 v[146:147], v84 offset:17312
    s_waitcnt lgkmcnt(12)
    s_nop 0
    v_mfma_f32_16x16x32_bf16 v[108:111], v[44:47], v[148:151], v[108:111]
    v_mfma_f32_16x16x32_bf16 v[112:115], v[44:47], v[152:155], v[112:115]
    ds_read_b64_tr_b16 v[148:149], v84 offset:17920
    ds_read_b64_tr_b16 v[150:151], v84 offset:18560
    ds_read_b64_tr_b16 v[152:153], v84 offset:17952
    ds_read_b64_tr_b16 v[154:155], v84 offset:18592
    s_waitcnt lgkmcnt(12)
    s_nop 0
    v_mfma_f32_16x16x32_bf16 v[108:111], v[48:51], v[156:159], v[108:111]
    v_mfma_f32_16x16x32_bf16 v[112:115], v[48:51], v[160:163], v[112:115]
    ds_read_b64_tr_b16 v[156:157], v84 offset:19200
    ds_read_b64_tr_b16 v[158:159], v84 offset:19840
    ds_read_b64_tr_b16 v[160:161], v84 offset:19232
    ds_read_b64_tr_b16 v[162:163], v84 offset:19872
    s_waitcnt lgkmcnt(12)
    s_nop 0
    v_mfma_f32_16x16x32_bf16 v[108:111], v[52:55], v[132:135], v[108:111]
    v_mfma_f32_16x16x32_bf16 v[112:115], v[52:55], v[136:139], v[112:115]
    ds_read_b64_tr_b16 v[132:133], v84 offset:20480
    ds_read_b64_tr_b16 v[134:135], v84 offset:21120
    ds_read_b64_tr_b16 v[136:137], v84 offset:20512
    ds_read_b64_tr_b16 v[138:139], v84 offset:21152
    s_waitcnt lgkmcnt(12)
    s_nop 0
    v_mfma_f32_16x16x32_bf16 v[108:111], v[56:59], v[140:143], v[108:111]
    v_mfma_f32_16x16x32_bf16 v[112:115], v[56:59], v[144:147], v[112:115]
    ds_read_b64_tr_b16 v[140:141], v84 offset:21760
    ds_read_b64_tr_b16 v[142:143], v84 offset:22400
    ds_read_b64_tr_b16 v[144:145], v84 offset:21792
    ds_read_b64_tr_b16 v[146:147], v84 offset:22432
    s_waitcnt lgkmcnt(12)
    s_nop 0
    v_mfma_f32_16x16x32_bf16 v[108:111], v[60:63], v[148:151], v[108:111]
    v_mfma_f32_16x16x32_bf16 v[112:115], v[60:63], v[152:155], v[112:115]
    ds_read_b64_tr_b16 v[148:149], v84 offset:23040
    ds_read_b64_tr_b16 v[150:151], v84 offset:23680
    ds_read_b64_tr_b16 v[152:153], v84 offset:23072
    ds_read_b64_tr_b16 v[154:155], v84 offset:23712
    s_waitcnt lgkmcnt(12)
    s_nop 0
    v_mfma_f32_16x16x32_bf16 v[108:111], v[64:67], v[156:159], v[108:111]
    v_mfma_f32_16x16x32_bf16 v[112:115], v[64:67], v[160:163], v[112:115]
    ds_read_b64_tr_b16 v[156:157], v84 offset:24320
    ds_read_b64_tr_b16 v[158:159], v84 offset:24960
    ds_read_b64_tr_b16 v[160:161], v84 offset:24352
    ds_read_b64_tr_b16 v[162:163], v84 offset:24992
    s_waitcnt lgkmcnt(12)
    s_nop 0
    v_mfma_f32_16x16x32_bf16 v[108:111], v[68:71], v[132:135], v[108:111]
    v_mfma_f32_16x16x32_bf16 v[112:115], v[68:71], v[136:139], v[112:115]
    s_waitcnt lgkmcnt(8)
    s_nop 0
    v_mfma_f32_16x16x32_bf16 v[108:111], v[72:75], v[140:143], v[108:111]
    v_mfma_f32_16x16x32_bf16 v[112:115], v[72:75], v[144:147], v[112:115]
    s_waitcnt lgkmcnt(4)
    s_nop 0
    v_mfma_f32_16x16x32_bf16 v[108:111], v[76:79], v[148:151], v[108:111]
    v_mfma_f32_16x16x32_bf16 v[112:115], v[76:79], v[152:155], v[112:115]
    s_waitcnt lgkmcnt(0)
    s_nop 0
    v_mfma_f32_16x16x32_bf16 v[108:111], v[80:83], v[156:159], v[108:111]
    v_mfma_f32_16x16x32_bf16 v[112:115], v[80:83], v[160:163], v[112:115]
    s_nop 6
    s_nop 0
    v_cvt_pk_bf16_f32 v120, v108, v109
    v_cvt_pk_bf16_f32 v121, v110, v111
    v_cvt_pk_bf16_f32 v122, v112, v113
    v_cvt_pk_bf16_f32 v123, v114, v115
    v_cmp_gt_u32 vcc, 4, v1
    s_nop 1
    v_cndmask_b32 v122, 0, v122, vcc
    v_cndmask_b32_e64 v123, 0, v123, vcc
    v_cmp_eq_u32 vcc, 4, v1
    v_mov_b32 v127, 0x3f803f80
    s_nop 0
    v_cndmask_b32 v122, v122, v127, vcc
    v_cndmask_b32 v123, v123, v127, vcc
    s_lshr_b32 s62, s27, 1
    s_mul_i32 s62, s62, 3328
    s_and_b32 s63, s27, 1
    s_lshl_b32 s63, s63, 10
    s_add_u32 s62, s62, s63
    s_add_u32 s62, s62, 1049856
    v_and_b32 v125, 1, v2
    v_lshl_add_u32 v125, v125, 5, v1
    v_lshlrev_b32 v125, 4, v125
    v_lshrrev_b32 v126, 1, v2
    v_lshl_add_u32 v125, v126, 3, v125
    buffer_store_dwordx2 v[120:121], v125, s[4:7], s62 offen sc1
    buffer_store_dwordx2 v[122:123], v125, s[4:7], s62 offen offset:256 sc1
    v_mov_b32 v116, 0
    s_lshl_b32 s62, s22, 2
    s_add_u32 s62, s62, 161024
    v_mov_b32_e64 v118, s62
    ds_write_b32 v118, v116
L_kvpub_21:
    s_waitcnt vmcnt(0) lgkmcnt(0)
    s_barrier
    s_cmp_lg_u32 s22, 0
    s_cbranch_scc1 L_kvnp_22
    v_mov_b32 v118, 161024
    ds_read_b128 v[120:123], v118
    s_waitcnt lgkmcnt(0)
    v_max_f32 v120, v120, v121
    v_max_f32 v122, v122, v123
    v_max_f32 v122, v120, v122
    v_mov_b32 v120, s20
    v_mov_b32 v121, s21
    v_mov_b32 v123, 0
    s_lshl_b32 s62, s24, 1
    s_add_u32 s62, s62, s23
    s_lshl_b32 s62, s62, 7
    s_add_u32 s62, s62, 16384
    v_mov_b32 v118, s62
    s_mov_b64 exec, 1
    buffer_store_dwordx4 v[120:123], v118, s[4:7], 0 offen sc1
    s_mov_b64 exec, -1
L_kvnp_22:
L_kvend_19:
    v_lshrrev_b32 v84, 2, v1
    v_lshl_add_u32 v84, v2, 2, v84
    v_mul_u32_u24 v84, 160, v84
    v_and_b32_e64 v85, 3, v1
    v_lshl_add_u32 v84, v85, 3, v84
    v_add_u32 v85, 51200, v84
    ds_read_b64_tr_b16 v[88:89], v84 offset:0
    ds_read_b64_tr_b16 v[90:91], v84 offset:2560
    ds_read_b64_tr_b16 v[92:93], v84 offset:32
    ds_read_b64_tr_b16 v[94:95], v84 offset:2592
    ds_read_b64_tr_b16 v[96:97], v84 offset:64
    ds_read_b64_tr_b16 v[98:99], v84 offset:2624
    ds_read_b64_tr_b16 v[100:101], v84 offset:96
    ds_read_b64_tr_b16 v[102:103], v84 offset:2656
    ds_read_b64_tr_b16 v[104:105], v84 offset:128
    ds_read_b64_tr_b16 v[106:107], v84 offset:2688
    ds_read_b64_tr_b16 v[108:109], v84 offset:5120
    ds_read_b64_tr_b16 v[110:111], v84 offset:7680
    ds_read_b64_tr_b16 v[112:113], v84 offset:5152
    ds_read_b64_tr_b16 v[114:115], v84 offset:7712
    ds_read_b64_tr_b16 v[116:117], v84 offset:5184
    ds_read_b64_tr_b16 v[118:119], v84 offset:7744
    ds_read_b64_tr_b16 v[120:121], v84 offset:5216
    ds_read_b64_tr_b16 v[122:123], v84 offset:7776
    ds_read_b64_tr_b16 v[124:125], v84 offset:5248
    ds_read_b64_tr_b16 v[126:127], v84 offset:7808
    s_waitcnt lgkmcnt(10)
    s_nop 0
    v_mfma_f32_16x16x32_bf16 v[148:151], v[88:91], v[4:7], 0
    ds_read_b64_tr_b16 v[128:129], v84 offset:10240
    ds_read_b64_tr_b16 v[130:131], v84 offset:12800
    v_mfma_f32_16x16x32_bf16 v[152:155], v[92:95], v[4:7], 0
    ds_read_b64_tr_b16 v[132:133], v84 offset:10272
    ds_read_b64_tr_b16 v[134:135], v84 offset:12832
    v_mfma_f32_16x16x32_bf16 v[156:159], v[96:99], v[4:7], 0
    ds_read_b64_tr_b16 v[136:137], v84 offset:10304
    ds_read_b64_tr_b16 v[138:139], v84 offset:12864
    v_mfma_f32_16x16x32_bf16 v[160:163], v[100:103], v[4:7], 0
    ds_read_b64_tr_b16 v[140:141], v84 offset:10336
    ds_read_b64_tr_b16 v[142:143], v84 offset:12896
    v_mfma_f32_16x16x32_bf16 v[164:167], v[104:107], v[4:7], 0
    ds_read_b64_tr_b16 v[144:145], v84 offset:10368
    ds_read_b64_tr_b16 v[146:147], v84 offset:12928
    s_waitcnt lgkmcnt(10)
    s_nop 0
    v_mfma_f32_16x16x32_bf16 v[148:151], v[108:111], v[8:11], v[148:151]
    ds_read_b64_tr_b16 v[88:89], v84 offset:15360
    ds_read_b64_tr_b16 v[90:91], v84 offset:17920
    v_mfma_f32_16x16x32_bf16 v[152:155], v[112:115], v[8:11], v[152:155]
    ds_read_b64_tr_b16 v[92:93], v84 offset:15392
    ds_read_b64_tr_b16 v[94:95], v84 offset:17952
    v_mfma_f32_16x16x32_bf16 v[156:159], v[116:119], v[8:11], v[156:159]
    ds_read_b64_tr_b16 v[96:97], v84 offset:15424
    ds_read_b64_tr_b16 v[98:99], v84 offset:17984
    v_mfma_f32_16x16x32_bf16 v[160:163], v[120:123], v[8:11], v[160:163]
    ds_read_b64_tr_b16 v[100:101], v84 offset:15456
    ds_read_b64_tr_b16 v[102:103], v84 offset:18016
    v_mfma_f32_16x16x32_bf16 v[164:167], v[124:127], v[8:11], v[164:167]
    ds_read_b64_tr_b16 v[104:105], v84 offset:15488
    ds_read_b64_tr_b16 v[106:107], v84 offset:18048
    s_waitcnt lgkmcnt(10)
    s_nop 0
    v_mfma_f32_16x16x32_bf16 v[148:151], v[128:131], v[12:15], v[148:151]
    ds_read_b64_tr_b16 v[108:109], v84 offset:20480
    ds_read_b64_tr_b16 v[110:111], v84 offset:23040
    v_mfma_f32_16x16x32_bf16 v[152:155], v[132:135], v[12:15], v[152:155]
    ds_read_b64_tr_b16 v[112:113], v84 offset:20512
    ds_read_b64_tr_b16 v[114:115], v84 offset:23072
    v_mfma_f32_16x16x32_bf16 v[156:159], v[136:139], v[12:15], v[156:159]
    ds_read_b64_tr_b16 v[116:117], v84 offset:20544
    ds_read_b64_tr_b16 v[118:119], v84 offset:23104
    v_mfma_f32_16x16x32_bf16 v[160:163], v[140:143], v[12:15], v[160:163]
    ds_read_b64_tr_b16 v[120:121], v84 offset:20576
    ds_read_b64_tr_b16 v[122:123], v84 offset:23136
    v_mfma_f32_16x16x32_bf16 v[164:167], v[144:147], v[12:15], v[164:167]
    ds_read_b64_tr_b16 v[124:125], v84 offset:20608
    ds_read_b64_tr_b16 v[126:127], v84 offset:23168
    s_waitcnt lgkmcnt(10)
    s_nop 0
    v_mfma_f32_16x16x32_bf16 v[148:151], v[88:91], v[16:19], v[148:151]
    ds_read_b64_tr_b16 v[128:129], v84 offset:25600
    ds_read_b64_tr_b16 v[130:131], v84 offset:28160
    v_mfma_f32_16x16x32_bf16 v[152:155], v[92:95], v[16:19], v[152:155]
    ds_read_b64_tr_b16 v[132:133], v84 offset:25632
    ds_read_b64_tr_b16 v[134:135], v84 offset:28192
    v_mfma_f32_16x16x32_bf16 v[156:159], v[96:99], v[16:19], v[156:159]
    ds_read_b64_tr_b16 v[136:137], v84 offset:25664
    ds_read_b64_tr_b16 v[138:139], v84 offset:28224
    v_mfma_f32_16x16x32_bf16 v[160:163], v[100:103], v[16:19], v[160:163]
    ds_read_b64_tr_b16 v[140:141], v84 offset:25696
    ds_read_b64_tr_b16 v[142:143], v84 offset:28256
    v_mfma_f32_16x16x32_bf16 v[164:167], v[104:107], v[16:19], v[164:167]
    ds_read_b64_tr_b16 v[144:145], v84 offset:25728
    ds_read_b64_tr_b16 v[146:147], v84 offset:28288
    s_waitcnt lgkmcnt(10)
    s_nop 0
    v_mfma_f32_16x16x32_bf16 v[148:151], v[108:111], v[20:23], v[148:151]
    ds_read_b64_tr_b16 v[88:89], v84 offset:30720
    ds_read_b64_tr_b16 v[90:91], v84 offset:33280
    v_mfma_f32_16x16x32_bf16 v[152:155], v[112:115], v[20:23], v[152:155]
    ds_read_b64_tr_b16 v[92:93], v84 offset:30752
    ds_read_b64_tr_b16 v[94:95], v84 offset:33312
    v_mfma_f32_16x16x32_bf16 v[156:159], v[116:119], v[20:23], v[156:159]
    ds_read_b64_tr_b16 v[96:97], v84 offset:30784
    ds_read_b64_tr_b16 v[98:99], v84 offset:33344
    v_mfma_f32_16x16x32_bf16 v[160:163], v[120:123], v[20:23], v[160:163]
    ds_read_b64_tr_b16 v[100:101], v84 offset:30816
    ds_read_b64_tr_b16 v[102:103], v84 offset:33376
    v_mfma_f32_16x16x32_bf16 v[164:167], v[124:127], v[20:23], v[164:167]
    ds_read_b64_tr_b16 v[104:105], v84 offset:30848
    ds_read_b64_tr_b16 v[106:107], v84 offset:33408
    s_waitcnt lgkmcnt(10)
    s_nop 0
    v_mfma_f32_16x16x32_bf16 v[148:151], v[128:131], v[24:27], v[148:151]
    ds_read_b64_tr_b16 v[108:109], v84 offset:35840
    ds_read_b64_tr_b16 v[110:111], v84 offset:38400
    v_mfma_f32_16x16x32_bf16 v[152:155], v[132:135], v[24:27], v[152:155]
    ds_read_b64_tr_b16 v[112:113], v84 offset:35872
    ds_read_b64_tr_b16 v[114:115], v84 offset:38432
    v_mfma_f32_16x16x32_bf16 v[156:159], v[136:139], v[24:27], v[156:159]
    ds_read_b64_tr_b16 v[116:117], v84 offset:35904
    ds_read_b64_tr_b16 v[118:119], v84 offset:38464
    v_mfma_f32_16x16x32_bf16 v[160:163], v[140:143], v[24:27], v[160:163]
    ds_read_b64_tr_b16 v[120:121], v84 offset:35936
    ds_read_b64_tr_b16 v[122:123], v84 offset:38496
    v_mfma_f32_16x16x32_bf16 v[164:167], v[144:147], v[24:27], v[164:167]
    ds_read_b64_tr_b16 v[124:125], v84 offset:35968
    ds_read_b64_tr_b16 v[126:127], v84 offset:38528
    s_waitcnt lgkmcnt(10)
    s_nop 0
    v_mfma_f32_16x16x32_bf16 v[148:151], v[88:91], v[28:31], v[148:151]
    ds_read_b64_tr_b16 v[128:129], v84 offset:40960
    ds_read_b64_tr_b16 v[130:131], v84 offset:43520
    v_mfma_f32_16x16x32_bf16 v[152:155], v[92:95], v[28:31], v[152:155]
    ds_read_b64_tr_b16 v[132:133], v84 offset:40992
    ds_read_b64_tr_b16 v[134:135], v84 offset:43552
    v_mfma_f32_16x16x32_bf16 v[156:159], v[96:99], v[28:31], v[156:159]
    ds_read_b64_tr_b16 v[136:137], v84 offset:41024
    ds_read_b64_tr_b16 v[138:139], v84 offset:43584
    v_mfma_f32_16x16x32_bf16 v[160:163], v[100:103], v[28:31], v[160:163]
    ds_read_b64_tr_b16 v[140:141], v84 offset:41056
    ds_read_b64_tr_b16 v[142:143], v84 offset:43616
    v_mfma_f32_16x16x32_bf16 v[164:167], v[104:107], v[28:31], v[164:167]
    ds_read_b64_tr_b16 v[144:145], v84 offset:41088
    ds_read_b64_tr_b16 v[146:147], v84 offset:43648
    s_waitcnt lgkmcnt(10)
    s_nop 0
    v_mfma_f32_16x16x32_bf16 v[148:151], v[108:111], v[32:35], v[148:151]
    ds_read_b64_tr_b16 v[88:89], v84 offset:46080
    ds_read_b64_tr_b16 v[90:91], v84 offset:48640
    v_mfma_f32_16x16x32_bf16 v[152:155], v[112:115], v[32:35], v[152:155]
    ds_read_b64_tr_b16 v[92:93], v84 offset:46112
    ds_read_b64_tr_b16 v[94:95], v84 offset:48672
    v_mfma_f32_16x16x32_bf16 v[156:159], v[116:119], v[32:35], v[156:159]
    ds_read_b64_tr_b16 v[96:97], v84 offset:46144
    ds_read_b64_tr_b16 v[98:99], v84 offset:48704
    v_mfma_f32_16x16x32_bf16 v[160:163], v[120:123], v[32:35], v[160:163]
    ds_read_b64_tr_b16 v[100:101], v84 offset:46176
    ds_read_b64_tr_b16 v[102:103], v84 offset:48736
    v_mfma_f32_16x16x32_bf16 v[164:167], v[124:127], v[32:35], v[164:167]
    ds_read_b64_tr_b16 v[104:105], v84 offset:46208
    ds_read_b64_tr_b16 v[106:107], v84 offset:48768
    s_waitcnt lgkmcnt(10)
    s_nop 0
    v_mfma_f32_16x16x32_bf16 v[148:151], v[128:131], v[36:39], v[148:151]
    ds_read_b64_tr_b16 v[108:109], v85 offset:0
    ds_read_b64_tr_b16 v[110:111], v85 offset:2560
    v_mfma_f32_16x16x32_bf16 v[152:155], v[132:135], v[36:39], v[152:155]
    ds_read_b64_tr_b16 v[112:113], v85 offset:32
    ds_read_b64_tr_b16 v[114:115], v85 offset:2592
    v_mfma_f32_16x16x32_bf16 v[156:159], v[136:139], v[36:39], v[156:159]
    ds_read_b64_tr_b16 v[116:117], v85 offset:64
    ds_read_b64_tr_b16 v[118:119], v85 offset:2624
    v_mfma_f32_16x16x32_bf16 v[160:163], v[140:143], v[36:39], v[160:163]
    ds_read_b64_tr_b16 v[120:121], v85 offset:96
    ds_read_b64_tr_b16 v[122:123], v85 offset:2656
    v_mfma_f32_16x16x32_bf16 v[164:167], v[144:147], v[36:39], v[164:167]
    ds_read_b64_tr_b16 v[124:125], v85 offset:128
    ds_read_b64_tr_b16 v[126:127], v85 offset:2688
    s_waitcnt lgkmcnt(10)
    s_nop 0
    v_mfma_f32_16x16x32_bf16 v[148:151], v[88:91], v[40:43], v[148:151]
    ds_read_b64_tr_b16 v[128:129], v85 offset:5120
    ds_read_b64_tr_b16 v[130:131], v85 offset:7680
    v_mfma_f32_16x16x32_bf16 v[152:155], v[92:95], v[40:43], v[152:155]
    ds_read_b64_tr_b16 v[132:133], v85 offset:5152
    ds_read_b64_tr_b16 v[134:135], v85 offset:7712
    v_mfma_f32_16x16x32_bf16 v[156:159], v[96:99], v[40:43], v[156:159]
    ds_read_b64_tr_b16 v[136:137], v85 offset:5184
    ds_read_b64_tr_b16 v[138:139], v85 offset:7744
    v_mfma_f32_16x16x32_bf16 v[160:163], v[100:103], v[40:43], v[160:163]
    ds_read_b64_tr_b16 v[140:141], v85 offset:5216
    ds_read_b64_tr_b16 v[142:143], v85 offset:7776
    v_mfma_f32_16x16x32_bf16 v[164:167], v[104:107], v[40:43], v[164:167]
    ds_read_b64_tr_b16 v[144:145], v85 offset:5248
    ds_read_b64_tr_b16 v[146:147], v85 offset:7808
    s_waitcnt lgkmcnt(10)
    s_nop 0
    v_mfma_f32_16x16x32_bf16 v[148:151], v[108:111], v[44:47], v[148:151]
    ds_read_b64_tr_b16 v[88:89], v85 offset:10240
    ds_read_b64_tr_b16 v[90:91], v85 offset:12800
    v_mfma_f32_16x16x32_bf16 v[152:155], v[112:115], v[44:47], v[152:155]
    ds_read_b64_tr_b16 v[92:93], v85 offset:10272
    ds_read_b64_tr_b16 v[94:95], v85 offset:12832
    v_mfma_f32_16x16x32_bf16 v[156:159], v[116:119], v[44:47], v[156:159]
    ds_read_b64_tr_b16 v[96:97], v85 offset:10304
    ds_read_b64_tr_b16 v[98:99], v85 offset:12864
    v_mfma_f32_16x16x32_bf16 v[160:163], v[120:123], v[44:47], v[160:163]
    ds_read_b64_tr_b16 v[100:101], v85 offset:10336
    ds_read_b64_tr_b16 v[102:103], v85 offset:12896
    v_mfma_f32_16x16x32_bf16 v[164:167], v[124:127], v[44:47], v[164:167]
    ds_read_b64_tr_b16 v[104:105], v85 offset:10368
    ds_read_b64_tr_b16 v[106:107], v85 offset:12928
    s_waitcnt lgkmcnt(10)
    s_nop 0
    v_mfma_f32_16x16x32_bf16 v[148:151], v[128:131], v[48:51], v[148:151]
    ds_read_b64_tr_b16 v[108:109], v85 offset:15360
    ds_read_b64_tr_b16 v[110:111], v85 offset:17920
    v_mfma_f32_16x16x32_bf16 v[152:155], v[132:135], v[48:51], v[152:155]
    ds_read_b64_tr_b16 v[112:113], v85 offset:15392
    ds_read_b64_tr_b16 v[114:115], v85 offset:17952
    v_mfma_f32_16x16x32_bf16 v[156:159], v[136:139], v[48:51], v[156:159]
    ds_read_b64_tr_b16 v[116:117], v85 offset:15424
    ds_read_b64_tr_b16 v[118:119], v85 offset:17984
    v_mfma_f32_16x16x32_bf16 v[160:163], v[140:143], v[48:51], v[160:163]
    ds_read_b64_tr_b16 v[120:121], v85 offset:15456
    ds_read_b64_tr_b16 v[122:123], v85 offset:18016
    v_mfma_f32_16x16x32_bf16 v[164:167], v[144:147], v[48:51], v[164:167]
    ds_read_b64_tr_b16 v[124:125], v85 offset:15488
    ds_read_b64_tr_b16 v[126:127], v85 offset:18048
    s_waitcnt lgkmcnt(10)
    s_nop 0
    v_mfma_f32_16x16x32_bf16 v[148:151], v[88:91], v[52:55], v[148:151]
    ds_read_b64_tr_b16 v[128:129], v85 offset:20480
    ds_read_b64_tr_b16 v[130:131], v85 offset:23040
    v_mfma_f32_16x16x32_bf16 v[152:155], v[92:95], v[52:55], v[152:155]
    ds_read_b64_tr_b16 v[132:133], v85 offset:20512
    ds_read_b64_tr_b16 v[134:135], v85 offset:23072
    v_mfma_f32_16x16x32_bf16 v[156:159], v[96:99], v[52:55], v[156:159]
    ds_read_b64_tr_b16 v[136:137], v85 offset:20544
    ds_read_b64_tr_b16 v[138:139], v85 offset:23104
    v_mfma_f32_16x16x32_bf16 v[160:163], v[100:103], v[52:55], v[160:163]
    ds_read_b64_tr_b16 v[140:141], v85 offset:20576
    ds_read_b64_tr_b16 v[142:143], v85 offset:23136
    v_mfma_f32_16x16x32_bf16 v[164:167], v[104:107], v[52:55], v[164:167]
    ds_read_b64_tr_b16 v[144:145], v85 offset:20608
    ds_read_b64_tr_b16 v[146:147], v85 offset:23168
    s_waitcnt lgkmcnt(10)
    s_nop 0
    v_mfma_f32_16x16x32_bf16 v[148:151], v[108:111], v[56:59], v[148:151]
    ds_read_b64_tr_b16 v[88:89], v85 offset:25600
    ds_read_b64_tr_b16 v[90:91], v85 offset:28160
    v_mfma_f32_16x16x32_bf16 v[152:155], v[112:115], v[56:59], v[152:155]
    ds_read_b64_tr_b16 v[92:93], v85 offset:25632
    ds_read_b64_tr_b16 v[94:95], v85 offset:28192
    v_mfma_f32_16x16x32_bf16 v[156:159], v[116:119], v[56:59], v[156:159]
    ds_read_b64_tr_b16 v[96:97], v85 offset:25664
    ds_read_b64_tr_b16 v[98:99], v85 offset:28224
    v_mfma_f32_16x16x32_bf16 v[160:163], v[120:123], v[56:59], v[160:163]
    ds_read_b64_tr_b16 v[100:101], v85 offset:25696
    ds_read_b64_tr_b16 v[102:103], v85 offset:28256
    v_mfma_f32_16x16x32_bf16 v[164:167], v[124:127], v[56:59], v[164:167]
    ds_read_b64_tr_b16 v[104:105], v85 offset:25728
    ds_read_b64_tr_b16 v[106:107], v85 offset:28288
    s_waitcnt lgkmcnt(10)
    s_nop 0
    v_mfma_f32_16x16x32_bf16 v[148:151], v[128:131], v[60:63], v[148:151]
    ds_read_b64_tr_b16 v[108:109], v85 offset:30720
    ds_read_b64_tr_b16 v[110:111], v85 offset:33280
    v_mfma_f32_16x16x32_bf16 v[152:155], v[132:135], v[60:63], v[152:155]
    ds_read_b64_tr_b16 v[112:113], v85 offset:30752
    ds_read_b64_tr_b16 v[114:115], v85 offset:33312
    v_mfma_f32_16x16x32_bf16 v[156:159], v[136:139], v[60:63], v[156:159]
    ds_read_b64_tr_b16 v[116:117], v85 offset:30784
    ds_read_b64_tr_b16 v[118:119], v85 offset:33344
    v_mfma_f32_16x16x32_bf16 v[160:163], v[140:143], v[60:63], v[160:163]
    ds_read_b64_tr_b16 v[120:121], v85 offset:30816
    ds_read_b64_tr_b16 v[122:123], v85 offset:33376
    v_mfma_f32_16x16x32_bf16 v[164:167], v[144:147], v[60:63], v[164:167]
    ds_read_b64_tr_b16 v[124:125], v85 offset:30848
    ds_read_b64_tr_b16 v[126:127], v85 offset:33408
    s_waitcnt lgkmcnt(10)
    s_nop 0
    v_mfma_f32_16x16x32_bf16 v[148:151], v[88:91], v[64:67], v[148:151]
    ds_read_b64_tr_b16 v[128:129], v85 offset:35840
    ds_read_b64_tr_b16 v[130:131], v85 offset:38400
    v_mfma_f32_16x16x32_bf16 v[152:155], v[92:95], v[64:67], v[152:155]
    ds_read_b64_tr_b16 v[132:133], v85 offset:35872
    ds_read_b64_tr_b16 v[134:135], v85 offset:38432
    v_mfma_f32_16x16x32_bf16 v[156:159], v[96:99], v[64:67], v[156:159]
    ds_read_b64_tr_b16 v[136:137], v85 offset:35904
    ds_read_b64_tr_b16 v[138:139], v85 offset:38464
    v_mfma_f32_16x16x32_bf16 v[160:163], v[100:103], v[64:67], v[160:163]
    ds_read_b64_tr_b16 v[140:141], v85 offset:35936
    ds_read_b64_tr_b16 v[142:143], v85 offset:38496
    v_mfma_f32_16x16x32_bf16 v[164:167], v[104:107], v[64:67], v[164:167]
    ds_read_b64_tr_b16 v[144:145], v85 offset:35968
    ds_read_b64_tr_b16 v[146:147], v85 offset:38528
    s_waitcnt lgkmcnt(10)
    s_nop 0
    v_mfma_f32_16x16x32_bf16 v[148:151], v[108:111], v[68:71], v[148:151]
    ds_read_b64_tr_b16 v[88:89], v85 offset:40960
    ds_read_b64_tr_b16 v[90:91], v85 offset:43520
    v_mfma_f32_16x16x32_bf16 v[152:155], v[112:115], v[68:71], v[152:155]
    ds_read_b64_tr_b16 v[92:93], v85 offset:40992
    ds_read_b64_tr_b16 v[94:95], v85 offset:43552
    v_mfma_f32_16x16x32_bf16 v[156:159], v[116:119], v[68:71], v[156:159]
    ds_read_b64_tr_b16 v[96:97], v85 offset:41024
    ds_read_b64_tr_b16 v[98:99], v85 offset:43584
    v_mfma_f32_16x16x32_bf16 v[160:163], v[120:123], v[68:71], v[160:163]
    ds_read_b64_tr_b16 v[100:101], v85 offset:41056
    ds_read_b64_tr_b16 v[102:103], v85 offset:43616
    v_mfma_f32_16x16x32_bf16 v[164:167], v[124:127], v[68:71], v[164:167]
    ds_read_b64_tr_b16 v[104:105], v85 offset:41088
    ds_read_b64_tr_b16 v[106:107], v85 offset:43648
    s_waitcnt lgkmcnt(10)
    s_nop 0
    v_mfma_f32_16x16x32_bf16 v[148:151], v[128:131], v[72:75], v[148:151]
    ds_read_b64_tr_b16 v[108:109], v85 offset:46080
    ds_read_b64_tr_b16 v[110:111], v85 offset:48640
    v_mfma_f32_16x16x32_bf16 v[152:155], v[132:135], v[72:75], v[152:155]
    ds_read_b64_tr_b16 v[112:113], v85 offset:46112
    ds_read_b64_tr_b16 v[114:115], v85 offset:48672
    v_mfma_f32_16x16x32_bf16 v[156:159], v[136:139], v[72:75], v[156:159]
    ds_read_b64_tr_b16 v[116:117], v85 offset:46144
    ds_read_b64_tr_b16 v[118:119], v85 offset:48704
    v_mfma_f32_16x16x32_bf16 v[160:163], v[140:143], v[72:75], v[160:163]
    ds_read_b64_tr_b16 v[120:121], v85 offset:46176
    ds_read_b64_tr_b16 v[122:123], v85 offset:48736
    v_mfma_f32_16x16x32_bf16 v[164:167], v[144:147], v[72:75], v[164:167]
    ds_read_b64_tr_b16 v[124:125], v85 offset:46208
    ds_read_b64_tr_b16 v[126:127], v85 offset:48768
    s_waitcnt lgkmcnt(10)
    s_nop 0
    v_mfma_f32_16x16x32_bf16 v[148:151], v[88:91], v[76:79], v[148:151]
    v_mfma_f32_16x16x32_bf16 v[152:155], v[92:95], v[76:79], v[152:155]
    v_mfma_f32_16x16x32_bf16 v[156:159], v[96:99], v[76:79], v[156:159]
    v_mfma_f32_16x16x32_bf16 v[160:163], v[100:103], v[76:79], v[160:163]
    v_mfma_f32_16x16x32_bf16 v[164:167], v[104:107], v[76:79], v[164:167]
    s_waitcnt lgkmcnt(0)
    s_nop 0
    v_mfma_f32_16x16x32_bf16 v[148:151], v[108:111], v[80:83], v[148:151]
    v_mfma_f32_16x16x32_bf16 v[152:155], v[112:115], v[80:83], v[152:155]
    v_mfma_f32_16x16x32_bf16 v[156:159], v[116:119], v[80:83], v[156:159]
    v_mfma_f32_16x16x32_bf16 v[160:163], v[120:123], v[80:83], v[160:163]
    v_mfma_f32_16x16x32_bf16 v[164:167], v[124:127], v[80:83], v[164:167]
    s_mov_b32 s62, 0x3ea52b5c
    s_mul_i32 s63, s22, 2816
    s_add_u32 s63, s63, 149760
    v_mul_u32_u24 v84, 176, v1
    v_lshl_add_u32 v84, v2, 3, v84
    v_add_u32 v84, s63, v84
    v_mul_f32 v148, s62, v148
    v_mul_f32 v149, s62, v149
    v_mul_f32 v150, s62, v150
    v_mul_f32_e64 v151, s62, v151
    v_cvt_pk_bf16_f32 v148, v148, v149
    v_cvt_pk_bf16_f32 v149, v150, v151
    ds_write_b64 v84, v[148:149] offset:0
    v_mul_f32 v152, s62, v152
    v_mul_f32 v153, s62, v153
    v_mul_f32 v154, s62, v154
    v_mul_f32 v155, s62, v155
    v_cvt_pk_bf16_f32 v152, v152, v153
    v_cvt_pk_bf16_f32 v153, v154, v155
    ds_write_b64 v84, v[152:153] offset:32
    v_mul_f32 v156, s62, v156
    v_mul_f32 v157, s62, v157
    v_mul_f32 v158, s62, v158
    v_mul_f32 v159, s62, v159
    v_cvt_pk_bf16_f32 v156, v156, v157
    v_cvt_pk_bf16_f32 v157, v158, v159
    ds_write_b64 v84, v[156:157] offset:64
    v_mul_f32 v160, s62, v160
    v_mul_f32 v161, s62, v161
    v_mul_f32 v162, s62, v162
    v_mul_f32 v163, s62, v163
    v_cvt_pk_bf16_f32 v160, v160, v161
    v_cvt_pk_bf16_f32 v161, v162, v163
    ds_write_b64 v84, v[160:161] offset:96
    v_mul_f32 v164, s62, v164
    v_mul_f32 v165, s62, v165
    v_mul_f32 v166, s62, v166
    v_mul_f32 v167, s62, v167
    v_cvt_pk_bf16_f32 v164, v164, v165
    v_cvt_pk_bf16_f32 v165, v166, v167
    ds_write_b64 v84, v[164:165] offset:128
    v_mul_u32_u24 v85, 176, v1
    v_bfe_u32 v84, v0, 4, 1
    v_mul_u32_u24 v84, 40, v84
    v_add_u32 v85, v85, v84
    v_add_u32 v85, s63, v85
    v_lshrrev_b32 v84, 5, v0
    v_lshl_add_u32 v84, v84, 4, v85
    s_waitcnt lgkmcnt(0)
    s_nop 0
    ds_read_b64 v[44:45], v84
    ds_read_b64 v[46:47], v84 offset:8
    ds_read_b64 v[52:53], v84 offset:80
    ds_read_b64 v[54:55], v84 offset:88
    ds_read_b64 v[48:49], v85 offset:32
    ds_read_b64 v[56:57], v85 offset:112
    v_cmp_gt_u32 vcc, 32, v0
    s_waitcnt lgkmcnt(0)
    s_nop 0
    v_cndmask_b32 v48, 0, v48, vcc
    v_cndmask_b32 v49, 0, v49, vcc
    v_cndmask_b32 v56, 0, v56, vcc
    v_cndmask_b32 v57, 0, v57, vcc
    v_mov_b32 v204, 0
    v_dot2_f32_bf16 v204, v44, v44, v204
    v_dot2_f32_bf16 v204, v45, v45, v204
    v_dot2_f32_bf16 v204, v46, v46, v204
    v_dot2_f32_bf16 v204, v47, v47, v204
    v_dot2_f32_bf16 v204, v48, v48, v204
    v_dot2_f32_bf16 v204, v49, v49, v204
    v_mov_b32_e64 v205, 0
    v_dot2_f32_bf16 v205, v52, v52, v205
    v_dot2_f32_bf16 v205, v53, v53, v205
    v_dot2_f32_bf16 v205, v54, v54, v205
    v_dot2_f32_bf16 v205, v55, v55, v205
    v_dot2_f32_bf16 v205, v56, v56, v205
    v_dot2_f32_bf16 v205, v57, v57, v205
    v_mov_b32 v206, v204
    s_nop 1
    v_permlane32_swap_b32 v204, v206
    v_add_f32 v204, v204, v206
    v_mov_b32 v206, v205
    s_nop 1
    v_permlane32_swap_b32 v205, v206
    v_add_f32 v205, v205, v206
    v_max_f32 v204, v204, v205
    s_barrier
    v_lshlrev_b32_e64 v207, 7, v0
    s_mov_b32 s62, 400000
    s_mov_b32 s63, 16384
L_kvw_23:
    buffer_load_dwordx4 v[208:211], v207, s[4:7], s63 offen sc1
    s_waitcnt vmcnt(0)
    v_cmp_ne_u32 vcc, s20, v208
    s_mov_b64 s[64:65], vcc
    v_cmp_ne_u32 vcc, s21, v209
    s_or_b64 s[64:65], s[64:65], vcc
    s_cmp_eq_u64 s[64:65], 0
    s_cbranch_scc1 L_kvok_24
    s_sub_u32 s62, s62, 1
    s_cmp_lg_u32 s62, 0
    s_cbranch_scc1 L_kvw_23
    s_mov_b32 s28, 3
    s_branch L_fail
L_kvok_24:
    v_mov_b32 v206, v210
    s_nop 1
    v_permlane16_swap_b32 v210, v206
    v_max_f32 v210, v210, v206
    v_mov_b32 v206, v210
    s_nop 1
    v_permlane32_swap_b32 v210, v206
    v_max_f32_e64 v210, v210, v206
    s_nop 1
    v_mov_b32_dpp v206, v210 row_ror:8 row_mask:0xf bank_mask:0xf
    v_max_f32 v210, v210, v206
    s_nop 1
    v_mov_b32_dpp v206, v210 row_ror:4 row_mask:0xf bank_mask:0xf
    v_max_f32 v210, v210, v206
    s_nop 1
    v_mov_b32_dpp v206, v210 row_ror:2 row_mask:0xf bank_mask:0xf
    v_max_f32 v210, v210, v206
    s_nop 1
    v_mov_b32_dpp v206, v210 row_ror:1 row_mask:0xf bank_mask:0xf
    v_max_f32 v210, v210, v206
    v_mov_b32 v205, v210
    s_cmp_lg_u32 s22, 0
    s_cbranch_scc1 L_xp_25
    s_getreg_b32 s62, hwreg(HW_REG_XCC_ID)
    s_and_b32 s62, s62, 15
    v_mov_b32 v252, s62
    v_mov_b32 v253, 0
    v_mov_b32 v254, s20
    v_mov_b32_e64 v255, s21
    s_lshl_b32 s62, s24, 7
    s_lshl_b32 s63, s23, 4
    s_add_u32 s62, s62, s63
    s_add_u32 s62, s62, 27066368
    v_mov_b32 v251, s62
    s_mov_b64 exec, 1
    buffer_store_dwordx4 v[252:255], v251, s[4:7], 0 offen sc1
    s_mov_b64 exec, -1
L_xp_25:
    s_cmp_lg_u32 s80, 2
    s_cbranch_scc1 L_dg_26
    s_nop 0
    v_accvgpr_read_b32 v248, a250
    v_accvgpr_read_b32 v249, a251
    s_waitcnt vmcnt(63)
    v_lshlrev_b32 v250, 16, v248
    v_and_b32 v251, 0xffff0000, v248
    v_lshlrev_b32_e64 v252, 16, v249
    v_and_b32 v253, 0xffff0000, v249
    v_mul_f32 v247, 0xbfb8aa3b, v250
    v_exp_f32 v247, v247
    s_nop 0
    v_add_f32 v247, 1.0, v247
    v_rcp_f32 v247, v247
    s_nop 0
    v_mul_f32 v250, v250, v247
    v_mul_f32 v247, 0xbfb8aa3b, v251
    v_exp_f32 v247, v247
    s_nop 0
    v_add_f32 v247, 1.0, v247
    v_rcp_f32 v247, v247
    s_nop 0
    v_mul_f32 v251, v251, v247
    v_mul_f32 v247, 0xbfb8aa3b, v252
    v_exp_f32 v247, v247
    s_nop 0
    v_add_f32 v247, 1.0, v247
    v_rcp_f32 v247, v247
    s_nop 0
    v_mul_f32 v252, v252, v247
    v_mul_f32 v247, 0xbfb8aa3b, v253
    v_exp_f32 v247, v247
    s_nop 0
    v_add_f32 v247, 1.0, v247
    v_rcp_f32 v247, v247
    s_nop 0
    v_mul_f32 v253, v253, v247
    v_cvt_pk_bf16_f32 v248, v250, v251
    v_cvt_pk_bf16_f32 v249, v252, v253
    s_mul_i32 s66, s22, 320
    s_add_u32 s66, s66, 143360
    v_lshlrev_b32 v246, 3, v0
    v_add_u32 v246, s66, v246
    s_mov_b32 exec_hi, 0xff
    ds_write_b64 v246, v[248:249]
    s_mov_b32 exec_hi, -1
    v_lshrrev_b32 v60, 2, v1
    v_lshl_add_u32 v60, v2, 2, v60
    v_lshlrev_b32 v60, 6, v60
    v_and_b32 v61, 3, v1
    v_lshl_add_u32 v60, v61, 3, v60
    s_mul_i32 s62, s22, 10240
    s_add_u32 s62, s62, 102400
    v_add_u32 v60, s62, v60
    v_lshlrev_b32 v61, 3, v2
    v_add_u32 v61, s66, v61
    s_waitcnt vmcnt(63) lgkmcnt(0)
    ds_read_b64 v[104:105], v61 offset:0
    ds_read_b64 v[106:107], v61 offset:32
    ds_read_b64 v[108:109], v61 offset:64
    ds_read_b64 v[110:111], v61 offset:96
    ds_read_b64 v[112:113], v61 offset:128
    ds_read_b64 v[114:115], v61 offset:160
    ds_read_b64 v[116:117], v61 offset:192
    ds_read_b64 v[118:119], v61 offset:224
    ds_read_b64 v[120:121], v61 offset:256
    ds_read_b64 v[122:123], v61 offset:288
    ds_read_b64_tr_b16 v[64:65], v60 offset:0
    ds_read_b64_tr_b16 v[66:67], v60 offset:1024
    ds_read_b64_tr_b16 v[68:69], v60 offset:32
    ds_read_b64_tr_b16 v[70:71], v60 offset:1056
    ds_read_b64_tr_b16 v[72:73], v60 offset:2048
    ds_read_b64_tr_b16 v[74:75], v60 offset:3072
    ds_read_b64_tr_b16 v[76:77], v60 offset:2080
    ds_read_b64_tr_b16 v[78:79], v60 offset:3104
    ds_read_b64_tr_b16 v[80:81], v60 offset:4096
    ds_read_b64_tr_b16 v[82:83], v60 offset:5120
    ds_read_b64_tr_b16 v[84:85], v60 offset:4128
    ds_read_b64_tr_b16 v[86:87], v60 offset:5152
    ds_read_b64_tr_b16 v[88:89], v60 offset:6144
    ds_read_b64_tr_b16 v[90:91], v60 offset:7168
    ds_read_b64_tr_b16 v[92:93], v60 offset:6176
    ds_read_b64_tr_b16 v[94:95], v60 offset:7200
    ds_read_b64_tr_b16 v[96:97], v60 offset:8192
    ds_read_b64_tr_b16 v[98:99], v60 offset:9216
    ds_read_b64_tr_b16 v[100:101], v60 offset:8224
    ds_read_b64_tr_b16 v[102:103], v60 offset:9248
    s_waitcnt lgkmcnt(0)
    s_nop 0
    v_mfma_f32_16x16x32_bf16 v[124:127], v[64:67], v[104:107], 0
    v_mfma_f32_16x16x32_bf16 v[128:131], v[68:71], v[104:107], 0
    v_mfma_f32_16x16x32_bf16 v[124:127], v[72:75], v[108:111], v[124:127]
    v_mfma_f32_16x16x32_bf16 v[128:131], v[76:79], v[108:111], v[128:131]
    v_mfma_f32_16x16x32_bf16 v[124:127], v[80:83], v[112:115], v[124:127]
    v_mfma_f32_16x16x32_bf16 v[128:131], v[84:87], v[112:115], v[128:131]
    v_mfma_f32_16x16x32_bf16 v[124:127], v[88:91], v[116:119], v[124:127]
    v_mfma_f32_16x16x32_bf16 v[128:131], v[92:95], v[116:119], v[128:131]
    v_mfma_f32_16x16x32_bf16 v[124:127], v[96:99], v[120:123], v[124:127]
    v_mfma_f32_16x16x32_bf16 v[128:131], v[100:103], v[120:123], v[128:131]
    s_lshl_b32 s62, s22, 7
    s_add_u32 s62, s62, 161088
    v_lshlrev_b32 v60, 4, v2
    v_add_u32 v60, s62, v60
    v_cmp_eq_u32 vcc, 0, v1
    s_and_saveexec_b64 s[66:67], vcc
    s_nop 0
    ds_write_b128 v60, v[124:127]
    ds_write_b128 v60, v[128:131] offset:64
    s_mov_b64 exec, s[66:67]
    s_waitcnt lgkmcnt(0)
    s_barrier
    s_cmp_lg_u32 s22, 0
    s_cbranch_scc1 L_gd_27
    v_lshlrev_b32 v60, 4, v0
    v_and_b32 v60, 0x7f, v60
    v_add_u32 v60, 161088, v60
    ds_read_b128 v[64:67], v60
    ds_read_b128 v[68:71], v60 offset:128
    ds_read_b128 v[72:75], v60 offset:256
    ds_read_b128 v[76:79], v60 offset:384
    s_waitcnt lgkmcnt(0)
    v_add_f32 v64, v64, v68
    v_add_f32 v72, v72, v76
    v_add_f32 v64, v64, v72
    v_add_f32 v65, v65, v69
    v_add_f32 v73, v73, v77
    v_add_f32 v65, v65, v73
    v_add_f32 v66, v66, v70
    v_add_f32 v74, v74, v78
    v_add_f32 v66, v66, v74
    v_add_f32 v67, v67, v71
    v_add_f32 v75, v75, v79
    v_add_f32_e64 v67, v67, v75
    v_cvt_pk_bf16_f32 v128, v64, v65
    v_cvt_pk_bf16_f32 v129, v66, v67
    v_mov_b32 v130, s20
    v_mov_b32_e64 v131, s21
    s_lshl_b32 s62, s81, 7
    s_mov_b64 exec, 0xff
    buffer_store_dwordx4 v[128:131], v3, s[4:7], s62 offen offset:0 sc1
    s_mov_b64 exec, -1
L_gd_27:
    s_barrier
L_dg_26:
    v_mul_f32 v204, v204, v205
    v_and_b32 v206, 31, v0
    v_lshlrev_b32_e64 v206, 3, v206
    s_mov_b32 s65, 0x45800000
    v_cmp_nge_f32 vcc, s65, v204
    s_cmp_lg_u64 vcc, 0
    s_cselect_b32 s77, 1, 0
    v_mov_b32 v108, 0
    v_mov_b32 v124, 0
    v_mov_b32 v109, 0
    v_mov_b32 v125, 0
    v_mov_b32 v110, 0
    v_mov_b32 v126, 0
    v_mov_b32 v111, 0
    v_mov_b32 v127, 0
    v_mov_b32 v112, 0
    v_mov_b32 v128, 0
    v_mov_b32 v113, 0
    v_mov_b32 v129, 0
    v_mov_b32 v114, 0
    v_mov_b32 v130, 0
    v_mov_b32 v115, 0
    v_mov_b32 v131, 0
    v_mov_b32 v116, 0
    v_mov_b32 v132, 0
    v_mov_b32 v117, 0
    v_mov_b32 v133, 0
    v_mov_b32 v118, 0
    v_mov_b32 v134, 0
    v_mov_b32 v119, 0
    v_mov_b32 v135, 0
    v_mov_b32 v120, 0
    v_mov_b32 v136, 0
    v_mov_b32 v121, 0
    v_mov_b32 v137, 0
    v_mov_b32 v122, 0
    v_mov_b32 v138, 0
    v_mov_b32 v123, 0
    v_mov_b32_e64 v139, 0
    v_add_u32 v200, 110592, v3
    v_add_u32 v201, 110592, v206
    v_mov_b32_e64 v202, v3
    s_mul_i32 s67, s22, 3328
    s_add_u32 s66, s67, 110592
    s_mov_b32 m0, s66
    s_nop 0
    s_add_u32 s67, s67, 1048576
    buffer_load_dwordx4 v3, s[4:7], s67 offen lds
    buffer_load_dwordx4 v3, s[4:7], s67 offen offset:1024 lds
    buffer_load_dwordx4 v3, s[4:7], s67 offen offset:2048 lds
    s_mov_b64 exec, 0xffff
    buffer_load_dwordx4 v3, s[4:7], s67 offen offset:3072 lds
    s_mov_b64 exec, -1
    s_nop 0
    s_mul_i32 s67, s22, 3328
    s_add_u32 s66, s67, 123904
    s_mov_b32 m0, s66
    s_nop 0
    s_add_u32 s67, s67, 1061888
    buffer_load_dwordx4 v3, s[4:7], s67 offen lds
    buffer_load_dwordx4 v3, s[4:7], s67 offen offset:1024 lds
    buffer_load_dwordx4 v3, s[4:7], s67 offen offset:2048 lds
    s_mov_b64 exec, 0xffff
    buffer_load_dwordx4 v3, s[4:7], s67 offen offset:3072 lds
    s_mov_b64 exec, -1
    s_nop 0
    s_mul_i32 s67, s22, 3328
    s_add_u32 s66, s67, 137216
    s_mov_b32 m0, s66
    s_nop 0
    s_add_u32 s67, s67, 1075200
    buffer_load_dwordx4 v3, s[4:7], s67 offen lds
    buffer_load_dwordx4 v3, s[4:7], s67 offen offset:1024 lds
    buffer_load_dwordx4 v3, s[4:7], s67 offen offset:2048 lds
    s_mov_b64 exec, 0xffff
    buffer_load_dwordx4 v3, s[4:7], s67 offen offset:3072 lds
    s_mov_b64 exec, -1
    s_nop 0
    v_mov_b32 v76, 0xff800000
    v_mov_b32 v77, 0xff800000
    v_mov_b32 v78, 0xff800000
    v_mov_b32 v79, 0xff800000
    v_mov_b32 v80, 0xff800000
    v_mov_b32 v81, 0xff800000
    v_mov_b32 v82, 0xff800000
    v_mov_b32 v83, 0xff800000
    v_mov_b32 v84, 0xff800000
    v_mov_b32 v85, 0xff800000
    v_mov_b32 v86, 0xff800000
    v_mov_b32 v87, 0xff800000
    v_mov_b32 v88, 0xff800000
    v_mov_b32 v89, 0xff800000
    v_mov_b32 v90, 0xff800000
    v_mov_b32 v91, 0xff800000
    v_mov_b32 v92, 0
    v_mov_b32 v93, 0
    v_mov_b32 v94, 0
    v_mov_b32 v95, 0
    v_mov_b32 v96, 0
    v_mov_b32 v97, 0
    v_mov_b32 v98, 0
    v_mov_b32 v99, 0
    v_accvgpr_write_b32 a72, 0
    v_accvgpr_write_b32 a73, 0
    v_accvgpr_write_b32 a74, 0
    v_accvgpr_write_b32 a75, 0
    v_accvgpr_write_b32 a76, 0
    v_accvgpr_write_b32 a77, 0
    v_accvgpr_write_b32 a78, 0
    v_accvgpr_write_b32 a79, 0
    s_lshl_b32 s66, s25, 2
    s_add_u32 s66, s66, s22
    s_cmp_ge_u32 s66, 912
    s_cbranch_scc1 L_r3_31
    s_cmp_ge_u32 s66, 480
    s_cbranch_scc1 L_r4_30
    s_mul_i32 s67, s66, 410
    s_lshr_b32 s67, s67, 16
    s_mul_i32 s68, s67, 160
    s_sub_u32 s66, s66, s68
    s_cmp_eq_u32 s67, 1
    s_cselect_b32 s8, s44, s40
    s_cselect_b32 s9, s45, s41
    s_cmp_eq_u32 s67, 2
    s_cselect_b32 s8, s46, s8
    s_cselect_b32 s9, s47, s9
    s_mov_b32 s10, 819200
    s_mul_i32 s67, s67, 100
    s_mul_i32 s68, s66, 3277
    s_lshr_b32 s68, s68, 16
    s_mul_i32 s69, s68, 20
    s_sub_u32 s66, s66, s69
    s_mul_i32 s69, s66, 5
    s_add_u32 s67, s67, s69
    s_lshl_b32 s67, s67, 10
    s_mul_i32 s69, s68, 311296
    s_add_u32 s67, s67, s69
    s_add_u32 s79, s67, 19660800
    s_branch L_rA_32
L_r4_30:
    s_sub_u32 s66, s66, 480
    s_mov_b32 s8, s50
    s_mov_b32 s9, s51
    s_mov_b32 s10, 2211840
    s_mul_i32 s68, s66, 1214
    s_lshr_b32 s68, s68, 16
    s_mul_i32 s69, s68, 54
    s_sub_u32 s66, s66, s69
    s_nop 0
    s_mul_i32 s67, s66, 5120
    s_mul_i32 s69, s68, 278528
    s_add_u32 s67, s67, s69
    s_nop 0
    s_add_u32 s79, s67, 24510464
L_rA_32:
    s_mov_b32 s11, 0x20000
    s_mov_b32 s78, 0
    s_nop 0
    s_mul_i32 s66, s66, 40960
    s_mul_i32 s68, s68, 160
    s_add_u32 s66, s66, s68
    s_mul_i32 s67, s22, 14336
    v_add_u32 v9, 0, v0
    v_mul_u32_u24 v10, 6554, v9
    v_lshrrev_b32_e64 v10, 16, v10
    v_mul_u32_u24 v4, 1120, v10
    v_lshl_add_u32 v4, v9, 4, v4
    v_add_u32_e64 v9, 64, v0
    v_mul_u32_u24 v10, 6554, v9
    v_lshrrev_b32_e64 v10, 16, v10
    v_mul_u32_u24 v5, 1120, v10
    v_lshl_add_u32 v5, v9, 4, v5
    v_add_u32 v9, 128, v0
    v_mul_u32_u24 v10, 6554, v9
    v_lshrrev_b32_e64 v10, 16, v10
    v_mul_u32_u24 v6, 1120, v10
    v_lshl_add_u32 v6, v9, 4, v6
    v_add_u32 v9, 192, v0
    v_mul_u32_u24 v10, 6554, v9
    v_lshrrev_b32_e64 v10, 16, v10
    v_mul_u32_u24 v7, 1120, v10
    v_lshl_add_u32 v7, v9, 4, v7
    v_add_u32 v9, 256, v0
    v_mul_u32_u24 v10, 6554, v9
    v_lshrrev_b32_e64 v10, 16, v10
    v_mul_u32_u24 v8, 1120, v10
    v_lshl_add_u32 v8, v9, 4, v8
    s_mov_b32 m0, s67
    s_nop 0
    s_add_u32 s67, s67, 1024
    buffer_load_dwordx4 v4, s[8:11], s66 offen lds
    s_mov_b32 m0, s67
    s_nop 0
    s_add_u32 s67, s67, 1024
    buffer_load_dwordx4 v5, s[8:11], s66 offen lds
    s_mov_b32 m0, s67
    s_nop 0
    s_add_u32 s67, s67, 1024
    buffer_load_dwordx4 v6, s[8:11], s66 offen lds
    s_mov_b32 m0, s67
    s_nop 0
    s_add_u32 s67, s67, 1024
    buffer_load_dwordx4 v7, s[8:11], s66 offen lds
    s_mov_b32 m0, s67
    s_nop 0
    s_add_u32 s67, s67, 1024
    buffer_load_dwordx4 v8, s[8:11], s66 offen lds
    v_lshrrev_b32_e64 v11, 2, v1
    v_lshl_add_u32 v11, v2, 2, v11
    v_mul_u32_u24 v11, 160, v11
    s_branch L_re_33_tr
L_r3_31:
    s_sub_u32 s66, s66, 912
    s_mov_b32 s8, s48
    s_mov_b32 s9, s49
    s_nop 0
    s_mov_b32 s10, 2211840
    s_mov_b32 s11, 0x20000
    s_mov_b32 s78, 1
    s_mul_i32 s68, s66, 3277
    s_lshr_b32 s68, s68, 16
    s_mul_i32 s69, s68, 20
    s_sub_u32 s66, s66, s69
    s_mul_i32 s69, s68, 147456
    s_add_u32 s69, s69, 22151168
    s_mul_i32 s67, s66, 7168
    s_add_u32 s79, s67, s69
    s_mul_i32 s67, s66, 7168
    s_add_u32 s67, s67, s69
    s_add_u32 s74, s67, 4096
    s_mul_i32 s67, s68, 7
    s_sub_u32 s69, s68, 12
    s_max_i32 s69, s69, 0
    s_sub_u32 s67, s67, s69
    s_lshl_b32 s67, s67, 5
    s_mul_i32 s66, s66, 110592
    s_add_u32 s66, s66, s67
    s_mul_i32 s67, s22, 14336
    s_add_u32 s67, s67, 0
    v_add_u32 v12, 0, v0
    v_mul_u32_u24 v13, 4682, v12
    v_lshrrev_b32_e64 v13, 16, v13
    v_mul_u32_u24 v4, 3232, v13
    v_lshl_add_u32 v4, v12, 4, v4
    v_add_u32_e64 v12, 64, v0
    v_mul_u32_u24 v13, 4682, v12
    v_lshrrev_b32_e64 v13, 16, v13
    v_mul_u32_u24 v5, 3232, v13
    v_lshl_add_u32 v5, v12, 4, v5
    v_add_u32 v12, 128, v0
    v_mul_u32_u24 v13, 4682, v12
    v_lshrrev_b32_e64 v13, 16, v13
    v_mul_u32_u24 v6, 3232, v13
    v_lshl_add_u32 v6, v12, 4, v6
    v_add_u32 v12, 192, v0
    v_mul_u32_u24 v13, 4682, v12
    v_lshrrev_b32_e64 v13, 16, v13
    v_mul_u32_u24 v7, 3232, v13
    v_lshl_add_u32 v7, v12, 4, v7
    v_add_u32 v12, 256, v0
    v_mul_u32_u24 v13, 4682, v12
    v_lshrrev_b32_e64 v13, 16, v13
    v_mul_u32_u24 v8, 3232, v13
    v_lshl_add_u32 v8, v12, 4, v8
    v_add_u32 v12, 320, v0
    v_mul_u32_u24 v13, 4682, v12
    v_lshrrev_b32_e64 v13, 16, v13
    v_mul_u32_u24 v9, 3232, v13
    v_lshl_add_u32 v9, v12, 4, v9
    v_add_u32 v12, 384, v0
    v_mul_u32_u24 v13, 4682, v12
    v_lshrrev_b32_e64 v13, 16, v13
    v_mul_u32_u24 v10, 3232, v13
    v_lshl_add_u32 v10, v12, 4, v10
    s_mov_b32 m0, s67
    s_nop 0
    s_add_u32 s67, s67, 1024
    buffer_load_dwordx4 v4, s[8:11], s66 offen lds
    s_mov_b32 m0, s67
    s_nop 0
    s_add_u32 s67, s67, 1024
    buffer_load_dwordx4 v5, s[8:11], s66 offen lds
    s_mov_b32 m0, s67
    s_nop 0
    s_add_u32 s67, s67, 1024
    buffer_load_dwordx4 v6, s[8:11], s66 offen lds
    s_mov_b32 m0, s67
    s_nop 0
    s_add_u32 s67, s67, 1024
    buffer_load_dwordx4 v7, s[8:11], s66 offen lds
    s_mov_b32 m0, s67
    s_nop 0
    s_add_u32 s67, s67, 1024
    buffer_load_dwordx4 v8, s[8:11], s66 offen lds
    s_mov_b32 m0, s67
    s_nop 0
    s_add_u32 s67, s67, 1024
    buffer_load_dwordx4 v9, s[8:11], s66 offen lds
    s_mov_b32 m0, s67
    s_nop 0
    s_add_u32 s67, s67, 1024
    buffer_load_dwordx4 v10, s[8:11], s66 offen lds
    v_lshrrev_b32_e64 v11, 2, v1
    v_lshl_add_u32 v11, v2, 2, v11
    v_mul_u32_u24 v11, 224, v11
L_re_33_tr:
    v_and_b32_e64 v12, 3, v1
    v_lshl_add_u32 v11, v12, 3, v11
    s_mul_i32 s67, s22, 14336
    s_add_u32 s67, s67, 0
    v_add_u32 v11, s67, v11
L_re_33:
    s_waitcnt vmcnt(9)
    s_barrier
    ds_read_b128 a[16:19], v200 offset:0
    ds_read_b64 a[20:21], v201 offset:1024
    ds_read_b128 a[24:27], v200 offset:3328
    ds_read_b64 a[28:29], v201 offset:4352
    ds_read_b128 a[48:51], v200 offset:1280
    ds_read_b128 a[52:55], v200 offset:2304
    s_mov_b32 s87, 16
    s_nop 0
    s_mul_i32 s85, s22, 3328
    s_add_u32 s86, s85, 1075200
    s_add_u32 s85, s85, 110592
    s_mov_b32 s76, 106496
    s_mov_b32 s95, 1048576
    s_mov_b32 s75, 0
    s_mov_b32 s84, 0x1edd6
    s_waitcnt lgkmcnt(0)
    s_branch L_hook_39
L_ent_44:
    s_nop 0
    s_add_u32 s86, s86, 13312
    s_add_u32 m0, s85, 39936
L_att_34:
    v_mfma_f32_32x32x16_bf16 v[60:75], a[16:19], v[44:47], 0
    ds_read_b128 a[32:35], v200 offset:6656
    v_exp_f32 v76, v76
    v_exp_f32 v77, v77
    v_exp_f32 v78, v78
    v_exp_f32 v79, v79
    v_cvt_pk_bf16_f32 v100, v76, v77
    v_cvt_pk_bf16_f32 v101, v78, v79
    v_mfma_f32_32x32x8_bf16 v[60:75], a[20:21], v[48:49], v[60:75]
    v_exp_f32 v80, v80
    v_exp_f32 v81, v81
    v_exp_f32 v82, v82
    v_exp_f32 v83, v83
    v_cvt_pk_bf16_f32 v102, v80, v81
    v_cvt_pk_bf16_f32 v103, v82, v83
    v_mfma_f32_32x32x16_bf16 v[108:123], a[72:75], v[92:95], v[108:123]
    ds_read_b64 a[36:37], v201 offset:7680
    v_exp_f32 v84, v84
    v_exp_f32 v85, v85
    v_exp_f32 v86, v86
    v_exp_f32 v87, v87
    v_cvt_pk_bf16_f32 v104, v84, v85
    v_cvt_pk_bf16_f32 v105, v86, v87
    v_mfma_f32_32x32x16_bf16 v[108:123], a[76:79], v[96:99], v[108:123]
    buffer_load_dwordx4 v3, s[4:7], s86 offen offset:0 lds
    v_exp_f32 v88, v88
    v_exp_f32 v89, v89
    v_exp_f32 v90, v90
    v_exp_f32 v91, v91
    v_cvt_pk_bf16_f32 v106, v88, v89
    v_cvt_pk_bf16_f32 v107, v90, v91
    v_mfma_f32_32x32x16_bf16 v[76:91], a[16:19], v[52:55], 0
    ds_read_b128 a[56:59], v200 offset:4608
    v_exp_f32 v60, v60
    v_exp_f32 v61, v61
    v_exp_f32 v62, v62
    v_exp_f32 v63, v63
    v_cvt_pk_bf16_f32 v92, v60, v61
    v_cvt_pk_bf16_f32 v93, v62, v63
    v_mfma_f32_32x32x8_bf16 v[76:91], a[20:21], v[56:57], v[76:91]
    buffer_load_dwordx4 v3, s[4:7], s86 offen offset:1024 lds
    v_exp_f32 v64, v64
    v_exp_f32 v65, v65
    v_exp_f32 v66, v66
    v_exp_f32 v67, v67
    v_cvt_pk_bf16_f32 v94, v64, v65
    v_cvt_pk_bf16_f32 v95, v66, v67
    v_mfma_f32_32x32x16_bf16 v[124:139], a[72:75], v[100:103], v[124:139]
    ds_read_b128 a[60:63], v200 offset:5632
    v_exp_f32 v68, v68
    v_exp_f32 v69, v69
    v_exp_f32 v70, v70
    v_exp_f32 v71, v71
    v_cvt_pk_bf16_f32 v96, v68, v69
    v_cvt_pk_bf16_f32 v97, v70, v71
    v_mfma_f32_32x32x16_bf16 v[124:139], a[76:79], v[104:107], v[124:139]
    s_waitcnt lgkmcnt(4)
    v_exp_f32 v72, v72
    v_exp_f32 v73, v73
    v_exp_f32 v74, v74
    v_exp_f32_e64 v75, v75
    v_cvt_pk_bf16_f32 v98, v72, v73
    v_cvt_pk_bf16_f32 v99, v74, v75
    v_mfma_f32_32x32x16_bf16 v[60:75], a[24:27], v[44:47], 0
    ds_read_b128 a[40:43], v200 offset:9984
    v_exp_f32 v76, v76
    v_exp_f32 v77, v77
    v_exp_f32 v78, v78
    v_exp_f32 v79, v79
    v_cvt_pk_bf16_f32 v100, v76, v77
    v_cvt_pk_bf16_f32 v101, v78, v79
    v_mfma_f32_32x32x8_bf16 v[60:75], a[28:29], v[48:49], v[60:75]
    v_exp_f32 v80, v80
    v_exp_f32 v81, v81
    v_exp_f32 v82, v82
    v_exp_f32 v83, v83
    v_cvt_pk_bf16_f32 v102, v80, v81
    v_cvt_pk_bf16_f32 v103, v82, v83
    v_mfma_f32_32x32x16_bf16 v[108:123], a[48:51], v[92:95], v[108:123]
    ds_read_b64 a[44:45], v201 offset:11008
    v_exp_f32 v84, v84
    v_exp_f32 v85, v85
    v_exp_f32 v86, v86
    v_exp_f32 v87, v87
    v_cvt_pk_bf16_f32 v104, v84, v85
    v_cvt_pk_bf16_f32 v105, v86, v87
    v_mfma_f32_32x32x16_bf16 v[108:123], a[52:55], v[96:99], v[108:123]
    buffer_load_dwordx4 v3, s[4:7], s86 offen offset:2048 lds
    v_exp_f32 v88, v88
    v_exp_f32 v89, v89
    v_exp_f32 v90, v90
    v_exp_f32 v91, v91
    v_cvt_pk_bf16_f32 v106, v88, v89
    v_cvt_pk_bf16_f32 v107, v90, v91
    v_mfma_f32_32x32x16_bf16 v[76:91], a[24:27], v[52:55], 0
    ds_read_b128 a[64:67], v200 offset:7936
    v_exp_f32 v60, v60
    v_exp_f32 v61, v61
    v_exp_f32 v62, v62
    v_exp_f32 v63, v63
    v_cvt_pk_bf16_f32 v92, v60, v61
    v_cvt_pk_bf16_f32 v93, v62, v63
    v_mfma_f32_32x32x8_bf16 v[76:91], a[28:29], v[56:57], v[76:91]
    s_mov_b64 exec, 0xffff
    buffer_load_dwordx4 v3, s[4:7], s86 offen offset:3072 lds
    s_mov_b64 exec, -1
    s_mov_b32 m0, s76
    v_exp_f32 v64, v64
    v_exp_f32 v65, v65
    v_exp_f32 v66, v66
    v_exp_f32 v67, v67
    v_cvt_pk_bf16_f32 v94, v64, v65
    v_cvt_pk_bf16_f32 v95, v66, v67
    v_mfma_f32_32x32x16_bf16 v[124:139], a[48:51], v[100:103], v[124:139]
    ds_read_b128 a[68:71], v200 offset:8960
    v_exp_f32 v68, v68
    v_exp_f32 v69, v69
    v_exp_f32 v70, v70
    v_exp_f32 v71, v71
    v_cvt_pk_bf16_f32 v96, v68, v69
    v_cvt_pk_bf16_f32 v97, v70, v71
    v_mfma_f32_32x32x16_bf16 v[124:139], a[52:55], v[104:107], v[124:139]
    s_waitcnt lgkmcnt(4)
    v_exp_f32 v72, v72
    v_exp_f32 v73, v73
    v_exp_f32 v74, v74
    v_exp_f32_e64 v75, v75
    v_cvt_pk_bf16_f32 v98, v72, v73
    v_cvt_pk_bf16_f32 v99, v74, v75
    v_mfma_f32_32x32x16_bf16 v[60:75], a[32:35], v[44:47], 0
    ds_read_b128 a[16:19], v200 offset:13312
    v_exp_f32 v76, v76
    v_exp_f32 v77, v77
    v_exp_f32 v78, v78
    v_exp_f32 v79, v79
    v_cvt_pk_bf16_f32 v100, v76, v77
    v_cvt_pk_bf16_f32 v101, v78, v79
    v_mfma_f32_32x32x8_bf16 v[60:75], a[36:37], v[48:49], v[60:75]
    v_exp_f32 v80, v80
    v_exp_f32 v81, v81
    v_exp_f32 v82, v82
    v_exp_f32 v83, v83
    v_cvt_pk_bf16_f32 v102, v80, v81
    v_cvt_pk_bf16_f32 v103, v82, v83
    v_mfma_f32_32x32x16_bf16 v[108:123], a[56:59], v[92:95], v[108:123]
    ds_read_b64 a[20:21], v201 offset:14336
    v_exp_f32 v84, v84
    v_exp_f32 v85, v85
    v_exp_f32 v86, v86
    v_exp_f32 v87, v87
    v_cvt_pk_bf16_f32 v104, v84, v85
    v_cvt_pk_bf16_f32 v105, v86, v87
    v_mfma_f32_32x32x16_bf16 v[108:123], a[60:63], v[96:99], v[108:123]
    buffer_load_dwordx4 v202, s[4:7], s95 offen offset:0 lds
    v_exp_f32 v88, v88
    v_exp_f32 v89, v89
    v_exp_f32 v90, v90
    v_exp_f32 v91, v91
    v_cvt_pk_bf16_f32 v106, v88, v89
    v_cvt_pk_bf16_f32 v107, v90, v91
    v_mfma_f32_32x32x16_bf16 v[76:91], a[32:35], v[52:55], 0
    ds_read_b128 a[72:75], v200 offset:11264
    v_exp_f32 v60, v60
    v_exp_f32 v61, v61
    v_exp_f32 v62, v62
    v_exp_f32 v63, v63
    v_cvt_pk_bf16_f32 v92, v60, v61
    v_cvt_pk_bf16_f32 v93, v62, v63
    v_mfma_f32_32x32x8_bf16 v[76:91], a[36:37], v[56:57], v[76:91]
    buffer_load_dwordx4 v202, s[4:7], s95 offen offset:1024 lds
    v_exp_f32 v64, v64
    v_exp_f32 v65, v65
    v_exp_f32 v66, v66
    v_exp_f32 v67, v67
    v_cvt_pk_bf16_f32 v94, v64, v65
    v_cvt_pk_bf16_f32 v95, v66, v67
    v_mfma_f32_32x32x16_bf16 v[124:139], a[56:59], v[100:103], v[124:139]
    ds_read_b128 a[76:79], v200 offset:12288
    v_exp_f32 v68, v68
    v_exp_f32 v69, v69
    v_exp_f32 v70, v70
    v_exp_f32 v71, v71
    v_cvt_pk_bf16_f32 v96, v68, v69
    v_cvt_pk_bf16_f32 v97, v70, v71
    v_mfma_f32_32x32x16_bf16 v[124:139], a[60:63], v[104:107], v[124:139]
    s_waitcnt lgkmcnt(4)
    v_exp_f32 v72, v72
    v_exp_f32 v73, v73
    v_exp_f32 v74, v74
    v_exp_f32_e64 v75, v75
    v_cvt_pk_bf16_f32 v98, v72, v73
    v_cvt_pk_bf16_f32 v99, v74, v75
    v_mfma_f32_32x32x16_bf16 v[60:75], a[40:43], v[44:47], 0
    ds_read_b128 a[24:27], v200 offset:16640
    v_exp_f32 v76, v76
    v_exp_f32 v77, v77
    v_exp_f32 v78, v78
    v_exp_f32 v79, v79
    v_cvt_pk_bf16_f32 v100, v76, v77
    v_cvt_pk_bf16_f32 v101, v78, v79
    v_mfma_f32_32x32x8_bf16 v[60:75], a[44:45], v[48:49], v[60:75]
    v_exp_f32 v80, v80
    v_exp_f32 v81, v81
    v_exp_f32 v82, v82
    v_exp_f32 v83, v83
    v_cvt_pk_bf16_f32 v102, v80, v81
    v_cvt_pk_bf16_f32 v103, v82, v83
    v_mfma_f32_32x32x16_bf16 v[108:123], a[64:67], v[92:95], v[108:123]
    ds_read_b64 a[28:29], v201 offset:17664
    v_exp_f32 v84, v84
    v_exp_f32 v85, v85
    v_exp_f32 v86, v86
    v_exp_f32 v87, v87
    v_cvt_pk_bf16_f32 v104, v84, v85
    v_cvt_pk_bf16_f32 v105, v86, v87
    v_mfma_f32_32x32x16_bf16 v[108:123], a[68:71], v[96:99], v[108:123]
    buffer_load_dwordx4 v202, s[4:7], s95 offen offset:2048 lds
    v_exp_f32 v88, v88
    v_exp_f32 v89, v89
    v_exp_f32 v90, v90
    v_exp_f32 v91, v91
    v_cvt_pk_bf16_f32 v106, v88, v89
    v_cvt_pk_bf16_f32 v107, v90, v91
    v_mfma_f32_32x32x16_bf16 v[76:91], a[40:43], v[52:55], 0
    ds_read_b128 a[48:51], v200 offset:14592
    v_exp_f32 v60, v60
    v_exp_f32 v61, v61
    v_exp_f32 v62, v62
    v_exp_f32 v63, v63
    v_cvt_pk_bf16_f32 v92, v60, v61
    v_cvt_pk_bf16_f32 v93, v62, v63
    v_mfma_f32_32x32x8_bf16 v[76:91], a[44:45], v[56:57], v[76:91]
    buffer_load_dwordx4 v202, s[4:7], s95 offen offset:3072 lds
    v_exp_f32 v64, v64
    v_exp_f32 v65, v65
    v_exp_f32 v66, v66
    v_exp_f32 v67, v67
    v_cvt_pk_bf16_f32 v94, v64, v65
    v_cvt_pk_bf16_f32 v95, v66, v67
    v_mfma_f32_32x32x16_bf16 v[124:139], a[64:67], v[100:103], v[124:139]
    ds_read_b128 a[52:55], v200 offset:15616
    v_exp_f32 v68, v68
    v_exp_f32 v69, v69
    v_exp_f32 v70, v70
    v_exp_f32 v71, v71
    v_cvt_pk_bf16_f32 v96, v68, v69
    v_cvt_pk_bf16_f32 v97, v70, v71
    v_mfma_f32_32x32x16_bf16 v[124:139], a[68:71], v[104:107], v[124:139]
    s_sub_u32 s87, s87, 1
    s_waitcnt vmcnt(12) lgkmcnt(4)
    s_barrier
    s_bitcmp1_b32 s84, s87
    s_cbranch_scc1 L_hook_36
L_back_41:
    s_add_u32 s86, s86, 13312
    s_add_u32 m0, s85, 0
    s_add_u32 s95, s95, s75
    s_add_u32 s76, s76, s75
    v_exp_f32 v72, v72
    v_exp_f32 v73, v73
    v_exp_f32 v74, v74
    v_exp_f32 v75, v75
    v_cvt_pk_bf16_f32 v98, v72, v73
    v_cvt_pk_bf16_f32 v99, v74, v75
    v_mfma_f32_32x32x16_bf16 v[60:75], a[16:19], v[44:47], 0
    ds_read_b128 a[32:35], v200 offset:19968
    v_exp_f32 v76, v76
    v_exp_f32 v77, v77
    v_exp_f32 v78, v78
    v_exp_f32 v79, v79
    v_cvt_pk_bf16_f32 v100, v76, v77
    v_cvt_pk_bf16_f32 v101, v78, v79
    v_mfma_f32_32x32x8_bf16 v[60:75], a[20:21], v[48:49], v[60:75]
    v_exp_f32 v80, v80
    v_exp_f32 v81, v81
    v_exp_f32 v82, v82
    v_exp_f32 v83, v83
    v_cvt_pk_bf16_f32 v102, v80, v81
    v_cvt_pk_bf16_f32 v103, v82, v83
    v_mfma_f32_32x32x16_bf16 v[108:123], a[72:75], v[92:95], v[108:123]
    ds_read_b64 a[36:37], v201 offset:20992
    v_exp_f32 v84, v84
    v_exp_f32 v85, v85
    v_exp_f32 v86, v86
    v_exp_f32 v87, v87
    v_cvt_pk_bf16_f32 v104, v84, v85
    v_cvt_pk_bf16_f32 v105, v86, v87
    v_mfma_f32_32x32x16_bf16 v[108:123], a[76:79], v[96:99], v[108:123]
    buffer_load_dwordx4 v3, s[4:7], s86 offen offset:0 lds
    v_exp_f32 v88, v88
    v_exp_f32 v89, v89
    v_exp_f32 v90, v90
    v_exp_f32 v91, v91
    v_cvt_pk_bf16_f32 v106, v88, v89
    v_cvt_pk_bf16_f32 v107, v90, v91
    v_mfma_f32_32x32x16_bf16 v[76:91], a[16:19], v[52:55], 0
    ds_read_b128 a[56:59], v200 offset:17920
    v_exp_f32 v60, v60
    v_exp_f32 v61, v61
    v_exp_f32 v62, v62
    v_exp_f32 v63, v63
    v_cvt_pk_bf16_f32 v92, v60, v61
    v_cvt_pk_bf16_f32 v93, v62, v63
    v_mfma_f32_32x32x8_bf16 v[76:91], a[20:21], v[56:57], v[76:91]
    buffer_load_dwordx4 v3, s[4:7], s86 offen offset:1024 lds
    v_exp_f32 v64, v64
    v_exp_f32 v65, v65
    v_exp_f32 v66, v66
    v_exp_f32 v67, v67
    v_cvt_pk_bf16_f32 v94, v64, v65
    v_cvt_pk_bf16_f32 v95, v66, v67
    v_mfma_f32_32x32x16_bf16 v[124:139], a[72:75], v[100:103], v[124:139]
    ds_read_b128 a[60:63], v200 offset:18944
    v_exp_f32 v68, v68
    v_exp_f32 v69, v69
    v_exp_f32 v70, v70
    v_exp_f32 v71, v71
    v_cvt_pk_bf16_f32 v96, v68, v69
    v_cvt_pk_bf16_f32 v97, v70, v71
    v_mfma_f32_32x32x16_bf16 v[124:139], a[76:79], v[104:107], v[124:139]
    s_waitcnt lgkmcnt(4)
    v_exp_f32 v72, v72
    v_exp_f32 v73, v73
    v_exp_f32 v74, v74
    v_exp_f32_e64 v75, v75
    v_cvt_pk_bf16_f32 v98, v72, v73
    v_cvt_pk_bf16_f32 v99, v74, v75
    v_mfma_f32_32x32x16_bf16 v[60:75], a[24:27], v[44:47], 0
    ds_read_b128 a[40:43], v200 offset:23296
    v_exp_f32 v76, v76
    v_exp_f32 v77, v77
    v_exp_f32 v78, v78
    v_exp_f32 v79, v79
    v_cvt_pk_bf16_f32 v100, v76, v77
    v_cvt_pk_bf16_f32 v101, v78, v79
    v_mfma_f32_32x32x8_bf16 v[60:75], a[28:29], v[48:49], v[60:75]
    v_exp_f32 v80, v80
    v_exp_f32 v81, v81
    v_exp_f32 v82, v82
    v_exp_f32 v83, v83
    v_cvt_pk_bf16_f32 v102, v80, v81
    v_cvt_pk_bf16_f32 v103, v82, v83
    v_mfma_f32_32x32x16_bf16 v[108:123], a[48:51], v[92:95], v[108:123]
    ds_read_b64 a[44:45], v201 offset:24320
    v_exp_f32 v84, v84
    v_exp_f32 v85, v85
    v_exp_f32 v86, v86
    v_exp_f32 v87, v87
    v_cvt_pk_bf16_f32 v104, v84, v85
    v_cvt_pk_bf16_f32 v105, v86, v87
    v_mfma_f32_32x32x16_bf16 v[108:123], a[52:55], v[96:99], v[108:123]
    buffer_load_dwordx4 v3, s[4:7], s86 offen offset:2048 lds
    v_exp_f32 v88, v88
    v_exp_f32 v89, v89
    v_exp_f32 v90, v90
    v_exp_f32 v91, v91
    v_cvt_pk_bf16_f32 v106, v88, v89
    v_cvt_pk_bf16_f32 v107, v90, v91
    v_mfma_f32_32x32x16_bf16 v[76:91], a[24:27], v[52:55], 0
    ds_read_b128 a[64:67], v200 offset:21248
    v_exp_f32 v60, v60
    v_exp_f32 v61, v61
    v_exp_f32 v62, v62
    v_exp_f32 v63, v63
    v_cvt_pk_bf16_f32 v92, v60, v61
    v_cvt_pk_bf16_f32 v93, v62, v63
    v_mfma_f32_32x32x8_bf16 v[76:91], a[28:29], v[56:57], v[76:91]
    s_mov_b64 exec, 0xffff
    buffer_load_dwordx4 v3, s[4:7], s86 offen offset:3072 lds
    s_mov_b64 exec, -1
    s_mov_b32 m0, s76
    v_exp_f32 v64, v64
    v_exp_f32 v65, v65
    v_exp_f32 v66, v66
    v_exp_f32 v67, v67
    v_cvt_pk_bf16_f32 v94, v64, v65
    v_cvt_pk_bf16_f32 v95, v66, v67
    v_mfma_f32_32x32x16_bf16 v[124:139], a[48:51], v[100:103], v[124:139]
    ds_read_b128 a[68:71], v200 offset:22272
    v_exp_f32 v68, v68
    v_exp_f32 v69, v69
    v_exp_f32 v70, v70
    v_exp_f32 v71, v71
    v_cvt_pk_bf16_f32 v96, v68, v69
    v_cvt_pk_bf16_f32 v97, v70, v71
    v_mfma_f32_32x32x16_bf16 v[124:139], a[52:55], v[104:107], v[124:139]
    s_waitcnt lgkmcnt(4)
    v_exp_f32 v72, v72
    v_exp_f32 v73, v73
    v_exp_f32 v74, v74
    v_exp_f32_e64 v75, v75
    v_cvt_pk_bf16_f32 v98, v72, v73
    v_cvt_pk_bf16_f32 v99, v74, v75
    v_mfma_f32_32x32x16_bf16 v[60:75], a[32:35], v[44:47], 0
    ds_read_b128 a[16:19], v200 offset:26624
    v_exp_f32 v76, v76
    v_exp_f32 v77, v77
    v_exp_f32 v78, v78
    v_exp_f32 v79, v79
    v_cvt_pk_bf16_f32 v100, v76, v77
    v_cvt_pk_bf16_f32 v101, v78, v79
    v_mfma_f32_32x32x8_bf16 v[60:75], a[36:37], v[48:49], v[60:75]
    v_exp_f32 v80, v80
    v_exp_f32 v81, v81
    v_exp_f32 v82, v82
    v_exp_f32 v83, v83
    v_cvt_pk_bf16_f32 v102, v80, v81
    v_cvt_pk_bf16_f32 v103, v82, v83
    v_mfma_f32_32x32x16_bf16 v[108:123], a[56:59], v[92:95], v[108:123]
    ds_read_b64 a[20:21], v201 offset:27648
    v_exp_f32 v84, v84
    v_exp_f32 v85, v85
    v_exp_f32 v86, v86
    v_exp_f32 v87, v87
    v_cvt_pk_bf16_f32 v104, v84, v85
    v_cvt_pk_bf16_f32 v105, v86, v87
    v_mfma_f32_32x32x16_bf16 v[108:123], a[60:63], v[96:99], v[108:123]
    buffer_load_dwordx4 v202, s[4:7], s95 offen offset:0 lds
    v_exp_f32 v88, v88
    v_exp_f32 v89, v89
    v_exp_f32 v90, v90
    v_exp_f32 v91, v91
    v_cvt_pk_bf16_f32 v106, v88, v89
    v_cvt_pk_bf16_f32 v107, v90, v91
    v_mfma_f32_32x32x16_bf16 v[76:91], a[32:35], v[52:55], 0
    ds_read_b128 a[72:75], v200 offset:24576
    v_exp_f32 v60, v60
    v_exp_f32 v61, v61
    v_exp_f32 v62, v62
    v_exp_f32 v63, v63
    v_cvt_pk_bf16_f32 v92, v60, v61
    v_cvt_pk_bf16_f32 v93, v62, v63
    v_mfma_f32_32x32x8_bf16 v[76:91], a[36:37], v[56:57], v[76:91]
    buffer_load_dwordx4 v202, s[4:7], s95 offen offset:1024 lds
    v_exp_f32 v64, v64
    v_exp_f32 v65, v65
    v_exp_f32 v66, v66
    v_exp_f32 v67, v67
    v_cvt_pk_bf16_f32 v94, v64, v65
    v_cvt_pk_bf16_f32 v95, v66, v67
    v_mfma_f32_32x32x16_bf16 v[124:139], a[56:59], v[100:103], v[124:139]
    ds_read_b128 a[76:79], v200 offset:25600
    v_exp_f32 v68, v68
    v_exp_f32 v69, v69
    v_exp_f32 v70, v70
    v_exp_f32 v71, v71
    v_cvt_pk_bf16_f32 v96, v68, v69
    v_cvt_pk_bf16_f32 v97, v70, v71
    v_mfma_f32_32x32x16_bf16 v[124:139], a[60:63], v[104:107], v[124:139]
    s_waitcnt lgkmcnt(4)
    v_exp_f32 v72, v72
    v_exp_f32 v73, v73
    v_exp_f32 v74, v74
    v_exp_f32_e64 v75, v75
    v_cvt_pk_bf16_f32 v98, v72, v73
    v_cvt_pk_bf16_f32 v99, v74, v75
    v_mfma_f32_32x32x16_bf16 v[60:75], a[40:43], v[44:47], 0
    ds_read_b128 a[24:27], v200 offset:29952
    v_exp_f32 v76, v76
    v_exp_f32 v77, v77
    v_exp_f32 v78, v78
    v_exp_f32 v79, v79
    v_cvt_pk_bf16_f32 v100, v76, v77
    v_cvt_pk_bf16_f32 v101, v78, v79
    v_mfma_f32_32x32x8_bf16 v[60:75], a[44:45], v[48:49], v[60:75]
    v_exp_f32 v80, v80
    v_exp_f32 v81, v81
    v_exp_f32 v82, v82
    v_exp_f32 v83, v83
    v_cvt_pk_bf16_f32 v102, v80, v81
    v_cvt_pk_bf16_f32 v103, v82, v83
    v_mfma_f32_32x32x16_bf16 v[108:123], a[64:67], v[92:95], v[108:123]
    ds_read_b64 a[28:29], v201 offset:30976
    v_exp_f32 v84, v84
    v_exp_f32 v85, v85
    v_exp_f32 v86, v86
    v_exp_f32 v87, v87
    v_cvt_pk_bf16_f32 v104, v84, v85
    v_cvt_pk_bf16_f32 v105, v86, v87
    v_mfma_f32_32x32x16_bf16 v[108:123], a[68:71], v[96:99], v[108:123]
    buffer_load_dwordx4 v202, s[4:7], s95 offen offset:2048 lds
    v_exp_f32 v88, v88
    v_exp_f32 v89, v89
    v_exp_f32 v90, v90
    v_exp_f32 v91, v91
    v_cvt_pk_bf16_f32 v106, v88, v89
    v_cvt_pk_bf16_f32 v107, v90, v91
    v_mfma_f32_32x32x16_bf16 v[76:91], a[40:43], v[52:55], 0
    ds_read_b128 a[48:51], v200 offset:27904
    v_exp_f32 v60, v60
    v_exp_f32 v61, v61
    v_exp_f32 v62, v62
    v_exp_f32 v63, v63
    v_cvt_pk_bf16_f32 v92, v60, v61
    v_cvt_pk_bf16_f32 v93, v62, v63
    v_mfma_f32_32x32x8_bf16 v[76:91], a[44:45], v[56:57], v[76:91]
    buffer_load_dwordx4 v202, s[4:7], s95 offen offset:3072 lds
    v_exp_f32 v64, v64
    v_exp_f32 v65, v65
    v_exp_f32 v66, v66
    v_exp_f32 v67, v67
    v_cvt_pk_bf16_f32 v94, v64, v65
    v_cvt_pk_bf16_f32 v95, v66, v67
    v_mfma_f32_32x32x16_bf16 v[124:139], a[64:67], v[100:103], v[124:139]
    ds_read_b128 a[52:55], v200 offset:28928
    v_exp_f32 v68, v68
    v_exp_f32 v69, v69
    v_exp_f32 v70, v70
    v_exp_f32 v71, v71
    v_cvt_pk_bf16_f32 v96, v68, v69
    v_cvt_pk_bf16_f32 v97, v70, v71
    v_mfma_f32_32x32x16_bf16 v[124:139], a[68:71], v[104:107], v[124:139]
    s_sub_u32 s87, s87, 1
    s_waitcnt vmcnt(12) lgkmcnt(4)
    s_barrier
    s_bitcmp1_b32 s84, s87
    s_cbranch_scc1 L_hook_37
L_back_42:
    s_nop 0
    s_add_u32 s86, s86, 13312
    s_add_u32 m0, s85, 13312
    s_add_u32 s95, s95, s75
    s_add_u32 s76, s76, s75
    v_exp_f32 v72, v72
    v_exp_f32 v73, v73
    v_exp_f32 v74, v74
    v_exp_f32 v75, v75
    v_cvt_pk_bf16_f32 v98, v72, v73
    v_cvt_pk_bf16_f32 v99, v74, v75
    v_mfma_f32_32x32x16_bf16 v[60:75], a[16:19], v[44:47], 0
    ds_read_b128 a[32:35], v200 offset:33280
    v_exp_f32 v76, v76
    v_exp_f32 v77, v77
    v_exp_f32 v78, v78
    v_exp_f32 v79, v79
    v_cvt_pk_bf16_f32 v100, v76, v77
    v_cvt_pk_bf16_f32 v101, v78, v79
    v_mfma_f32_32x32x8_bf16 v[60:75], a[20:21], v[48:49], v[60:75]
    v_exp_f32 v80, v80
    v_exp_f32 v81, v81
    v_exp_f32 v82, v82
    v_exp_f32 v83, v83
    v_cvt_pk_bf16_f32 v102, v80, v81
    v_cvt_pk_bf16_f32 v103, v82, v83
    v_mfma_f32_32x32x16_bf16 v[108:123], a[72:75], v[92:95], v[108:123]
    ds_read_b64 a[36:37], v201 offset:34304
    v_exp_f32 v84, v84
    v_exp_f32 v85, v85
    v_exp_f32 v86, v86
    v_exp_f32 v87, v87
    v_cvt_pk_bf16_f32 v104, v84, v85
    v_cvt_pk_bf16_f32 v105, v86, v87
    v_mfma_f32_32x32x16_bf16 v[108:123], a[76:79], v[96:99], v[108:123]
    buffer_load_dwordx4 v3, s[4:7], s86 offen offset:0 lds
    v_exp_f32 v88, v88
    v_exp_f32 v89, v89
    v_exp_f32 v90, v90
    v_exp_f32 v91, v91
    v_cvt_pk_bf16_f32 v106, v88, v89
    v_cvt_pk_bf16_f32 v107, v90, v91
    v_mfma_f32_32x32x16_bf16 v[76:91], a[16:19], v[52:55], 0
    ds_read_b128 a[56:59], v200 offset:31232
    v_exp_f32 v60, v60
    v_exp_f32 v61, v61
    v_exp_f32 v62, v62
    v_exp_f32 v63, v63
    v_cvt_pk_bf16_f32 v92, v60, v61
    v_cvt_pk_bf16_f32 v93, v62, v63
    v_mfma_f32_32x32x8_bf16 v[76:91], a[20:21], v[56:57], v[76:91]
    buffer_load_dwordx4 v3, s[4:7], s86 offen offset:1024 lds
    v_exp_f32 v64, v64
    v_exp_f32 v65, v65
    v_exp_f32 v66, v66
    v_exp_f32 v67, v67
    v_cvt_pk_bf16_f32 v94, v64, v65
    v_cvt_pk_bf16_f32 v95, v66, v67
    v_mfma_f32_32x32x16_bf16 v[124:139], a[72:75], v[100:103], v[124:139]
    ds_read_b128 a[60:63], v200 offset:32256
    v_exp_f32 v68, v68
    v_exp_f32 v69, v69
    v_exp_f32 v70, v70
    v_exp_f32 v71, v71
    v_cvt_pk_bf16_f32 v96, v68, v69
    v_cvt_pk_bf16_f32 v97, v70, v71
    v_mfma_f32_32x32x16_bf16 v[124:139], a[76:79], v[104:107], v[124:139]
    s_waitcnt lgkmcnt(4)
    v_exp_f32 v72, v72
    v_exp_f32 v73, v73
    v_exp_f32 v74, v74
    v_exp_f32_e64 v75, v75
    v_cvt_pk_bf16_f32 v98, v72, v73
    v_cvt_pk_bf16_f32 v99, v74, v75
    v_mfma_f32_32x32x16_bf16 v[60:75], a[24:27], v[44:47], 0
    ds_read_b128 a[40:43], v200 offset:36608
    v_exp_f32 v76, v76
    v_exp_f32 v77, v77
    v_exp_f32 v78, v78
    v_exp_f32 v79, v79
    v_cvt_pk_bf16_f32 v100, v76, v77
    v_cvt_pk_bf16_f32 v101, v78, v79
    v_mfma_f32_32x32x8_bf16 v[60:75], a[28:29], v[48:49], v[60:75]
    v_exp_f32 v80, v80
    v_exp_f32 v81, v81
    v_exp_f32 v82, v82
    v_exp_f32 v83, v83
    v_cvt_pk_bf16_f32 v102, v80, v81
    v_cvt_pk_bf16_f32 v103, v82, v83
    v_mfma_f32_32x32x16_bf16 v[108:123], a[48:51], v[92:95], v[108:123]
    ds_read_b64 a[44:45], v201 offset:37632
    v_exp_f32 v84, v84
    v_exp_f32 v85, v85
    v_exp_f32 v86, v86
    v_exp_f32 v87, v87
    v_cvt_pk_bf16_f32 v104, v84, v85
    v_cvt_pk_bf16_f32 v105, v86, v87
    v_mfma_f32_32x32x16_bf16 v[108:123], a[52:55], v[96:99], v[108:123]
    buffer_load_dwordx4 v3, s[4:7], s86 offen offset:2048 lds
    v_exp_f32 v88, v88
    v_exp_f32 v89, v89
    v_exp_f32 v90, v90
    v_exp_f32 v91, v91
    v_cvt_pk_bf16_f32 v106, v88, v89
    v_cvt_pk_bf16_f32 v107, v90, v91
    v_mfma_f32_32x32x16_bf16 v[76:91], a[24:27], v[52:55], 0
    ds_read_b128 a[64:67], v200 offset:34560
    v_exp_f32 v60, v60
    v_exp_f32 v61, v61
    v_exp_f32 v62, v62
    v_exp_f32 v63, v63
    v_cvt_pk_bf16_f32 v92, v60, v61
    v_cvt_pk_bf16_f32 v93, v62, v63
    v_mfma_f32_32x32x8_bf16 v[76:91], a[28:29], v[56:57], v[76:91]
    s_mov_b64 exec, 0xffff
    buffer_load_dwordx4 v3, s[4:7], s86 offen offset:3072 lds
    s_mov_b64 exec, -1
    s_mov_b32 m0, s76
    v_exp_f32 v64, v64
    v_exp_f32 v65, v65
    v_exp_f32 v66, v66
    v_exp_f32 v67, v67
    v_cvt_pk_bf16_f32 v94, v64, v65
    v_cvt_pk_bf16_f32 v95, v66, v67
    v_mfma_f32_32x32x16_bf16 v[124:139], a[48:51], v[100:103], v[124:139]
    ds_read_b128 a[68:71], v200 offset:35584
    v_exp_f32 v68, v68
    v_exp_f32 v69, v69
    v_exp_f32 v70, v70
    v_exp_f32 v71, v71
    v_cvt_pk_bf16_f32 v96, v68, v69
    v_cvt_pk_bf16_f32 v97, v70, v71
    v_mfma_f32_32x32x16_bf16 v[124:139], a[52:55], v[104:107], v[124:139]
    s_waitcnt lgkmcnt(4)
    v_exp_f32 v72, v72
    v_exp_f32 v73, v73
    v_exp_f32 v74, v74
    v_exp_f32_e64 v75, v75
    v_cvt_pk_bf16_f32 v98, v72, v73
    v_cvt_pk_bf16_f32 v99, v74, v75
    v_mfma_f32_32x32x16_bf16 v[60:75], a[32:35], v[44:47], 0
    ds_read_b128 a[16:19], v200 offset:39936
    v_exp_f32 v76, v76
    v_exp_f32 v77, v77
    v_exp_f32 v78, v78
    v_exp_f32 v79, v79
    v_cvt_pk_bf16_f32 v100, v76, v77
    v_cvt_pk_bf16_f32 v101, v78, v79
    v_mfma_f32_32x32x8_bf16 v[60:75], a[36:37], v[48:49], v[60:75]
    v_exp_f32 v80, v80
    v_exp_f32 v81, v81
    v_exp_f32 v82, v82
    v_exp_f32 v83, v83
    v_cvt_pk_bf16_f32 v102, v80, v81
    v_cvt_pk_bf16_f32 v103, v82, v83
    v_mfma_f32_32x32x16_bf16 v[108:123], a[56:59], v[92:95], v[108:123]
    ds_read_b64 a[20:21], v201 offset:40960
    v_exp_f32 v84, v84
    v_exp_f32 v85, v85
    v_exp_f32 v86, v86
    v_exp_f32 v87, v87
    v_cvt_pk_bf16_f32 v104, v84, v85
    v_cvt_pk_bf16_f32 v105, v86, v87
    v_mfma_f32_32x32x16_bf16 v[108:123], a[60:63], v[96:99], v[108:123]
    buffer_load_dwordx4 v202, s[4:7], s95 offen offset:0 lds
    v_exp_f32 v88, v88
    v_exp_f32 v89, v89
    v_exp_f32 v90, v90
    v_exp_f32 v91, v91
    v_cvt_pk_bf16_f32 v106, v88, v89
    v_cvt_pk_bf16_f32 v107, v90, v91
    v_mfma_f32_32x32x16_bf16 v[76:91], a[32:35], v[52:55], 0
    ds_read_b128 a[72:75], v200 offset:37888
    v_exp_f32 v60, v60
    v_exp_f32 v61, v61
    v_exp_f32 v62, v62
    v_exp_f32 v63, v63
    v_cvt_pk_bf16_f32 v92, v60, v61
    v_cvt_pk_bf16_f32 v93, v62, v63
    v_mfma_f32_32x32x8_bf16 v[76:91], a[36:37], v[56:57], v[76:91]
    buffer_load_dwordx4 v202, s[4:7], s95 offen offset:1024 lds
    v_exp_f32 v64, v64
    v_exp_f32 v65, v65
    v_exp_f32 v66, v66
    v_exp_f32 v67, v67
    v_cvt_pk_bf16_f32 v94, v64, v65
    v_cvt_pk_bf16_f32 v95, v66, v67
    v_mfma_f32_32x32x16_bf16 v[124:139], a[56:59], v[100:103], v[124:139]
    ds_read_b128 a[76:79], v200 offset:38912
    v_exp_f32 v68, v68
    v_exp_f32 v69, v69
    v_exp_f32 v70, v70
    v_exp_f32 v71, v71
    v_cvt_pk_bf16_f32 v96, v68, v69
    v_cvt_pk_bf16_f32 v97, v70, v71
    v_mfma_f32_32x32x16_bf16 v[124:139], a[60:63], v[104:107], v[124:139]
    s_waitcnt lgkmcnt(4)
    v_exp_f32 v72, v72
    v_exp_f32 v73, v73
    v_exp_f32 v74, v74
    v_exp_f32_e64 v75, v75
    v_cvt_pk_bf16_f32 v98, v72, v73
    v_cvt_pk_bf16_f32 v99, v74, v75
    v_mfma_f32_32x32x16_bf16 v[60:75], a[40:43], v[44:47], 0
    ds_read_b128 a[24:27], v200 offset:43264
    v_exp_f32 v76, v76
    v_exp_f32 v77, v77
    v_exp_f32 v78, v78
    v_exp_f32 v79, v79
    v_cvt_pk_bf16_f32 v100, v76, v77
    v_cvt_pk_bf16_f32 v101, v78, v79
    v_mfma_f32_32x32x8_bf16 v[60:75], a[44:45], v[48:49], v[60:75]
    v_exp_f32 v80, v80
    v_exp_f32 v81, v81
    v_exp_f32 v82, v82
    v_exp_f32 v83, v83
    v_cvt_pk_bf16_f32 v102, v80, v81
    v_cvt_pk_bf16_f32 v103, v82, v83
    v_mfma_f32_32x32x16_bf16 v[108:123], a[64:67], v[92:95], v[108:123]
    ds_read_b64 a[28:29], v201 offset:44288
    v_exp_f32 v84, v84
    v_exp_f32 v85, v85
    v_exp_f32 v86, v86
    v_exp_f32 v87, v87
    v_cvt_pk_bf16_f32 v104, v84, v85
    v_cvt_pk_bf16_f32 v105, v86, v87
    v_mfma_f32_32x32x16_bf16 v[108:123], a[68:71], v[96:99], v[108:123]
    buffer_load_dwordx4 v202, s[4:7], s95 offen offset:2048 lds
    v_exp_f32 v88, v88
    v_exp_f32 v89, v89
    v_exp_f32 v90, v90
    v_exp_f32 v91, v91
    v_cvt_pk_bf16_f32 v106, v88, v89
    v_cvt_pk_bf16_f32 v107, v90, v91
    v_mfma_f32_32x32x16_bf16 v[76:91], a[40:43], v[52:55], 0
    ds_read_b128 a[48:51], v200 offset:41216
    v_exp_f32 v60, v60
    v_exp_f32 v61, v61
    v_exp_f32 v62, v62
    v_exp_f32 v63, v63
    v_cvt_pk_bf16_f32 v92, v60, v61
    v_cvt_pk_bf16_f32 v93, v62, v63
    v_mfma_f32_32x32x8_bf16 v[76:91], a[44:45], v[56:57], v[76:91]
    buffer_load_dwordx4 v202, s[4:7], s95 offen offset:3072 lds
    v_exp_f32 v64, v64
    v_exp_f32 v65, v65
    v_exp_f32 v66, v66
    v_exp_f32 v67, v67
    v_cvt_pk_bf16_f32 v94, v64, v65
    v_cvt_pk_bf16_f32 v95, v66, v67
    v_mfma_f32_32x32x16_bf16 v[124:139], a[64:67], v[100:103], v[124:139]
    ds_read_b128 a[52:55], v200 offset:42240
    v_exp_f32 v68, v68
    v_exp_f32 v69, v69
    v_exp_f32 v70, v70
    v_exp_f32 v71, v71
    v_cvt_pk_bf16_f32 v96, v68, v69
    v_cvt_pk_bf16_f32 v97, v70, v71
    v_mfma_f32_32x32x16_bf16 v[124:139], a[68:71], v[104:107], v[124:139]
    s_sub_u32 s87, s87, 1
    s_waitcnt vmcnt(12) lgkmcnt(4)
    s_barrier
    s_bitcmp1_b32 s84, s87
    s_cbranch_scc1 L_hook_38
L_back_43:
    s_nop 0
    s_add_u32 s86, s86, 13312
    s_add_u32 m0, s85, 26624
    s_add_u32 s95, s95, s75
    s_add_u32 s76, s76, s75
    v_exp_f32 v72, v72
    v_exp_f32 v73, v73
    v_exp_f32 v74, v74
    v_exp_f32 v75, v75
    v_cvt_pk_bf16_f32 v98, v72, v73
    v_cvt_pk_bf16_f32 v99, v74, v75
    v_mfma_f32_32x32x16_bf16 v[60:75], a[16:19], v[44:47], 0
    ds_read_b128 a[32:35], v200 offset:46592
    v_exp_f32 v76, v76
    v_exp_f32 v77, v77
    v_exp_f32 v78, v78
    v_exp_f32 v79, v79
    v_cvt_pk_bf16_f32 v100, v76, v77
    v_cvt_pk_bf16_f32 v101, v78, v79
    v_mfma_f32_32x32x8_bf16 v[60:75], a[20:21], v[48:49], v[60:75]
    v_exp_f32 v80, v80
    v_exp_f32 v81, v81
    v_exp_f32 v82, v82
    v_exp_f32 v83, v83
    v_cvt_pk_bf16_f32 v102, v80, v81
    v_cvt_pk_bf16_f32 v103, v82, v83
    v_mfma_f32_32x32x16_bf16 v[108:123], a[72:75], v[92:95], v[108:123]
    ds_read_b64 a[36:37], v201 offset:47616
    v_exp_f32 v84, v84
    v_exp_f32 v85, v85
    v_exp_f32 v86, v86
    v_exp_f32 v87, v87
    v_cvt_pk_bf16_f32 v104, v84, v85
    v_cvt_pk_bf16_f32 v105, v86, v87
    v_mfma_f32_32x32x16_bf16 v[108:123], a[76:79], v[96:99], v[108:123]
    buffer_load_dwordx4 v3, s[4:7], s86 offen offset:0 lds
    v_exp_f32 v88, v88
    v_exp_f32 v89, v89
    v_exp_f32 v90, v90
    v_exp_f32 v91, v91
    v_cvt_pk_bf16_f32 v106, v88, v89
    v_cvt_pk_bf16_f32 v107, v90, v91
    v_mfma_f32_32x32x16_bf16 v[76:91], a[16:19], v[52:55], 0
    ds_read_b128 a[56:59], v200 offset:44544
    v_exp_f32 v60, v60
    v_exp_f32 v61, v61
    v_exp_f32 v62, v62
    v_exp_f32 v63, v63
    v_cvt_pk_bf16_f32 v92, v60, v61
    v_cvt_pk_bf16_f32 v93, v62, v63
    v_mfma_f32_32x32x8_bf16 v[76:91], a[20:21], v[56:57], v[76:91]
    buffer_load_dwordx4 v3, s[4:7], s86 offen offset:1024 lds
    v_exp_f32 v64, v64
    v_exp_f32 v65, v65
    v_exp_f32 v66, v66
    v_exp_f32 v67, v67
    v_cvt_pk_bf16_f32 v94, v64, v65
    v_cvt_pk_bf16_f32 v95, v66, v67
    v_mfma_f32_32x32x16_bf16 v[124:139], a[72:75], v[100:103], v[124:139]
    ds_read_b128 a[60:63], v200 offset:45568
    v_exp_f32 v68, v68
    v_exp_f32 v69, v69
    v_exp_f32 v70, v70
    v_exp_f32 v71, v71
    v_cvt_pk_bf16_f32 v96, v68, v69
    v_cvt_pk_bf16_f32 v97, v70, v71
    v_mfma_f32_32x32x16_bf16 v[124:139], a[76:79], v[104:107], v[124:139]
    s_waitcnt lgkmcnt(4)
    v_exp_f32 v72, v72
    v_exp_f32 v73, v73
    v_exp_f32 v74, v74
    v_exp_f32_e64 v75, v75
    v_cvt_pk_bf16_f32 v98, v72, v73
    v_cvt_pk_bf16_f32 v99, v74, v75
    v_mfma_f32_32x32x16_bf16 v[60:75], a[24:27], v[44:47], 0
    ds_read_b128 a[40:43], v200 offset:49920
    v_exp_f32 v76, v76
    v_exp_f32 v77, v77
    v_exp_f32 v78, v78
    v_exp_f32 v79, v79
    v_cvt_pk_bf16_f32 v100, v76, v77
    v_cvt_pk_bf16_f32 v101, v78, v79
    v_mfma_f32_32x32x8_bf16 v[60:75], a[28:29], v[48:49], v[60:75]
    v_exp_f32 v80, v80
    v_exp_f32 v81, v81
    v_exp_f32 v82, v82
    v_exp_f32 v83, v83
    v_cvt_pk_bf16_f32 v102, v80, v81
    v_cvt_pk_bf16_f32 v103, v82, v83
    v_mfma_f32_32x32x16_bf16 v[108:123], a[48:51], v[92:95], v[108:123]
    ds_read_b64 a[44:45], v201 offset:50944
    v_exp_f32 v84, v84
    v_exp_f32 v85, v85
    v_exp_f32 v86, v86
    v_exp_f32 v87, v87
    v_cvt_pk_bf16_f32 v104, v84, v85
    v_cvt_pk_bf16_f32 v105, v86, v87
    v_mfma_f32_32x32x16_bf16 v[108:123], a[52:55], v[96:99], v[108:123]
    buffer_load_dwordx4 v3, s[4:7], s86 offen offset:2048 lds
    v_exp_f32 v88, v88
    v_exp_f32 v89, v89
    v_exp_f32 v90, v90
    v_exp_f32 v91, v91
    v_cvt_pk_bf16_f32 v106, v88, v89
    v_cvt_pk_bf16_f32 v107, v90, v91
    v_mfma_f32_32x32x16_bf16 v[76:91], a[24:27], v[52:55], 0
    ds_read_b128 a[64:67], v200 offset:47872
    v_exp_f32 v60, v60
    v_exp_f32 v61, v61
    v_exp_f32 v62, v62
    v_exp_f32 v63, v63
    v_cvt_pk_bf16_f32 v92, v60, v61
    v_cvt_pk_bf16_f32 v93, v62, v63
    v_mfma_f32_32x32x8_bf16 v[76:91], a[28:29], v[56:57], v[76:91]
    s_mov_b64 exec, 0xffff
    buffer_load_dwordx4 v3, s[4:7], s86 offen offset:3072 lds
    s_mov_b64 exec, -1
    s_mov_b32 m0, s76
    v_exp_f32 v64, v64
    v_exp_f32 v65, v65
    v_exp_f32 v66, v66
    v_exp_f32 v67, v67
    v_cvt_pk_bf16_f32 v94, v64, v65
    v_cvt_pk_bf16_f32 v95, v66, v67
    v_mfma_f32_32x32x16_bf16 v[124:139], a[48:51], v[100:103], v[124:139]
    ds_read_b128 a[68:71], v200 offset:48896
    v_exp_f32 v68, v68
    v_exp_f32 v69, v69
    v_exp_f32 v70, v70
    v_exp_f32 v71, v71
    v_cvt_pk_bf16_f32 v96, v68, v69
    v_cvt_pk_bf16_f32 v97, v70, v71
    v_mfma_f32_32x32x16_bf16 v[124:139], a[52:55], v[104:107], v[124:139]
    s_waitcnt lgkmcnt(4)
    v_exp_f32 v72, v72
    v_exp_f32 v73, v73
    v_exp_f32 v74, v74
    v_exp_f32_e64 v75, v75
    v_cvt_pk_bf16_f32 v98, v72, v73
    v_cvt_pk_bf16_f32 v99, v74, v75
    v_mfma_f32_32x32x16_bf16 v[60:75], a[32:35], v[44:47], 0
    ds_read_b128 a[16:19], v200 offset:0
    v_exp_f32 v76, v76
    v_exp_f32 v77, v77
    v_exp_f32 v78, v78
    v_exp_f32 v79, v79
    v_cvt_pk_bf16_f32 v100, v76, v77
    v_cvt_pk_bf16_f32 v101, v78, v79
    v_mfma_f32_32x32x8_bf16 v[60:75], a[36:37], v[48:49], v[60:75]
    v_exp_f32 v80, v80
    v_exp_f32 v81, v81
    v_exp_f32 v82, v82
    v_exp_f32 v83, v83
    v_cvt_pk_bf16_f32 v102, v80, v81
    v_cvt_pk_bf16_f32 v103, v82, v83
    v_mfma_f32_32x32x16_bf16 v[108:123], a[56:59], v[92:95], v[108:123]
    ds_read_b64 a[20:21], v201 offset:1024
    v_exp_f32 v84, v84
    v_exp_f32 v85, v85
    v_exp_f32 v86, v86
    v_exp_f32 v87, v87
    v_cvt_pk_bf16_f32 v104, v84, v85
    v_cvt_pk_bf16_f32 v105, v86, v87
    v_mfma_f32_32x32x16_bf16 v[108:123], a[60:63], v[96:99], v[108:123]
    buffer_load_dwordx4 v202, s[4:7], s95 offen offset:0 lds
    v_exp_f32 v88, v88
    v_exp_f32 v89, v89
    v_exp_f32 v90, v90
    v_exp_f32 v91, v91
    v_cvt_pk_bf16_f32 v106, v88, v89
    v_cvt_pk_bf16_f32 v107, v90, v91
    v_mfma_f32_32x32x16_bf16 v[76:91], a[32:35], v[52:55], 0
    ds_read_b128 a[72:75], v200 offset:51200
    v_exp_f32 v60, v60
    v_exp_f32 v61, v61
    v_exp_f32 v62, v62
    v_exp_f32 v63, v63
    v_cvt_pk_bf16_f32 v92, v60, v61
    v_cvt_pk_bf16_f32 v93, v62, v63
    v_mfma_f32_32x32x8_bf16 v[76:91], a[36:37], v[56:57], v[76:91]
    buffer_load_dwordx4 v202, s[4:7], s95 offen offset:1024 lds
    v_exp_f32 v64, v64
    v_exp_f32 v65, v65
    v_exp_f32 v66, v66
    v_exp_f32 v67, v67
    v_cvt_pk_bf16_f32 v94, v64, v65
    v_cvt_pk_bf16_f32 v95, v66, v67
    v_mfma_f32_32x32x16_bf16 v[124:139], a[56:59], v[100:103], v[124:139]
    ds_read_b128 a[76:79], v200 offset:52224
    v_exp_f32 v68, v68
    v_exp_f32 v69, v69
    v_exp_f32 v70, v70
    v_exp_f32 v71, v71
    v_cvt_pk_bf16_f32 v96, v68, v69
    v_cvt_pk_bf16_f32 v97, v70, v71
    v_mfma_f32_32x32x16_bf16 v[124:139], a[60:63], v[104:107], v[124:139]
    s_waitcnt lgkmcnt(4)
    v_exp_f32 v72, v72
    v_exp_f32 v73, v73
    v_exp_f32 v74, v74
    v_exp_f32_e64 v75, v75
    v_cvt_pk_bf16_f32 v98, v72, v73
    v_cvt_pk_bf16_f32 v99, v74, v75
    v_mfma_f32_32x32x16_bf16 v[60:75], a[40:43], v[44:47], 0
    ds_read_b128 a[24:27], v200 offset:3328
    v_exp_f32 v76, v76
    v_exp_f32 v77, v77
    v_exp_f32 v78, v78
    v_exp_f32 v79, v79
    v_cvt_pk_bf16_f32 v100, v76, v77
    v_cvt_pk_bf16_f32 v101, v78, v79
    v_mfma_f32_32x32x8_bf16 v[60:75], a[44:45], v[48:49], v[60:75]
    v_exp_f32 v80, v80
    v_exp_f32 v81, v81
    v_exp_f32 v82, v82
    v_exp_f32 v83, v83
    v_cvt_pk_bf16_f32 v102, v80, v81
    v_cvt_pk_bf16_f32 v103, v82, v83
    v_mfma_f32_32x32x16_bf16 v[108:123], a[64:67], v[92:95], v[108:123]
    ds_read_b64 a[28:29], v201 offset:4352
    v_exp_f32 v84, v84
    v_exp_f32 v85, v85
    v_exp_f32 v86, v86
    v_exp_f32 v87, v87
    v_cvt_pk_bf16_f32 v104, v84, v85
    v_cvt_pk_bf16_f32 v105, v86, v87
    v_mfma_f32_32x32x16_bf16 v[108:123], a[68:71], v[96:99], v[108:123]
    buffer_load_dwordx4 v202, s[4:7], s95 offen offset:2048 lds
    v_exp_f32 v88, v88
    v_exp_f32 v89, v89
    v_exp_f32 v90, v90
    v_exp_f32 v91, v91
    v_cvt_pk_bf16_f32 v106, v88, v89
    v_cvt_pk_bf16_f32 v107, v90, v91
    v_mfma_f32_32x32x16_bf16 v[76:91], a[40:43], v[52:55], 0
    ds_read_b128 a[48:51], v200 offset:1280
    v_exp_f32 v60, v60
    v_exp_f32 v61, v61
    v_exp_f32 v62, v62
    v_exp_f32 v63, v63
    v_cvt_pk_bf16_f32 v92, v60, v61
    v_cvt_pk_bf16_f32 v93, v62, v63
    v_mfma_f32_32x32x8_bf16 v[76:91], a[44:45], v[56:57], v[76:91]
    buffer_load_dwordx4 v202, s[4:7], s95 offen offset:3072 lds
    v_exp_f32 v64, v64
    v_exp_f32 v65, v65
    v_exp_f32 v66, v66
    v_exp_f32 v67, v67
    v_cvt_pk_bf16_f32 v94, v64, v65
    v_cvt_pk_bf16_f32 v95, v66, v67
    v_mfma_f32_32x32x16_bf16 v[124:139], a[64:67], v[100:103], v[124:139]
    ds_read_b128 a[52:55], v200 offset:2304
    v_exp_f32 v68, v68
    v_exp_f32 v69, v69
    v_exp_f32 v70, v70
    v_exp_f32 v71, v71
    v_cvt_pk_bf16_f32 v96, v68, v69
    v_cvt_pk_bf16_f32 v97, v70, v71
    v_mfma_f32_32x32x16_bf16 v[124:139], a[68:71], v[104:107], v[124:139]
    s_sub_u32 s87, s87, 1
    s_waitcnt vmcnt(12) lgkmcnt(4)
    s_barrier
    s_bitcmp1_b32 s84, s87
    s_cbranch_scc1 L_hook_35
L_back_40:
    s_nop 0
    s_add_u32 s86, s86, 13312
    s_add_u32 m0, s85, 39936
    s_add_u32 s95, s95, s75
    s_add_u32 s76, s76, s75
    v_exp_f32 v72, v72
    v_exp_f32 v73, v73
    v_exp_f32 v74, v74
    v_exp_f32 v75, v75
    v_cvt_pk_bf16_f32 v98, v72, v73
    v_cvt_pk_bf16_f32 v99, v74, v75
    s_cmp_lg_u32 s87, 0
    s_cbranch_scc1 L_att_34
    s_waitcnt lgkmcnt(0)
    v_exp_f32 v76, v76
    v_exp_f32 v77, v77
    v_exp_f32 v78, v78
    v_exp_f32_e64 v79, v79
    v_cvt_pk_bf16_f32 v100, v76, v77
    v_cvt_pk_bf16_f32 v101, v78, v79
    v_exp_f32 v80, v80
    v_exp_f32 v81, v81
    v_exp_f32 v82, v82
    v_exp_f32 v83, v83
    v_cvt_pk_bf16_f32 v102, v80, v81
    v_cvt_pk_bf16_f32 v103, v82, v83
    v_mfma_f32_32x32x16_bf16 v[108:123], a[72:75], v[92:95], v[108:123]
    v_exp_f32 v84, v84
    v_exp_f32 v85, v85
    v_exp_f32 v86, v86
    v_exp_f32 v87, v87
    v_cvt_pk_bf16_f32 v104, v84, v85
    v_cvt_pk_bf16_f32 v105, v86, v87
    v_mfma_f32_32x32x16_bf16 v[108:123], a[76:79], v[96:99], v[108:123]
    v_exp_f32 v88, v88
    v_exp_f32 v89, v89
    v_exp_f32 v90, v90
    v_exp_f32 v91, v91
    v_cvt_pk_bf16_f32 v106, v88, v89
    v_cvt_pk_bf16_f32 v107, v90, v91
    v_mfma_f32_32x32x16_bf16 v[124:139], a[72:75], v[100:103], v[124:139]
    s_nop 0
    v_mfma_f32_32x32x16_bf16 v[124:139], a[76:79], v[104:107], v[124:139]
    s_cmp_lg_u32 s77, 0
    s_cbranch_scc1 L_slow_28
    s_branch L_adone_29
L_hook_39:
    s_lshr_b32 s95, s24, 2
    s_mul_i32 s95, s95, 327680
    s_and_b32 s68, s24, 3
    s_lshl_b32 s68, s68, 3
    s_add_u32 s68, s68, s23
    s_lshl_b32 s68, s68, 2
    s_add_u32 s68, s68, s22
    s_mul_i32 s68, s68, 2560
    s_add_u32 s95, s95, s68
    s_nop 0
    s_add_u32 s95, s95, 2097152
    s_mov_b32 s76, 106496
    s_branch L_ent_44
L_hook_35:
    s_cmp_lg_u32 s87, 8
    s_cbranch_scc1 L_hk_45
    s_and_b32 s67, s24, 28
    s_lshl_b32 s67, s67, 7
    s_add_u32 s67, s67, 27066368
    v_and_b32 v251, 31, v0
    v_lshlrev_b32_e64 v251, 4, v251
    buffer_load_dwordx4 v[240:243], v251, s[4:7], s67 offen sc1
    s_cmp_lg_u32 s22, 0
    s_cbranch_scc1 L_rpi_46
    v_lshlrev_b32_e64 v250, 7, v0
    s_mov_b32 s67, 32768
    buffer_load_dwordx2 v[232:233], v250, s[4:7], s67 offen sc1
    s_mov_b32 s67, 40960
    buffer_load_dwordx2 v[234:235], v250, s[4:7], s67 offen sc1
    s_mov_b32 s67, 49152
    buffer_load_dwordx2 v[236:237], v250, s[4:7], s67 offen sc1
    s_mov_b32 s67, 57344
    buffer_load_dwordx2 v[238:239], v250, s[4:7], s67 offen sc1
L_rpi_46:
    s_lshl_b32 s93, s22, 12
    s_nop 0
    s_mul_i32 s90, s23, 311296
    s_add_u32 s90, s90, 19660800
    s_add_u32 s90, s90, s93
    s_and_b32 s91, s24, 1
    s_lshl_b32 s91, s91, 3
    s_add_u32 s91, s91, s23
    s_mul_i32 s91, s91, 147456
    s_add_u32 s91, s91, 22151168
    s_add_u32 s91, s91, s93
    s_nop 0
    s_mul_i32 s92, s23, 278528
    s_add_u32 s92, s92, 24510464
    s_add_u32 s92, s92, s93
    s_branch L_back_40
L_hk_45:
    v_lshlrev_b32_e64 v246, 7, v0
    s_and_b32 s66, s24, 3
    s_lshr_b32 s67, s66, 0
    s_lshl_b32 s67, s67, 2
    s_add_u32 s67, s67, s22
    s_lshl_b32 s67, s67, 1
    s_add_u32 s67, s67, 1
    s_mul_i32 s67, s67, 6656
    s_add_u32 s67, s67, s90
    s_sub_u32 s67, s67, s93
    s_add_u32 s67, s67, 98304
    v_cmp_gt_u32 vcc, 52, v0
    s_and_saveexec_b64 s[68:69], vcc
    buffer_load_dword a254, v246, s[4:7], s67 offen
    s_mov_b64 exec, s[68:69]
    s_branch L_back_40
L_hook_36:
    s_cmp_lg_u32 s87, 15
    s_cbranch_scc1 L_hk_47
    s_lshl_b32 s66, s25, 2
    s_add_u32 s66, s66, s22
    s_mov_b32 s82, 2
    s_cmp_lt_u32 s23, 6
    s_cbranch_scc1 L_re_51
    s_lshl_b32 s66, s24, 1
    s_add_u32 s66, s66, s23
    s_sub_u32 s66, s66, 6
    s_lshl_b32 s66, s66, 2
    s_add_u32 s66, s66, s22
    s_add_u32 s66, s66, 1024
    s_cmp_ge_u32 s66, 1232
    s_cbranch_scc1 L_re_51
    s_branch L_r3_49
L_r3_49:
    s_sub_u32 s66, s66, 912
    s_mov_b32 s8, s48
    s_mov_b32 s9, s49
    s_mov_b32 s10, 2211840
    s_mov_b32 s11, 0x20000
    s_mov_b32 s82, 1
    s_mul_i32 s68, s66, 3277
    s_lshr_b32 s68, s68, 16
    s_mul_i32 s69, s68, 20
    s_sub_u32 s66, s66, s69
    s_mul_i32 s69, s68, 147456
    s_add_u32 s69, s69, 22151168
    s_mul_i32 s67, s66, 7168
    s_add_u32 s83, s67, s69
    s_mul_i32 s67, s66, 7168
    s_add_u32 s67, s67, s69
    s_add_u32 s73, s67, 4096
    s_mul_i32 s67, s68, 7
    s_sub_u32 s69, s68, 12
    s_max_i32 s69, s69, 0
    s_sub_u32 s67, s67, s69
    s_lshl_b32 s67, s67, 5
    s_mul_i32 s66, s66, 110592
    s_add_u32 s66, s66, s67
    s_mul_i32 s67, s22, 14336
    s_add_u32 s67, s67, 7168
    v_add_u32_e64 v12, 0, v0
    v_mul_u32_u24 v13, 4682, v12
    v_lshrrev_b32_e64 v13, 16, v13
    v_mul_u32_u24 v4, 3232, v13
    v_lshl_add_u32 v4, v12, 4, v4
    v_add_u32_e64 v12, 64, v0
    v_mul_u32_u24 v13, 4682, v12
    v_lshrrev_b32_e64 v13, 16, v13
    v_mul_u32_u24 v5, 3232, v13
    v_lshl_add_u32 v5, v12, 4, v5
    v_add_u32 v12, 128, v0
    v_mul_u32_u24 v13, 4682, v12
    v_lshrrev_b32_e64 v13, 16, v13
    v_mul_u32_u24 v6, 3232, v13
    v_lshl_add_u32 v6, v12, 4, v6
    v_add_u32 v12, 192, v0
    v_mul_u32_u24 v13, 4682, v12
    v_lshrrev_b32_e64 v13, 16, v13
    v_mul_u32_u24 v7, 3232, v13
    v_lshl_add_u32 v7, v12, 4, v7
    v_add_u32 v12, 256, v0
    v_mul_u32_u24 v13, 4682, v12
    v_lshrrev_b32_e64 v13, 16, v13
    v_mul_u32_u24 v8, 3232, v13
    v_lshl_add_u32 v8, v12, 4, v8
    v_add_u32 v12, 320, v0
    v_mul_u32_u24 v13, 4682, v12
    v_lshrrev_b32_e64 v13, 16, v13
    v_mul_u32_u24 v9, 3232, v13
    v_lshl_add_u32 v9, v12, 4, v9
    v_add_u32 v12, 384, v0
    v_mul_u32_u24 v13, 4682, v12
    v_lshrrev_b32_e64 v13, 16, v13
    v_mul_u32_u24 v10, 3232, v13
    v_lshl_add_u32 v10, v12, 4, v10
    s_mov_b32 m0, s67
    s_nop 0
    s_add_u32 s67, s67, 1024
    buffer_load_dwordx4 v4, s[8:11], s66 offen lds
    s_mov_b32 m0, s67
    s_nop 0
    s_add_u32 s67, s67, 1024
    buffer_load_dwordx4 v5, s[8:11], s66 offen lds
    s_mov_b32 m0, s67
    s_nop 0
    s_add_u32 s67, s67, 1024
    buffer_load_dwordx4 v6, s[8:11], s66 offen lds
    s_mov_b32 m0, s67
    s_nop 0
    s_add_u32 s67, s67, 1024
    buffer_load_dwordx4 v7, s[8:11], s66 offen lds
    s_mov_b32 m0, s67
    s_nop 0
    s_add_u32 s67, s67, 1024
    buffer_load_dwordx4 v8, s[8:11], s66 offen lds
    s_mov_b32 m0, s67
    s_nop 0
    s_add_u32 s67, s67, 1024
    buffer_load_dwordx4 v9, s[8:11], s66 offen lds
    s_mov_b32 m0, s67
    s_nop 0
    s_add_u32 s67, s67, 1024
    buffer_load_dwordx4 v10, s[8:11], s66 offen lds
    v_lshrrev_b32_e64 v40, 2, v1
    v_lshl_add_u32 v40, v2, 2, v40
    v_mul_u32_u24 v40, 224, v40
L_re_51_tr:
    v_and_b32_e64 v12, 3, v1
    v_lshl_add_u32 v40, v12, 3, v40
    s_mul_i32 s67, s22, 14336
    s_add_u32 s67, s67, 7168
    v_add_u32 v40, s67, v40
L_re_51:
    s_lshr_b32 s95, s24, 2
    s_mul_i32 s95, s95, 327680
    s_and_b32 s68, s24, 3
    s_lshl_b32 s68, s68, 3
    s_add_u32 s68, s68, s23
    s_lshl_b32 s68, s68, 2
    s_add_u32 s68, s68, s22
    s_mul_i32 s68, s68, 2560
    s_add_u32 s95, s95, s68
    s_add_u32 s95, s95, 4718592
    s_mov_b32 s76, 106496
    s_branch L_back_41
L_hk_47:
    s_cmp_lg_u32 s87, 11
    s_cbranch_scc1 L_hk_52
    s_waitcnt vmcnt(16)
    s_barrier
    s_cmp_lg_u32 s22, 0
    s_cbranch_scc1 L_rlp_53
    v_mov_b32 v252, s20
    v_mov_b32 v253, s21
    s_lshl_b32 s66, s25, 7
    s_add_u32 s66, s66, 32768
    v_mov_b32 v251, s66
    s_mov_b64 exec, 1
    buffer_store_dwordx2 v[252:253], v251, s[4:7], 0 offen sc1
    s_mov_b64 exec, -1
L_rlp_53:
    s_branch L_back_41
L_hk_52:
    s_waitcnt vmcnt(8)
    s_cmp_lg_u32 s22, 0
    s_cbranch_scc1 L_rw_54
    s_mov_b32 s66, 400000
L_rwp_55:
    s_mov_b64 s[68:69], 0
    v_cmp_ne_u32 vcc, s20, v232
    s_or_b64 s[68:69], s[68:69], vcc
    v_cmp_ne_u32 vcc, s21, v233
    s_or_b64 s[68:69], s[68:69], vcc
    v_cmp_ne_u32 vcc, s20, v234
    s_or_b64 s[68:69], s[68:69], vcc
    v_cmp_ne_u32 vcc, s21, v235
    s_or_b64 s[68:69], s[68:69], vcc
    v_cmp_ne_u32 vcc, s20, v236
    s_or_b64 s[68:69], s[68:69], vcc
    v_cmp_ne_u32 vcc, s21, v237
    s_or_b64 s[68:69], s[68:69], vcc
    v_cmp_ne_u32 vcc, s20, v238
    s_or_b64 s[68:69], s[68:69], vcc
    v_cmp_ne_u32 vcc, s21, v239
    s_or_b64 s[68:69], s[68:69], vcc
    s_cmp_eq_u64 s[68:69], 0
    s_cbranch_scc1 L_rwok_56
    s_cmp_lg_u32 s22, 0
    s_cbranch_scc1 L_rpi_57
    v_lshlrev_b32_e64 v250, 7, v0
    s_mov_b32 s67, 32768
    buffer_load_dwordx2 v[232:233], v250, s[4:7], s67 offen sc1
    s_mov_b32 s67, 40960
    buffer_load_dwordx2 v[234:235], v250, s[4:7], s67 offen sc1
    s_mov_b32 s67, 49152
    buffer_load_dwordx2 v[236:237], v250, s[4:7], s67 offen sc1
    s_mov_b32 s67, 57344
    buffer_load_dwordx2 v[238:239], v250, s[4:7], s67 offen sc1
L_rpi_57:
    s_waitcnt vmcnt(0)
    s_sub_u32 s66, s66, 1
    s_cmp_lg_u32 s66, 0
    s_cbranch_scc1 L_rwp_55
    s_mov_b32 s28, 4
    s_branch L_fail
L_rwok_56:
L_rw_54:
    s_barrier
    s_nop 0
    s_add_u32 s95, s90, 4294950912
    s_add_u32 s76, s93, 4294950912
    s_mov_b32 s75, 16384
    s_branch L_back_41
L_hook_37:
    s_cmp_lg_u32 s87, 14
    s_cbranch_scc1 L_hk_58
    s_cmp_ge_u32 s22, 2
    s_cbranch_scc1 L_j14_59
    s_waitcnt vmcnt(16)
    s_cmp_eq_u32 s78, 2
    s_cbranch_scc1 L_rse_61
    s_cmp_eq_u32 s78, 1
    s_cbranch_scc1 L_rs7_60
    ds_read_b64_tr_b16 v[12:13], v11 offset:0
    ds_read_b64_tr_b16 v[14:15], v11 offset:2560
    ds_read_b64_tr_b16 v[16:17], v11 offset:32
    ds_read_b64_tr_b16 v[18:19], v11 offset:2592
    ds_read_b64_tr_b16 v[20:21], v11 offset:64
    ds_read_b64_tr_b16 v[22:23], v11 offset:2624
    ds_read_b64_tr_b16 v[24:25], v11 offset:96
    ds_read_b64_tr_b16 v[26:27], v11 offset:2656
    ds_read_b64_tr_b16 v[28:29], v11 offset:128
    ds_read_b64_tr_b16 v[30:31], v11 offset:2688
    s_add_u32 s66, s79, 4096
    s_waitcnt lgkmcnt(0)
    s_nop 0
    buffer_store_dwordx4 v[12:15], v3, s[4:7], s79 offen offset:0 sc1
    buffer_store_dwordx4 v[16:19], v3, s[4:7], s79 offen offset:1024 sc1
    buffer_store_dwordx4 v[20:23], v3, s[4:7], s79 offen offset:2048 sc1
    buffer_store_dwordx4 v[24:27], v3, s[4:7], s79 offen offset:3072 sc1
    buffer_store_dwordx4 v[28:31], v3, s[4:7], s66 offen offset:0 sc1
    s_branch L_rse_61
L_rs7_60:
    s_nop 0
    ds_read_b64_tr_b16 v[12:13], v11 offset:0
    ds_read_b64_tr_b16 v[14:15], v11 offset:3584
    ds_read_b64_tr_b16 v[16:17], v11 offset:32
    ds_read_b64_tr_b16 v[18:19], v11 offset:3616
    ds_read_b64_tr_b16 v[20:21], v11 offset:64
    ds_read_b64_tr_b16 v[22:23], v11 offset:3648
    ds_read_b64_tr_b16 v[24:25], v11 offset:96
    ds_read_b64_tr_b16 v[26:27], v11 offset:3680
    ds_read_b64_tr_b16 v[28:29], v11 offset:128
    ds_read_b64_tr_b16 v[30:31], v11 offset:3712
    ds_read_b64_tr_b16 v[32:33], v11 offset:160
    ds_read_b64_tr_b16 v[34:35], v11 offset:3744
    ds_read_b64_tr_b16 v[36:37], v11 offset:192
    ds_read_b64_tr_b16 v[38:39], v11 offset:3776
    s_mov_b32 s66, s74
    s_waitcnt lgkmcnt(0)
    buffer_store_dwordx4 v[12:15], v3, s[4:7], s79 offen offset:0 sc1
    buffer_store_dwordx4 v[16:19], v3, s[4:7], s79 offen offset:1024 sc1
    buffer_store_dwordx4 v[20:23], v3, s[4:7], s79 offen offset:2048 sc1
    buffer_store_dwordx4 v[24:27], v3, s[4:7], s79 offen offset:3072 sc1
    buffer_store_dwordx4 v[28:31], v3, s[4:7], s66 offen offset:0 sc1
    buffer_store_dwordx4 v[32:35], v3, s[4:7], s66 offen offset:1024 sc1
    buffer_store_dwordx4 v[36:39], v3, s[4:7], s66 offen offset:2048 sc1
L_rse_61:
L_j14_59:
    s_mov_b32 s95, 1048576
    s_mov_b32 s76, 106496
    s_branch L_back_42
L_hk_58:
    s_cmp_lg_u32 s87, 10
    s_cbranch_scc1 L_hk_62
    s_nop 0
    s_mov_b32 s95, 1048576
    s_mov_b32 s76, 106496
    s_branch L_back_42
L_hk_62:
    s_cmp_lg_u32 s87, 6
    s_cbranch_scc1 L_hk_63
    v_lshlrev_b32 v246, 7, v0
    s_and_b32 s66, s24, 3
    s_lshr_b32 s67, s66, 0
    s_lshl_b32 s67, s67, 2
    s_add_u32 s67, s67, s22
    s_lshl_b32 s67, s67, 1
    s_add_u32 s67, s67, 0
    s_mul_i32 s67, s67, 6656
    s_add_u32 s67, s67, s90
    s_sub_u32 s67, s67, s93
    s_add_u32 s67, s67, 98304
    v_cmp_gt_u32 vcc, 52, v0
    s_and_saveexec_b64 s[68:69], vcc
    buffer_load_dword a254, v246, s[4:7], s67 offen
    s_mov_b64 exec, s[68:69]
    s_branch L_back_42
L_hk_63:
    s_mov_b32 s66, 400000
L_xc_64:
    v_cmp_ne_u32 vcc, s20, v242
    s_mov_b64 s[68:69], vcc
    v_cmp_ne_u32 vcc, s21, v243
    s_or_b64 s[68:69], s[68:69], vcc
    s_cmp_eq_u64 s[68:69], 0
    s_cbranch_scc1 L_xcok_65
    s_and_b32 s67, s24, 28
    s_lshl_b32 s67, s67, 7
    s_add_u32 s67, s67, 27066368
    v_and_b32 v251, 31, v0
    v_lshlrev_b32 v251, 4, v251
    buffer_load_dwordx4 v[240:243], v251, s[4:7], s67 offen sc1
    s_waitcnt vmcnt(0)
    s_sub_u32 s66, s66, 1
    s_cmp_lg_u32 s66, 0
    s_cbranch_scc1 L_xc_64
    s_mov_b32 s28, 14
    s_branch L_fail
L_xcok_65:
    s_getreg_b32 s66, hwreg(HW_REG_XCC_ID)
    s_and_b32 s66, s66, 15
    v_cmp_ne_u32 vcc, s66, v240
    s_cmp_eq_u64 vcc, 0
    s_cselect_b32 s3, 1, 0
    s_branch L_back_42
L_hook_38:
    s_cmp_lg_u32 s87, 13
    s_cbranch_scc1 L_hk_66
    s_waitcnt vmcnt(16)
    s_cmp_lt_u32 s22, 2
    s_cbranch_scc1 L_j13_67
    s_cmp_eq_u32 s78, 2
    s_cbranch_scc1 L_rse_69
    s_cmp_eq_u32 s78, 1
    s_cbranch_scc1 L_rs7_68
    s_nop 0
    ds_read_b64_tr_b16 v[12:13], v11 offset:0
    ds_read_b64_tr_b16 v[14:15], v11 offset:2560
    ds_read_b64_tr_b16 v[16:17], v11 offset:32
    ds_read_b64_tr_b16 v[18:19], v11 offset:2592
    ds_read_b64_tr_b16 v[20:21], v11 offset:64
    ds_read_b64_tr_b16 v[22:23], v11 offset:2624
    ds_read_b64_tr_b16 v[24:25], v11 offset:96
    ds_read_b64_tr_b16 v[26:27], v11 offset:2656
    ds_read_b64_tr_b16 v[28:29], v11 offset:128
    ds_read_b64_tr_b16 v[30:31], v11 offset:2688
    s_add_u32 s66, s79, 4096
    s_waitcnt lgkmcnt(0)
    s_nop 0
    buffer_store_dwordx4 v[12:15], v3, s[4:7], s79 offen offset:0 sc1
    buffer_store_dwordx4 v[16:19], v3, s[4:7], s79 offen offset:1024 sc1
    buffer_store_dwordx4 v[20:23], v3, s[4:7], s79 offen offset:2048 sc1
    buffer_store_dwordx4 v[24:27], v3, s[4:7], s79 offen offset:3072 sc1
    buffer_store_dwordx4 v[28:31], v3, s[4:7], s66 offen offset:0 sc1
    s_branch L_rse_69
L_rs7_68:
    s_nop 0
    ds_read_b64_tr_b16 v[12:13], v11 offset:0
    ds_read_b64_tr_b16 v[14:15], v11 offset:3584
    ds_read_b64_tr_b16 v[16:17], v11 offset:32
    ds_read_b64_tr_b16 v[18:19], v11 offset:3616
    ds_read_b64_tr_b16 v[20:21], v11 offset:64
    ds_read_b64_tr_b16 v[22:23], v11 offset:3648
    ds_read_b64_tr_b16 v[24:25], v11 offset:96
    ds_read_b64_tr_b16 v[26:27], v11 offset:3680
    ds_read_b64_tr_b16 v[28:29], v11 offset:128
    ds_read_b64_tr_b16 v[30:31], v11 offset:3712
    ds_read_b64_tr_b16 v[32:33], v11 offset:160
    ds_read_b64_tr_b16 v[34:35], v11 offset:3744
    ds_read_b64_tr_b16 v[36:37], v11 offset:192
    ds_read_b64_tr_b16 v[38:39], v11 offset:3776
    s_mov_b32 s66, s74
    s_waitcnt lgkmcnt(0)
    buffer_store_dwordx4 v[12:15], v3, s[4:7], s79 offen offset:0 sc1
    buffer_store_dwordx4 v[16:19], v3, s[4:7], s79 offen offset:1024 sc1
    buffer_store_dwordx4 v[20:23], v3, s[4:7], s79 offen offset:2048 sc1
    buffer_store_dwordx4 v[24:27], v3, s[4:7], s79 offen offset:3072 sc1
    buffer_store_dwordx4 v[28:31], v3, s[4:7], s66 offen offset:0 sc1
    buffer_store_dwordx4 v[32:35], v3, s[4:7], s66 offen offset:1024 sc1
    buffer_store_dwordx4 v[36:39], v3, s[4:7], s66 offen offset:2048 sc1
L_rse_69:
L_j13_67:
    s_cmp_eq_u32 s82, 2
    s_cbranch_scc1 L_rse_71
    s_cmp_eq_u32 s82, 1
    s_cbranch_scc1 L_rs7_70
    ds_read_b64_tr_b16 v[12:13], v40 offset:0
    ds_read_b64_tr_b16 v[14:15], v40 offset:2560
    ds_read_b64_tr_b16 v[16:17], v40 offset:32
    ds_read_b64_tr_b16 v[18:19], v40 offset:2592
    ds_read_b64_tr_b16 v[20:21], v40 offset:64
    ds_read_b64_tr_b16 v[22:23], v40 offset:2624
    ds_read_b64_tr_b16 v[24:25], v40 offset:96
    ds_read_b64_tr_b16 v[26:27], v40 offset:2656
    ds_read_b64_tr_b16 v[28:29], v40 offset:128
    ds_read_b64_tr_b16 v[30:31], v40 offset:2688
    s_add_u32 s66, s83, 4096
    s_waitcnt lgkmcnt(0)
    s_nop 0
    buffer_store_dwordx4 v[12:15], v3, s[4:7], s83 offen offset:0 sc1
    buffer_store_dwordx4 v[16:19], v3, s[4:7], s83 offen offset:1024 sc1
    buffer_store_dwordx4 v[20:23], v3, s[4:7], s83 offen offset:2048 sc1
    buffer_store_dwordx4 v[24:27], v3, s[4:7], s83 offen offset:3072 sc1
    buffer_store_dwordx4 v[28:31], v3, s[4:7], s66 offen offset:0 sc1
    s_branch L_rse_71
L_rs7_70:
    s_nop 0
    ds_read_b64_tr_b16 v[12:13], v40 offset:0
    ds_read_b64_tr_b16 v[14:15], v40 offset:3584
    ds_read_b64_tr_b16 v[16:17], v40 offset:32
    ds_read_b64_tr_b16 v[18:19], v40 offset:3616
    ds_read_b64_tr_b16 v[20:21], v40 offset:64
    ds_read_b64_tr_b16 v[22:23], v40 offset:3648
    ds_read_b64_tr_b16 v[24:25], v40 offset:96
    ds_read_b64_tr_b16 v[26:27], v40 offset:3680
    ds_read_b64_tr_b16 v[28:29], v40 offset:128
    ds_read_b64_tr_b16 v[30:31], v40 offset:3712
    ds_read_b64_tr_b16 v[32:33], v40 offset:160
    ds_read_b64_tr_b16 v[34:35], v40 offset:3744
    ds_read_b64_tr_b16 v[36:37], v40 offset:192
    ds_read_b64_tr_b16 v[38:39], v40 offset:3776
    s_mov_b32 s66, s73
    s_waitcnt lgkmcnt(0)
    buffer_store_dwordx4 v[12:15], v3, s[4:7], s83 offen offset:0 sc1
    buffer_store_dwordx4 v[16:19], v3, s[4:7], s83 offen offset:1024 sc1
    buffer_store_dwordx4 v[20:23], v3, s[4:7], s83 offen offset:2048 sc1
    buffer_store_dwordx4 v[24:27], v3, s[4:7], s83 offen offset:3072 sc1
    buffer_store_dwordx4 v[28:31], v3, s[4:7], s66 offen offset:0 sc1
    buffer_store_dwordx4 v[32:35], v3, s[4:7], s66 offen offset:1024 sc1
    buffer_store_dwordx4 v[36:39], v3, s[4:7], s66 offen offset:2048 sc1
L_rse_71:
    s_cmp_eq_u32 s22, 3
    s_cbranch_scc1 L_st3_72
    v_lshlrev_b32_e64 v245, 7, v0
    s_mul_i32 s67, s22, 262144
    s_lshl_b32 s68, s24, 13
    s_add_u32 s67, s67, s68
    s_add_u32 s67, s67, 131072
    buffer_load_dword a255, v245, s[4:7], s67 offen
    s_branch L_stj_73
L_st3_72:
    v_lshrrev_b32 v245, 4, v0
    v_lshlrev_b32 v245, 14, v245
    v_and_b32 v244, 15, v0
    v_lshl_add_u32 v245, v244, 7, v245
    s_and_b32 s67, s24, 28
    s_lshl_b32 s67, s67, 9
    s_add_u32 s67, s67, 27201536
    buffer_load_dword a255, v245, s[4:7], s67 offen
    s_add_u32 s67, s67, 65536
    v_lshlrev_b32_e64 v245, 7, v244
    buffer_load_dword a255, v245, s[4:7], s67 offen
L_stj_73:
    s_sub_u32 s67, s27, 1
    s_max_i32 s67, s67, 0
    s_lshl_b32 s67, s67, 7
    s_add_u32 s67, s67, 27103232
    v_lshlrev_b32_e64 v245, 7, v0
    s_mov_b64 exec, 7
    buffer_load_dword a255, v245, s[4:7], s67 offen
    s_mov_b64 exec, -1
    s_branch L_back_43
L_hk_66:
    v_mul_u32_u24 v245, 3277, v0
    v_lshrrev_b32_e64 v245, 16, v245
    v_mul_u32_u24 v202, 2240, v245
    v_add_u32_e64 v202, v202, v3
    s_mul_i32 s95, s23, 320
    s_add_u32 s95, s95, 5120
    s_mov_b32 s76, 98304
    s_mov_b32 s75, 0
    s_branch L_back_43
L_slow_28:
    s_nop 1
    v_mov_b32 v108, 0
    s_nop 6
    v_mov_b32 v124, 0
    v_mov_b32 v109, 0
    v_mov_b32 v125, 0
    v_mov_b32 v110, 0
    v_mov_b32 v126, 0
    v_mov_b32 v111, 0
    v_mov_b32 v127, 0
    v_mov_b32 v112, 0
    v_mov_b32 v128, 0
    v_mov_b32 v113, 0
    v_mov_b32 v129, 0
    v_mov_b32 v114, 0
    v_mov_b32 v130, 0
    v_mov_b32 v115, 0
    v_mov_b32 v131, 0
    v_mov_b32 v116, 0
    v_mov_b32 v132, 0
    v_mov_b32 v117, 0
    v_mov_b32 v133, 0
    v_mov_b32 v118, 0
    v_mov_b32 v134, 0
    v_mov_b32 v119, 0
    v_mov_b32 v135, 0
    v_mov_b32 v120, 0
    v_mov_b32 v136, 0
    v_mov_b32 v121, 0
    v_mov_b32 v137, 0
    v_mov_b32 v122, 0
    v_mov_b32 v138, 0
    v_mov_b32 v123, 0
    v_mov_b32 v139, 0
    v_mov_b32 v208, 0xff7fffff
    v_mov_b32 v209, 0xff7fffff
    s_mov_b32 s85, 1048576
    s_mov_b32 s87, 64
L_atts_74:
    s_nop 0
    buffer_load_dwordx4 a[16:19], v3, s[4:7], s85 offen
    buffer_load_dwordx2 a[20:21], v206, s[4:7], s85 offen offset:1024
    buffer_load_dwordx4 a[48:51], v3, s[4:7], s85 offen offset:1280
    buffer_load_dwordx4 a[52:55], v3, s[4:7], s85 offen offset:2304
    s_add_u32 s85, s85, 3328
    s_waitcnt vmcnt(0)
    s_nop 0
    v_mfma_f32_32x32x16_bf16 v[60:75], a[16:19], v[44:47], 0
    v_mfma_f32_32x32x8_bf16 v[60:75], a[20:21], v[48:49], v[60:75]
    s_nop 11
    s_nop 0
    v_max3_f32 v210, v60, v61, v62
    v_max3_f32 v210, v210, v63, v64
    v_max3_f32 v210, v210, v65, v66
    v_max3_f32 v210, v210, v67, v68
    v_max3_f32 v210, v210, v69, v70
    v_max3_f32 v210, v210, v71, v72
    v_max3_f32 v210, v210, v73, v74
    v_max_f32 v210, v210, v75
    v_mov_b32 v211, v210
    s_nop 1
    v_permlane32_swap_b32 v210, v211
    v_max_f32 v210, v210, v211
    v_max_f32 v210, v210, v208
    v_sub_f32 v211, v208, v210
    v_exp_f32 v211, v211
    v_mov_b32 v208, v210
    v_mul_f32 v108, v108, v211
    v_mul_f32 v109, v109, v211
    v_mul_f32 v110, v110, v211
    v_mul_f32 v111, v111, v211
    v_mul_f32 v112, v112, v211
    v_mul_f32 v113, v113, v211
    v_mul_f32 v114, v114, v211
    v_mul_f32 v115, v115, v211
    v_mul_f32 v116, v116, v211
    v_mul_f32 v117, v117, v211
    v_mul_f32 v118, v118, v211
    v_mul_f32 v119, v119, v211
    v_mul_f32 v120, v120, v211
    v_mul_f32 v121, v121, v211
    v_mul_f32 v122, v122, v211
    v_mul_f32 v123, v123, v211
    v_sub_f32 v60, v60, v210
    v_sub_f32 v61, v61, v210
    v_sub_f32 v62, v62, v210
    v_sub_f32 v63, v63, v210
    v_sub_f32 v64, v64, v210
    v_sub_f32 v65, v65, v210
    v_sub_f32 v66, v66, v210
    v_sub_f32 v67, v67, v210
    v_sub_f32 v68, v68, v210
    v_sub_f32 v69, v69, v210
    v_sub_f32 v70, v70, v210
    v_sub_f32 v71, v71, v210
    v_sub_f32 v72, v72, v210
    v_sub_f32 v73, v73, v210
    v_sub_f32 v74, v74, v210
    v_sub_f32 v75, v75, v210
    v_exp_f32 v60, v60
    v_exp_f32 v61, v61
    v_exp_f32 v62, v62
    v_exp_f32_e64 v63, v63
    v_cvt_pk_bf16_f32 v92, v60, v61
    v_cvt_pk_bf16_f32 v93, v62, v63
    v_exp_f32 v64, v64
    v_exp_f32 v65, v65
    v_exp_f32 v66, v66
    v_exp_f32 v67, v67
    v_cvt_pk_bf16_f32 v94, v64, v65
    v_cvt_pk_bf16_f32 v95, v66, v67
    v_exp_f32 v68, v68
    v_exp_f32 v69, v69
    v_exp_f32 v70, v70
    v_exp_f32 v71, v71
    v_cvt_pk_bf16_f32 v96, v68, v69
    v_cvt_pk_bf16_f32 v97, v70, v71
    v_exp_f32 v72, v72
    v_exp_f32 v73, v73
    v_exp_f32 v74, v74
    v_exp_f32 v75, v75
    v_cvt_pk_bf16_f32 v98, v72, v73
    v_cvt_pk_bf16_f32 v99, v74, v75
    v_mfma_f32_32x32x16_bf16 v[108:123], a[48:51], v[92:95], v[108:123]
    s_nop 0
    s_nop 0
    v_mfma_f32_32x32x16_bf16 v[108:123], a[52:55], v[96:99], v[108:123]
    v_mfma_f32_32x32x16_bf16 v[76:91], a[16:19], v[52:55], 0
    v_mfma_f32_32x32x8_bf16 v[76:91], a[20:21], v[56:57], v[76:91]
    s_nop 11
    s_nop 0
    v_max3_f32 v210, v76, v77, v78
    v_max3_f32 v210, v210, v79, v80
    v_max3_f32 v210, v210, v81, v82
    v_max3_f32 v210, v210, v83, v84
    v_max3_f32 v210, v210, v85, v86
    v_max3_f32 v210, v210, v87, v88
    v_max3_f32 v210, v210, v89, v90
    v_max_f32 v210, v210, v91
    v_mov_b32 v211, v210
    s_nop 1
    v_permlane32_swap_b32 v210, v211
    v_max_f32 v210, v210, v211
    v_max_f32 v210, v210, v209
    v_sub_f32 v211, v209, v210
    v_exp_f32 v211, v211
    v_mov_b32 v209, v210
    v_mul_f32 v124, v124, v211
    v_mul_f32 v125, v125, v211
    v_mul_f32 v126, v126, v211
    v_mul_f32 v127, v127, v211
    v_mul_f32 v128, v128, v211
    v_mul_f32 v129, v129, v211
    v_mul_f32 v130, v130, v211
    v_mul_f32 v131, v131, v211
    v_mul_f32 v132, v132, v211
    v_mul_f32 v133, v133, v211
    v_mul_f32 v134, v134, v211
    v_mul_f32 v135, v135, v211
    v_mul_f32 v136, v136, v211
    v_mul_f32 v137, v137, v211
    v_mul_f32 v138, v138, v211
    v_mul_f32 v139, v139, v211
    v_sub_f32 v76, v76, v210
    v_sub_f32 v77, v77, v210
    v_sub_f32 v78, v78, v210
    v_sub_f32 v79, v79, v210
    v_sub_f32 v80, v80, v210
    v_sub_f32 v81, v81, v210
    v_sub_f32 v82, v82, v210
    v_sub_f32 v83, v83, v210
    v_sub_f32 v84, v84, v210
    v_sub_f32 v85, v85, v210
    v_sub_f32 v86, v86, v210
    v_sub_f32 v87, v87, v210
    v_sub_f32 v88, v88, v210
    v_sub_f32 v89, v89, v210
    v_sub_f32 v90, v90, v210
    v_sub_f32 v91, v91, v210
    v_exp_f32 v76, v76
    v_exp_f32 v77, v77
    v_exp_f32 v78, v78
    v_exp_f32_e64 v79, v79
    v_cvt_pk_bf16_f32 v100, v76, v77
    v_cvt_pk_bf16_f32 v101, v78, v79
    v_exp_f32 v80, v80
    v_exp_f32 v81, v81
    v_exp_f32 v82, v82
    v_exp_f32 v83, v83
    v_cvt_pk_bf16_f32 v102, v80, v81
    v_cvt_pk_bf16_f32 v103, v82, v83
    v_exp_f32 v84, v84
    v_exp_f32 v85, v85
    v_exp_f32 v86, v86
    v_exp_f32 v87, v87
    v_cvt_pk_bf16_f32 v104, v84, v85
    v_cvt_pk_bf16_f32 v105, v86, v87
    v_exp_f32 v88, v88
    v_exp_f32 v89, v89
    v_exp_f32 v90, v90
    v_exp_f32 v91, v91
    v_cvt_pk_bf16_f32 v106, v88, v89
    v_cvt_pk_bf16_f32 v107, v90, v91
    v_mfma_f32_32x32x16_bf16 v[124:139], a[48:51], v[100:103], v[124:139]
    s_nop 0
    v_mfma_f32_32x32x16_bf16 v[124:139], a[52:55], v[104:107], v[124:139]
    s_sub_u32 s87, s87, 1
    s_cmp_lg_u32 s87, 0
    s_cbranch_scc1 L_atts_74
L_adone_29:
    s_waitcnt vmcnt(0)
    s_barrier
    v_lshlrev_b32_e64 v244, 4, v2
    v_add_u32 v244, 98304, v244
    ds_read_b64 v[140:141], v244 offset:0
    ds_read_b64 v[142:143], v244 offset:64
    ds_read_b64 v[144:145], v244 offset:128
    ds_read_b64 v[146:147], v244 offset:192
    ds_read_b64 v[148:149], v244 offset:256
    ds_read_b64 v[150:151], v244 offset:320
    ds_read_b64 v[152:153], v244 offset:384
    ds_read_b64 v[154:155], v244 offset:448
    ds_read_b64 v[156:157], v244 offset:512
    ds_read_b64 v[158:159], v244 offset:576
    ds_read_b64 v[214:215], v244 offset:640
    ds_read_b64 v[216:217], v244 offset:704
    ds_read_b64 v[218:219], v244 offset:768
    ds_read_b64 v[220:221], v244 offset:832
    ds_read_b64 v[222:223], v244 offset:896
    v_lshlrev_b32_e64 v203, 3, v0
    s_mul_i32 s62, s22, 3072
    s_add_u32 s62, s62, 147456
    v_mul_u32_u24 v204, 176, v1
    v_add_u32_e64 v204, s62, v204
    v_lshl_add_u32 v205, v2, 3, v204
    v_bfe_u32 v208, v0, 4, 1
    v_mul_u32_u24 v208, 40, v208
    v_add_u32 v204, v204, v208
    v_lshrrev_b32_e64 v208, 5, v0
    v_lshl_add_u32 v204, v208, 3, v204
    v_mov_b32 v206, v116
    v_mov_b32 v207, v116
    s_nop 1
    v_permlane32_swap_b32 v206, v207
    v_rcp_f32 v207, v207
    s_nop 0
    v_mul_f32 v108, v108, v207
    v_mul_f32 v109, v109, v207
    v_mul_f32 v110, v110, v207
    v_mul_f32 v111, v111, v207
    v_cvt_pk_bf16_f32 v108, v108, v109
    v_cvt_pk_bf16_f32 v109, v110, v111
    ds_write_b64 v204, v[108:109] offset:0
    v_mul_f32 v112, v112, v207
    v_mul_f32 v113, v113, v207
    v_mul_f32 v114, v114, v207
    v_mul_f32 v115, v115, v207
    v_cvt_pk_bf16_f32 v112, v112, v113
    v_cvt_pk_bf16_f32 v113, v114, v115
    ds_write_b64 v204, v[112:113] offset:16
    v_mul_f32 v116, v116, v207
    v_mul_f32 v117, v117, v207
    v_mul_f32 v118, v118, v207
    v_mul_f32 v119, v119, v207
    v_cvt_pk_bf16_f32 v116, v116, v117
    v_cvt_pk_bf16_f32 v117, v118, v119
    s_mov_b32 exec_hi, 0
    ds_write_b64 v204, v[116:117] offset:32
    s_mov_b32 exec_hi, -1
    v_mov_b32 v206, v132
    v_mov_b32 v207, v132
    s_nop 1
    v_permlane32_swap_b32 v206, v207
    v_rcp_f32 v207, v207
    s_nop 0
    v_mul_f32 v124, v124, v207
    v_mul_f32 v125, v125, v207
    v_mul_f32 v126, v126, v207
    v_mul_f32 v127, v127, v207
    v_cvt_pk_bf16_f32 v124, v124, v125
    v_cvt_pk_bf16_f32 v125, v126, v127
    ds_write_b64 v204, v[124:125] offset:80
    v_mul_f32 v128, v128, v207
    v_mul_f32 v129, v129, v207
    v_mul_f32 v130, v130, v207
    v_mul_f32 v131, v131, v207
    v_cvt_pk_bf16_f32 v128, v128, v129
    v_cvt_pk_bf16_f32 v129, v130, v131
    ds_write_b64 v204, v[128:129] offset:96
    v_mul_f32 v132, v132, v207
    v_mul_f32 v133, v133, v207
    v_mul_f32 v134, v134, v207
    v_mul_f32 v135, v135, v207
    v_cvt_pk_bf16_f32 v132, v132, v133
    v_cvt_pk_bf16_f32 v133, v134, v135
    s_mov_b32 exec_hi, 0
    ds_write_b64 v204, v[132:133] offset:112
    s_mov_b32 exec_hi, -1
    s_waitcnt lgkmcnt(0)
    s_nop 0
    ds_read_b64 v[60:61], v205 offset:0
    ds_read_b64 v[62:63], v205 offset:32
    ds_read_b64 v[64:65], v205 offset:64
    ds_read_b64 v[66:67], v205 offset:96
    ds_read_b64 v[68:69], v205 offset:128
    s_mul_i32 s29, s23, 5
    s_nop 0
    s_mul_i32 s66, s27, 20480
    s_add_u32 s66, s66, 2097152
    s_waitcnt lgkmcnt(0)
    s_lshr_b32 s67, s29, 1
    s_lshl_b32 s67, s67, 10
    s_add_u32 s67, s67, s66
    s_bitcmp1_b32 s29, 0
    s_cbranch_scc1 L_so_75
    s_cmp_eq_u32 s3, 0
    s_cbranch_scc1 L_sl_77
    buffer_store_dwordx4 v[60:63], v3, s[4:7], s67 offen offset:0
    buffer_store_dwordx4 v[64:67], v3, s[4:7], s67 offen offset:1024
    buffer_store_dwordx2 v[68:69], v203, s[4:7], s67 offen offset:2048
    s_branch L_sj_78
L_sl_77:
    s_nop 0
    buffer_store_dwordx4 v[60:63], v3, s[4:7], s67 offen offset:0 sc1
    buffer_store_dwordx4 v[64:67], v3, s[4:7], s67 offen offset:1024 sc1
    buffer_store_dwordx2 v[68:69], v203, s[4:7], s67 offen offset:2048 sc1
L_sj_78:
    s_branch L_sj_76
L_so_75:
    s_cmp_eq_u32 s3, 0
    s_cbranch_scc1 L_sl_79
    s_nop 0
    buffer_store_dwordx2 v[60:61], v203, s[4:7], s67 offen offset:512
    buffer_store_dwordx4 v[62:65], v3, s[4:7], s67 offen offset:1024
    buffer_store_dwordx4 v[66:69], v3, s[4:7], s67 offen offset:2048
    s_branch L_sj_80
L_sl_79:
    s_nop 0
    buffer_store_dwordx2 v[60:61], v203, s[4:7], s67 offen offset:512 sc1
    buffer_store_dwordx4 v[62:65], v3, s[4:7], s67 offen offset:1024 sc1
    buffer_store_dwordx4 v[66:69], v3, s[4:7], s67 offen offset:2048 sc1
L_sj_80:
L_sj_76:
    v_mov_b32 v254, s20
    v_mov_b32_e64 v255, s21
    s_lshl_b32 s62, s27, 7
    s_lshl_b32 s63, s23, 3
    s_add_u32 s62, s62, s63
    s_add_u32 s62, s62, 27070464
    v_mov_b32_e64 v253, s62
    s_mov_b32 s63, 131072
    s_waitcnt vmcnt(0)
    s_mov_b64 exec, 1
    s_cmp_eq_u32 s3, 0
    s_cbranch_scc1 L_sl_81
    buffer_store_dwordx2 v[254:255], v253, s[4:7], s63 offen
    s_branch L_sj_82
L_sl_81:
    buffer_store_dwordx2 v[254:255], v253, s[4:7], 0 offen sc1
L_sj_82:
    s_mov_b64 exec, -1
    s_barrier
    s_add_u32 s94, s93, 98304
    s_mov_b32 m0, s94
    s_add_u32 s95, s90, 98304
    buffer_load_dwordx4 v3, s[4:7], s95 offen offset:0 lds
    buffer_load_dwordx4 v3, s[4:7], s95 offen offset:1024 lds
    buffer_load_dwordx4 v3, s[4:7], s95 offen offset:2048 lds
    buffer_load_dwordx4 v3, s[4:7], s95 offen offset:3072 lds
    v_mov_b32_e64 v200, v3
    v_add_u32 v201, 61440, v3
    v_add_u32 v202, 122880, v3
    s_barrier
    v_mov_b32 v251, s27
    v_lshrrev_b32_e64 v250, 4, v251
    s_lshr_b32 s62, s24, 2
    v_cmp_eq_u32 vcc, s62, v250
    s_mul_i32 s62, s3, 131072
    v_mov_b32 v252, s62
    v_cndmask_b32 v250, 0, v252, vcc
    v_lshl_add_u32 v251, v251, 7, v250
    v_and_b32_e64 v252, 7, v0
    v_lshl_add_u32 v251, v252, 3, v251
    s_mov_b32 s63, 27070464
    s_mov_b32 s62, 400000
    buffer_load_dwordx2 v[254:255], v251, s[4:7], s63 offen sc1
    s_add_u32 s94, s93, 114688
    s_mov_b32 m0, s94
    s_nop 0
    s_add_u32 s95, s90, 114688
    buffer_load_dwordx4 v3, s[4:7], s95 offen offset:0 lds
    buffer_load_dwordx4 v3, s[4:7], s95 offen offset:1024 lds
    buffer_load_dwordx4 v3, s[4:7], s95 offen offset:2048 lds
    v_lshlrev_b32_e64 v64, 16, v140
    v_and_b32 v65, 0xffff0000, v140
    v_lshlrev_b32_e64 v66, 16, v141
    v_and_b32 v67, 0xffff0000, v141
    v_lshlrev_b32_e64 v68, 16, v142
    v_and_b32 v69, 0xffff0000, v142
    v_lshlrev_b32_e64 v70, 16, v143
    v_and_b32 v71, 0xffff0000, v143
    v_lshlrev_b32_e64 v72, 16, v144
    v_and_b32 v73, 0xffff0000, v144
    v_lshlrev_b32_e64 v74, 16, v145
    v_and_b32 v75, 0xffff0000, v145
    v_lshlrev_b32_e64 v76, 16, v146
    v_and_b32 v77, 0xffff0000, v146
    v_lshlrev_b32_e64 v78, 16, v147
    v_and_b32 v79, 0xffff0000, v147
    v_lshlrev_b32_e64 v80, 16, v148
    v_and_b32 v81, 0xffff0000, v148
    v_lshlrev_b32_e64 v82, 16, v149
    v_and_b32 v83, 0xffff0000, v149
    v_lshlrev_b32_e64 v180, 16, v150
    v_and_b32 v181, 0xffff0000, v150
    v_lshlrev_b32_e64 v182, 16, v151
    v_and_b32 v183, 0xffff0000, v151
    v_lshlrev_b32_e64 v184, 16, v152
    v_and_b32 v185, 0xffff0000, v152
    v_lshlrev_b32_e64 v186, 16, v153
    v_and_b32 v187, 0xffff0000, v153
    v_lshlrev_b32_e64 v188, 16, v154
    v_and_b32 v189, 0xffff0000, v154
    v_lshlrev_b32_e64 v190, 16, v155
    v_and_b32 v191, 0xffff0000, v155
    v_lshlrev_b32_e64 v192, 16, v156
    v_and_b32 v193, 0xffff0000, v156
    v_lshlrev_b32_e64 v194, 16, v157
    v_and_b32 v195, 0xffff0000, v157
    v_lshlrev_b32_e64 v196, 16, v158
    v_and_b32 v197, 0xffff0000, v158
    v_lshlrev_b32_e64 v198, 16, v159
    v_and_b32 v199, 0xffff0000, v159
    v_lshlrev_b32_e64 v160, 16, v214
    v_and_b32 v161, 0xffff0000, v214
    v_lshlrev_b32_e64 v162, 16, v215
    v_and_b32 v163, 0xffff0000, v215
    v_lshlrev_b32_e64 v164, 16, v216
    v_and_b32 v165, 0xffff0000, v216
    v_lshlrev_b32_e64 v166, 16, v217
    v_and_b32 v167, 0xffff0000, v217
    v_lshlrev_b32_e64 v168, 16, v218
    v_and_b32 v169, 0xffff0000, v218
    v_lshlrev_b32_e64 v170, 16, v219
    v_and_b32 v171, 0xffff0000, v219
    v_lshlrev_b32_e64 v172, 16, v220
    v_and_b32 v173, 0xffff0000, v220
    v_lshlrev_b32_e64 v174, 16, v221
    v_and_b32 v175, 0xffff0000, v221
    v_lshlrev_b32_e64 v176, 16, v222
    v_and_b32 v177, 0xffff0000, v222
    v_lshlrev_b32_e64 v178, 16, v223
    v_and_b32 v179, 0xffff0000, v223
    v_add_f32 v160, 1.0, v160
    v_add_f32 v161, 1.0, v161
    v_cvt_pk_bf16_f32 v160, v160, v161
    v_and_b32 v161, 0xffff0000, v160
    v_lshlrev_b32 v160, 16, v160
    v_add_f32 v162, 1.0, v162
    v_add_f32_e64 v163, 1.0, v163
    v_cvt_pk_bf16_f32 v162, v162, v163
    v_and_b32 v163, 0xffff0000, v162
    v_lshlrev_b32 v162, 16, v162
    v_add_f32 v164, 1.0, v164
    v_add_f32_e64 v165, 1.0, v165
    v_cvt_pk_bf16_f32 v164, v164, v165
    v_and_b32 v165, 0xffff0000, v164
    v_lshlrev_b32 v164, 16, v164
    v_add_f32 v166, 1.0, v166
    v_add_f32_e64 v167, 1.0, v167
    v_cvt_pk_bf16_f32 v166, v166, v167
    v_and_b32 v167, 0xffff0000, v166
    v_lshlrev_b32 v166, 16, v166
    v_add_f32 v168, 1.0, v168
    v_add_f32_e64 v169, 1.0, v169
    v_cvt_pk_bf16_f32 v168, v168, v169
    v_and_b32 v169, 0xffff0000, v168
    v_lshlrev_b32 v168, 16, v168
    v_add_f32 v170, 1.0, v170
    v_add_f32_e64 v171, 1.0, v171
    v_cvt_pk_bf16_f32 v170, v170, v171
    v_and_b32 v171, 0xffff0000, v170
    v_lshlrev_b32 v170, 16, v170
    v_add_f32 v172, 1.0, v172
    v_add_f32_e64 v173, 1.0, v173
    v_cvt_pk_bf16_f32 v172, v172, v173
    v_and_b32 v173, 0xffff0000, v172
    v_lshlrev_b32 v172, 16, v172
    v_add_f32 v174, 1.0, v174
    v_add_f32_e64 v175, 1.0, v175
    v_cvt_pk_bf16_f32 v174, v174, v175
    v_and_b32 v175, 0xffff0000, v174
    v_lshlrev_b32 v174, 16, v174
    v_add_f32 v176, 1.0, v176
    v_add_f32_e64 v177, 1.0, v177
    v_cvt_pk_bf16_f32 v176, v176, v177
    v_and_b32 v177, 0xffff0000, v176
    v_lshlrev_b32 v176, 16, v176
    v_add_f32 v178, 1.0, v178
    v_add_f32_e64 v179, 1.0, v179
    v_cvt_pk_bf16_f32 v178, v178, v179
    v_and_b32 v179, 0xffff0000, v178
    v_lshlrev_b32_e64 v178, 16, v178
    v_accvgpr_read_b32 v204, a0
    v_lshlrev_b32_e64 v4, 16, v204
    v_and_b32 v5, 0xffff0000, v204
    v_accvgpr_read_b32 v204, a1
    v_lshlrev_b32_e64 v6, 16, v204
    v_and_b32 v7, 0xffff0000, v204
    v_accvgpr_read_b32 v204, a2
    v_lshlrev_b32_e64 v8, 16, v204
    v_and_b32 v9, 0xffff0000, v204
    v_accvgpr_read_b32 v204, a3
    v_lshlrev_b32_e64 v10, 16, v204
    v_and_b32 v11, 0xffff0000, v204
    v_accvgpr_read_b32 v204, a4
    v_lshlrev_b32_e64 v12, 16, v204
    v_and_b32 v13, 0xffff0000, v204
    v_accvgpr_read_b32 v204, a5
    v_lshlrev_b32_e64 v14, 16, v204
    v_and_b32 v15, 0xffff0000, v204
    v_accvgpr_read_b32 v204, a6
    v_lshlrev_b32_e64 v16, 16, v204
    v_and_b32 v17, 0xffff0000, v204
    v_accvgpr_read_b32 v204, a7
    v_lshlrev_b32_e64 v18, 16, v204
    v_and_b32 v19, 0xffff0000, v204
    v_accvgpr_read_b32 v204, a8
    v_lshlrev_b32_e64 v20, 16, v204
    v_and_b32 v21, 0xffff0000, v204
    v_accvgpr_read_b32 v204, a9
    v_lshlrev_b32_e64 v22, 16, v204
    v_and_b32 v23, 0xffff0000, v204
    s_waitcnt vmcnt(3)
    v_cmp_ne_u32 vcc, s20, v254
    s_mov_b64 s[64:65], vcc
    v_cmp_ne_u32 vcc, s21, v255
    s_or_b64 s[64:65], s[64:65], vcc
    s_cmp_eq_u64 s[64:65], 0
    s_cbranch_scc1 L_wfok_84
    buffer_load_dwordx2 v[254:255], v251, s[4:7], s63 offen sc1
L_wfp_83:
    s_sleep 2
    buffer_load_dwordx2 v[252:253], v251, s[4:7], s63 offen sc1
    s_waitcnt vmcnt(1)
    v_cmp_ne_u32 vcc, s20, v254
    s_mov_b64 s[64:65], vcc
    v_cmp_ne_u32 vcc, s21, v255
    s_or_b64 s[64:65], s[64:65], vcc
    s_cmp_eq_u64 s[64:65], 0
    s_cbranch_scc1 L_wfo2_85
    s_sleep 2
    buffer_load_dwordx2 v[254:255], v251, s[4:7], s63 offen sc1
    s_waitcnt vmcnt(1)
    v_cmp_ne_u32 vcc, s20, v252
    s_mov_b64 s[64:65], vcc
    v_cmp_ne_u32 vcc, s21, v253
    s_or_b64 s[64:65], s[64:65], vcc
    s_cmp_eq_u64 s[64:65], 0
    s_cbranch_scc1 L_wfo2_85
    s_sub_u32 s62, s62, 1
    s_cmp_lg_u32 s62, 0
    s_cbranch_scc1 L_wfp_83
    s_mov_b32 s28, 6
    s_branch L_fail
L_wfo2_85:
L_wfok_84:
    s_mul_i32 s30, s27, 20480
    s_add_u32 s30, s30, 2097152
    buffer_load_dwordx4 v3, s[4:7], s95 offen offset:3072 lds
    s_add_u32 s88, s30, 0
    s_nop 0
    buffer_load_dwordx4 a[16:19], v3, s[4:7], s88 offen offset:0 sc1
    buffer_load_dwordx4 a[20:23], v3, s[4:7], s88 offen offset:1024 sc1
    buffer_load_dwordx2 a[24:25], v203, s[4:7], s88 offen offset:2048 sc1
    buffer_load_dwordx2 a[26:27], v203, s[4:7], s88 offen offset:2560 sc1
    buffer_load_dwordx4 a[28:31], v3, s[4:7], s88 offen offset:3072 sc1
    s_add_u32 s88, s30, 4096
    buffer_load_dwordx4 a[32:35], v3, s[4:7], s88 offen offset:0 sc1
    buffer_load_dwordx4 a[36:39], v3, s[4:7], s88 offen offset:1024 sc1
    ds_read_b128 v[100:103], v200 offset:0
    ds_read_b128 v[104:107], v200 offset:1024
    ds_read_b128 v[108:111], v200 offset:2048
    ds_read_b128 v[112:115], v200 offset:3072
    ds_read_b128 v[116:119], v200 offset:4096
    ds_read_b128 v[120:123], v200 offset:5120
    ds_read_b128 v[124:127], v200 offset:6144
    ds_read_b128 v[128:131], v200 offset:7168
    ds_read_b128 v[132:135], v200 offset:8192
    ds_read_b128 v[136:139], v200 offset:9216
    s_waitcnt lgkmcnt(5)
    s_waitcnt vmcnt(6)
    v_mfma_f32_16x16x32_bf16 v[44:47], v[100:103], a[16:19], 0
    ds_read_b128 v[140:143], v200 offset:10240
    buffer_load_dwordx4 a[40:43], v3, s[4:7], s88 offen offset:2048 sc1
    v_mfma_f32_16x16x32_bf16 v[48:51], v[104:107], a[16:19], 0
    ds_read_b128 v[144:147], v200 offset:11264
    v_mfma_f32_16x16x32_bf16 v[52:55], v[108:111], a[16:19], 0
    ds_read_b128 v[148:151], v200 offset:12288
    v_mfma_f32_16x16x32_bf16 v[56:59], v[112:115], a[16:19], 0
    ds_read_b128 v[152:155], v200 offset:13312
    v_mfma_f32_16x16x32_bf16 v[60:63], v[116:119], a[16:19], 0
    ds_read_b128 v[156:159], v200 offset:14336
    s_waitcnt lgkmcnt(5)
    s_waitcnt vmcnt(6)
    v_mfma_f32_16x16x32_bf16 v[44:47], v[120:123], a[20:23], v[44:47]
    ds_read_b128 v[100:103], v200 offset:15360
    buffer_load_dwordx2 a[44:45], v203, s[4:7], s88 offen offset:3072 sc1
    buffer_load_dwordx2 a[46:47], v203, s[4:7], s88 offen offset:3584 sc1
    v_mfma_f32_16x16x32_bf16 v[48:51], v[124:127], a[20:23], v[48:51]
    ds_read_b128 v[104:107], v200 offset:16384
    v_mfma_f32_16x16x32_bf16 v[52:55], v[128:131], a[20:23], v[52:55]
    ds_read_b128 v[108:111], v200 offset:17408
    v_mfma_f32_16x16x32_bf16 v[56:59], v[132:135], a[20:23], v[56:59]
    ds_read_b128 v[112:115], v200 offset:18432
    v_mfma_f32_16x16x32_bf16 v[60:63], v[136:139], a[20:23], v[60:63]
    ds_read_b128 v[116:119], v200 offset:19456
    s_barrier
    s_waitcnt lgkmcnt(5)
    s_waitcnt vmcnt(6)
    s_nop 0
    v_mfma_f32_16x16x32_bf16 v[44:47], v[140:143], a[24:27], v[44:47]
    ds_read_b128 v[120:123], v200 offset:20480
    s_add_u32 s88, s30, 8192
    buffer_load_dwordx4 a[48:51], v3, s[4:7], s88 offen offset:0 sc1
    v_mfma_f32_16x16x32_bf16 v[48:51], v[144:147], a[24:27], v[48:51]
    ds_read_b128 v[124:127], v200 offset:21504
    v_mfma_f32_16x16x32_bf16 v[52:55], v[148:151], a[24:27], v[52:55]
    ds_read_b128 v[128:131], v200 offset:22528
    v_mfma_f32_16x16x32_bf16 v[56:59], v[152:155], a[24:27], v[56:59]
    ds_read_b128 v[132:135], v200 offset:23552
    v_mfma_f32_16x16x32_bf16 v[60:63], v[156:159], a[24:27], v[60:63]
    ds_read_b128 v[136:139], v200 offset:24576
    s_waitcnt lgkmcnt(5)
    s_waitcnt vmcnt(6)
    v_mfma_f32_16x16x32_bf16 v[44:47], v[100:103], a[28:31], v[44:47]
    ds_read_b128 v[140:143], v200 offset:25600
    buffer_load_dwordx4 a[52:55], v3, s[4:7], s88 offen offset:1024 sc1
    v_mfma_f32_16x16x32_bf16 v[48:51], v[104:107], a[28:31], v[48:51]
    ds_read_b128 v[144:147], v200 offset:26624
    v_mfma_f32_16x16x32_bf16 v[52:55], v[108:111], a[28:31], v[52:55]
    ds_read_b128 v[148:151], v200 offset:27648
    buffer_load_dwordx4 a[56:59], v3, s[4:7], s88 offen offset:2048 sc1
    v_mfma_f32_16x16x32_bf16 v[56:59], v[112:115], a[28:31], v[56:59]
    ds_read_b128 v[152:155], v200 offset:28672
    v_mfma_f32_16x16x32_bf16 v[60:63], v[116:119], a[28:31], v[60:63]
    ds_read_b128 v[156:159], v200 offset:29696
    s_waitcnt lgkmcnt(5)
    s_waitcnt vmcnt(7)
    v_mfma_f32_16x16x32_bf16 v[44:47], v[120:123], a[32:35], v[44:47]
    ds_read_b128 v[100:103], v200 offset:30720
    buffer_load_dwordx4 a[60:63], v3, s[4:7], s88 offen offset:3072 sc1
    v_mfma_f32_16x16x32_bf16 v[48:51], v[124:127], a[32:35], v[48:51]
    ds_read_b128 v[104:107], v200 offset:31744
    v_mfma_f32_16x16x32_bf16 v[52:55], v[128:131], a[32:35], v[52:55]
    ds_read_b128 v[108:111], v200 offset:32768
    v_mfma_f32_16x16x32_bf16 v[56:59], v[132:135], a[32:35], v[56:59]
    ds_read_b128 v[112:115], v200 offset:33792
    v_mfma_f32_16x16x32_bf16 v[60:63], v[136:139], a[32:35], v[60:63]
    ds_read_b128 v[116:119], v200 offset:34816
    s_waitcnt lgkmcnt(5)
    s_waitcnt vmcnt(7)
    v_mfma_f32_16x16x32_bf16 v[44:47], v[140:143], a[36:39], v[44:47]
    ds_read_b128 v[120:123], v200 offset:35840
    s_add_u32 s88, s30, 12288
    buffer_load_dwordx2 a[64:65], v203, s[4:7], s88 offen offset:0 sc1
    buffer_load_dwordx2 a[66:67], v203, s[4:7], s88 offen offset:512 sc1
    v_mfma_f32_16x16x32_bf16 v[48:51], v[144:147], a[36:39], v[48:51]
    ds_read_b128 v[124:127], v200 offset:36864
    v_mfma_f32_16x16x32_bf16 v[52:55], v[148:151], a[36:39], v[52:55]
    ds_read_b128 v[128:131], v200 offset:37888
    v_mfma_f32_16x16x32_bf16 v[56:59], v[152:155], a[36:39], v[56:59]
    ds_read_b128 v[132:135], v200 offset:38912
    v_mfma_f32_16x16x32_bf16 v[60:63], v[156:159], a[36:39], v[60:63]
    ds_read_b128 v[136:139], v200 offset:39936
    s_barrier
    s_waitcnt lgkmcnt(5)
    s_waitcnt vmcnt(8)
    s_nop 0
    v_mfma_f32_16x16x32_bf16 v[44:47], v[100:103], a[40:43], v[44:47]
    ds_read_b128 v[140:143], v200 offset:40960
    buffer_load_dwordx4 a[68:71], v3, s[4:7], s88 offen offset:1024 sc1
    v_mfma_f32_16x16x32_bf16 v[48:51], v[104:107], a[40:43], v[48:51]
    ds_read_b128 v[144:147], v200 offset:41984
    v_mfma_f32_16x16x32_bf16 v[52:55], v[108:111], a[40:43], v[52:55]
    ds_read_b128 v[148:151], v200 offset:43008
    buffer_load_dwordx4 a[72:75], v3, s[4:7], s88 offen offset:2048 sc1
    v_mfma_f32_16x16x32_bf16 v[56:59], v[112:115], a[40:43], v[56:59]
    ds_read_b128 v[152:155], v200 offset:44032
    v_mfma_f32_16x16x32_bf16 v[60:63], v[116:119], a[40:43], v[60:63]
    ds_read_b128 v[156:159], v200 offset:45056
    s_waitcnt lgkmcnt(5)
    s_waitcnt vmcnt(8)
    v_mfma_f32_16x16x32_bf16 v[44:47], v[120:123], a[44:47], v[44:47]
    ds_read_b128 v[100:103], v200 offset:46080
    buffer_load_dwordx4 a[76:79], v3, s[4:7], s88 offen offset:3072 sc1
    v_mfma_f32_16x16x32_bf16 v[48:51], v[124:127], a[44:47], v[48:51]
    ds_read_b128 v[104:107], v200 offset:47104
    v_mfma_f32_16x16x32_bf16 v[52:55], v[128:131], a[44:47], v[52:55]
    ds_read_b128 v[108:111], v200 offset:48128
    v_mfma_f32_16x16x32_bf16 v[56:59], v[132:135], a[44:47], v[56:59]
    ds_read_b128 v[112:115], v200 offset:49152
    v_mfma_f32_16x16x32_bf16 v[60:63], v[136:139], a[44:47], v[60:63]
    ds_read_b128 v[116:119], v200 offset:50176
    s_waitcnt lgkmcnt(5)
    s_waitcnt vmcnt(8)
    v_mfma_f32_16x16x32_bf16 v[44:47], v[140:143], a[48:51], v[44:47]
    ds_read_b128 v[120:123], v200 offset:51200
    s_add_u32 s88, s30, 16384
    buffer_load_dwordx4 a[80:83], v3, s[4:7], s88 offen offset:0 sc1
    v_mfma_f32_16x16x32_bf16 v[48:51], v[144:147], a[48:51], v[48:51]
    ds_read_b128 v[124:127], v200 offset:52224
    v_mfma_f32_16x16x32_bf16 v[52:55], v[148:151], a[48:51], v[52:55]
    ds_read_b128 v[128:131], v200 offset:53248
    v_mfma_f32_16x16x32_bf16 v[56:59], v[152:155], a[48:51], v[56:59]
    ds_read_b128 v[132:135], v200 offset:54272
    v_mfma_f32_16x16x32_bf16 v[60:63], v[156:159], a[48:51], v[60:63]
    ds_read_b128 v[136:139], v200 offset:55296
    s_waitcnt lgkmcnt(5)
    s_waitcnt vmcnt(8)
    v_mfma_f32_16x16x32_bf16 v[44:47], v[100:103], a[52:55], v[44:47]
    ds_read_b128 v[140:143], v200 offset:56320
    buffer_load_dwordx2 a[84:85], v203, s[4:7], s88 offen offset:1024 sc1
    buffer_load_dwordx2 a[86:87], v203, s[4:7], s88 offen offset:1536 sc1
    v_mfma_f32_16x16x32_bf16 v[48:51], v[104:107], a[52:55], v[48:51]
    ds_read_b128 v[144:147], v200 offset:57344
    v_mfma_f32_16x16x32_bf16 v[52:55], v[108:111], a[52:55], v[52:55]
    ds_read_b128 v[148:151], v200 offset:58368
    buffer_load_dwordx4 a[88:91], v3, s[4:7], s88 offen offset:2048 sc1
    v_mfma_f32_16x16x32_bf16 v[56:59], v[112:115], a[52:55], v[56:59]
    ds_read_b128 v[152:155], v200 offset:59392
    v_mfma_f32_16x16x32_bf16 v[60:63], v[116:119], a[52:55], v[60:63]
    ds_read_b128 v[156:159], v200 offset:60416
    s_barrier
    s_waitcnt lgkmcnt(5)
    s_waitcnt vmcnt(10)
    s_nop 0
    v_mfma_f32_16x16x32_bf16 v[44:47], v[120:123], a[56:59], v[44:47]
    ds_read_b128 v[100:103], v201 offset:0
    buffer_load_dwordx4 a[92:95], v3, s[4:7], s88 offen offset:3072 sc1
    v_mfma_f32_16x16x32_bf16 v[48:51], v[124:127], a[56:59], v[48:51]
    ds_read_b128 v[104:107], v201 offset:1024
    v_mfma_f32_16x16x32_bf16 v[52:55], v[128:131], a[56:59], v[52:55]
    ds_read_b128 v[108:111], v201 offset:2048
    v_mfma_f32_16x16x32_bf16 v[56:59], v[132:135], a[56:59], v[56:59]
    ds_read_b128 v[112:115], v201 offset:3072
    v_mfma_f32_16x16x32_bf16 v[60:63], v[136:139], a[56:59], v[60:63]
    ds_read_b128 v[116:119], v201 offset:4096
    s_waitcnt lgkmcnt(5)
    s_waitcnt vmcnt(10)
    v_mfma_f32_16x16x32_bf16 v[44:47], v[140:143], a[60:63], v[44:47]
    ds_read_b128 v[120:123], v201 offset:5120
    s_add_u32 s94, s93, 131072
    s_mov_b32 m0, s94
    s_nop 0
    s_add_u32 s95, s90, 131072
    buffer_load_dwordx4 v3, s[4:7], s95 offen offset:0 lds
    v_mfma_f32_16x16x32_bf16 v[48:51], v[144:147], a[60:63], v[48:51]
    ds_read_b128 v[124:127], v201 offset:6144
    v_mfma_f32_16x16x32_bf16 v[52:55], v[148:151], a[60:63], v[52:55]
    ds_read_b128 v[128:131], v201 offset:7168
    v_mfma_f32_16x16x32_bf16 v[56:59], v[152:155], a[60:63], v[56:59]
    ds_read_b128 v[132:135], v201 offset:8192
    v_mfma_f32_16x16x32_bf16 v[60:63], v[156:159], a[60:63], v[60:63]
    ds_read_b128 v[136:139], v201 offset:9216
    s_waitcnt lgkmcnt(5)
    s_waitcnt vmcnt(9)
    v_mfma_f32_16x16x32_bf16 v[44:47], v[100:103], a[64:67], v[44:47]
    ds_read_b128 v[140:143], v201 offset:10240
    buffer_load_dwordx4 v3, s[4:7], s95 offen offset:1024 lds
    v_mfma_f32_16x16x32_bf16 v[48:51], v[104:107], a[64:67], v[48:51]
    ds_read_b128 v[144:147], v201 offset:11264
    v_mfma_f32_16x16x32_bf16 v[52:55], v[108:111], a[64:67], v[52:55]
    ds_read_b128 v[148:151], v201 offset:12288
    v_mfma_f32_16x16x32_bf16 v[56:59], v[112:115], a[64:67], v[56:59]
    ds_read_b128 v[152:155], v201 offset:13312
    v_mfma_f32_16x16x32_bf16 v[60:63], v[116:119], a[64:67], v[60:63]
    ds_read_b128 v[156:159], v201 offset:14336
    s_waitcnt lgkmcnt(5)
    s_waitcnt vmcnt(9)
    v_mfma_f32_16x16x32_bf16 v[44:47], v[120:123], a[68:71], v[44:47]
    ds_read_b128 v[100:103], v201 offset:15360
    buffer_load_dwordx4 v3, s[4:7], s95 offen offset:2048 lds
    v_mfma_f32_16x16x32_bf16 v[48:51], v[124:127], a[68:71], v[48:51]
    ds_read_b128 v[104:107], v201 offset:16384
    v_mfma_f32_16x16x32_bf16 v[52:55], v[128:131], a[68:71], v[52:55]
    ds_read_b128 v[108:111], v201 offset:17408
    buffer_load_dwordx4 v3, s[4:7], s95 offen offset:3072 lds
    v_mfma_f32_16x16x32_bf16 v[56:59], v[132:135], a[68:71], v[56:59]
    ds_read_b128 v[112:115], v201 offset:18432
    v_mfma_f32_16x16x32_bf16 v[60:63], v[136:139], a[68:71], v[60:63]
    ds_read_b128 v[116:119], v201 offset:19456
    s_barrier
    s_waitcnt lgkmcnt(5)
    s_waitcnt vmcnt(10)
    s_nop 0
    v_mfma_f32_16x16x32_bf16 v[44:47], v[140:143], a[72:75], v[44:47]
    ds_read_b128 v[120:123], v201 offset:20480
    s_add_u32 s94, s93, 147456
    s_mov_b32 m0, s94
    s_nop 0
    s_add_u32 s95, s90, 147456
    buffer_load_dwordx4 v3, s[4:7], s95 offen offset:0 lds
    v_mfma_f32_16x16x32_bf16 v[48:51], v[144:147], a[72:75], v[48:51]
    ds_read_b128 v[124:127], v201 offset:21504
    v_mfma_f32_16x16x32_bf16 v[52:55], v[148:151], a[72:75], v[52:55]
    ds_read_b128 v[128:131], v201 offset:22528
    v_mfma_f32_16x16x32_bf16 v[56:59], v[152:155], a[72:75], v[56:59]
    ds_read_b128 v[132:135], v201 offset:23552
    v_mfma_f32_16x16x32_bf16 v[60:63], v[156:159], a[72:75], v[60:63]
    ds_read_b128 v[136:139], v201 offset:24576
    s_waitcnt lgkmcnt(5)
    s_waitcnt vmcnt(10)
    v_mfma_f32_16x16x32_bf16 v[44:47], v[100:103], a[76:79], v[44:47]
    ds_read_b128 v[140:143], v201 offset:25600
    buffer_load_dwordx4 v3, s[4:7], s95 offen offset:1024 lds
    v_mfma_f32_16x16x32_bf16 v[48:51], v[104:107], a[76:79], v[48:51]
    ds_read_b128 v[144:147], v201 offset:26624
    v_mfma_f32_16x16x32_bf16 v[52:55], v[108:111], a[76:79], v[52:55]
    ds_read_b128 v[148:151], v201 offset:27648
    v_mfma_f32_16x16x32_bf16 v[56:59], v[112:115], a[76:79], v[56:59]
    ds_read_b128 v[152:155], v201 offset:28672
    v_mfma_f32_16x16x32_bf16 v[60:63], v[116:119], a[76:79], v[60:63]
    ds_read_b128 v[156:159], v201 offset:29696
    s_waitcnt lgkmcnt(5)
    s_waitcnt vmcnt(10)
    v_mfma_f32_16x16x32_bf16 v[44:47], v[120:123], a[80:83], v[44:47]
    ds_read_b128 v[100:103], v201 offset:30720
    buffer_load_dwordx4 v3, s[4:7], s95 offen offset:2048 lds
    v_mfma_f32_16x16x32_bf16 v[48:51], v[124:127], a[80:83], v[48:51]
    ds_read_b128 v[104:107], v201 offset:31744
    v_mfma_f32_16x16x32_bf16 v[52:55], v[128:131], a[80:83], v[52:55]
    ds_read_b128 v[108:111], v201 offset:32768
    buffer_load_dwordx4 v3, s[4:7], s95 offen offset:3072 lds
    v_mfma_f32_16x16x32_bf16 v[56:59], v[132:135], a[80:83], v[56:59]
    ds_read_b128 v[112:115], v201 offset:33792
    v_mfma_f32_16x16x32_bf16 v[60:63], v[136:139], a[80:83], v[60:63]
    ds_read_b128 v[116:119], v201 offset:34816
    s_waitcnt lgkmcnt(5)
    s_waitcnt vmcnt(10)
    v_mfma_f32_16x16x32_bf16 v[44:47], v[140:143], a[84:87], v[44:47]
    ds_read_b128 v[120:123], v201 offset:35840
    s_add_u32 s94, s93, 0
    s_mov_b32 m0, s94
    s_add_u32 s95, s90, 163840
    buffer_load_dwordx4 v3, s[4:7], s95 offen offset:0 lds
    v_mfma_f32_16x16x32_bf16 v[48:51], v[144:147], a[84:87], v[48:51]
    ds_read_b128 v[124:127], v201 offset:36864
    v_mfma_f32_16x16x32_bf16 v[52:55], v[148:151], a[84:87], v[52:55]
    ds_read_b128 v[128:131], v201 offset:37888
    v_mfma_f32_16x16x32_bf16 v[56:59], v[152:155], a[84:87], v[56:59]
    ds_read_b128 v[132:135], v201 offset:38912
    v_mfma_f32_16x16x32_bf16 v[60:63], v[156:159], a[84:87], v[60:63]
    ds_read_b128 v[136:139], v201 offset:39936
    s_waitcnt lgkmcnt(5)
    s_waitcnt vmcnt(10)
    v_mfma_f32_16x16x32_bf16 v[44:47], v[100:103], a[88:91], v[44:47]
    buffer_load_dwordx4 v3, s[4:7], s95 offen offset:1024 lds
    v_mfma_f32_16x16x32_bf16 v[48:51], v[104:107], a[88:91], v[48:51]
    v_mfma_f32_16x16x32_bf16 v[52:55], v[108:111], a[88:91], v[52:55]
    v_mfma_f32_16x16x32_bf16 v[56:59], v[112:115], a[88:91], v[56:59]
    v_mfma_f32_16x16x32_bf16 v[60:63], v[116:119], a[88:91], v[60:63]
    s_waitcnt lgkmcnt(0)
    s_waitcnt vmcnt(10)
    v_mfma_f32_16x16x32_bf16 v[44:47], v[120:123], a[92:95], v[44:47]
    buffer_load_dwordx4 v3, s[4:7], s95 offen offset:2048 lds
    v_mfma_f32_16x16x32_bf16 v[48:51], v[124:127], a[92:95], v[48:51]
    v_mfma_f32_16x16x32_bf16 v[52:55], v[128:131], a[92:95], v[52:55]
    buffer_load_dwordx4 v3, s[4:7], s95 offen offset:3072 lds
    v_mfma_f32_16x16x32_bf16 v[56:59], v[132:135], a[92:95], v[56:59]
    v_mfma_f32_16x16x32_bf16 v[60:63], v[136:139], a[92:95], v[60:63]
    s_barrier
    s_nop 0
    v_pk_fma_f32 v[4:5], v[64:65], v[44:45], v[4:5]
    v_pk_fma_f32 v[6:7], v[66:67], v[46:47], v[6:7]
    v_pk_fma_f32 v[8:9], v[68:69], v[48:49], v[8:9]
    v_pk_fma_f32 v[10:11], v[70:71], v[50:51], v[10:11]
    v_pk_fma_f32 v[12:13], v[72:73], v[52:53], v[12:13]
    v_pk_fma_f32 v[14:15], v[74:75], v[54:55], v[14:15]
    v_pk_fma_f32 v[16:17], v[76:77], v[56:57], v[16:17]
    v_pk_fma_f32 v[18:19], v[78:79], v[58:59], v[18:19]
    v_pk_fma_f32 v[20:21], v[80:81], v[60:61], v[20:21]
    v_pk_fma_f32 v[22:23], v[82:83], v[62:63], v[22:23]
    v_pk_add_f32 v[204:205], v[4:5], v[6:7]
    v_pk_mul_f32 v[206:207], v[4:5], v[4:5]
    v_pk_fma_f32 v[206:207], v[6:7], v[6:7], v[206:207]
    v_pk_add_f32 v[204:205], v[204:205], v[8:9]
    v_pk_fma_f32 v[206:207], v[8:9], v[8:9], v[206:207]
    v_pk_add_f32 v[204:205], v[204:205], v[10:11]
    v_pk_fma_f32 v[206:207], v[10:11], v[10:11], v[206:207]
    v_pk_add_f32 v[204:205], v[204:205], v[12:13]
    v_pk_fma_f32 v[206:207], v[12:13], v[12:13], v[206:207]
    v_pk_add_f32 v[204:205], v[204:205], v[14:15]
    v_pk_fma_f32 v[206:207], v[14:15], v[14:15], v[206:207]
    v_pk_add_f32 v[204:205], v[204:205], v[16:17]
    v_pk_fma_f32 v[206:207], v[16:17], v[16:17], v[206:207]
    v_pk_add_f32 v[204:205], v[204:205], v[18:19]
    v_pk_fma_f32 v[206:207], v[18:19], v[18:19], v[206:207]
    v_pk_add_f32 v[204:205], v[204:205], v[20:21]
    v_pk_fma_f32 v[206:207], v[20:21], v[20:21], v[206:207]
    v_pk_add_f32 v[204:205], v[204:205], v[22:23]
    v_pk_fma_f32 v[206:207], v[22:23], v[22:23], v[206:207]
    v_add_f32 v204, v204, v205
    v_add_f32 v205, v206, v207
    v_mov_b32 v208, v204
    v_mov_b32 v209, v205
    s_nop 0
    v_permlane16_swap_b32 v204, v208
    v_permlane16_swap_b32 v205, v209
    v_add_f32 v204, v204, v208
    v_add_f32 v205, v205, v209
    v_mov_b32 v208, v204
    v_mov_b32 v209, v205
    s_nop 0
    v_permlane32_swap_b32 v204, v208
    v_permlane32_swap_b32 v205, v209
    v_add_f32 v204, v204, v208
    v_add_f32 v205, v205, v209
    v_mov_b32 v206, s20
    v_mov_b32_e64 v207, s21
    s_lshl_b32 s66, s24, 13
    s_lshl_b32 s67, s22, 8
    s_add_u32 s66, s66, s67
    s_add_u32 s66, s66, 131072
    s_lshl_b32 s67, s23, 10
    s_add_u32 s67, s67, s66
    v_lshlrev_b32_e64 v208, 4, v1
    s_mov_b64 exec, 0xffff
    s_cmp_eq_u32 s3, 0
    s_cbranch_scc1 L_sl_86
    buffer_store_dwordx4 v[204:207], v208, s[4:7], s67 offen
    s_branch L_sj_87
L_sl_86:
    buffer_store_dwordx4 v[204:207], v208, s[4:7], s67 offen sc1
L_sj_87:
    s_mov_b64 exec, -1
    s_mov_b64 exec, -1
    s_nop 0
    v_lshl_add_u32 v209, v2, 11, v208
    s_mov_b32 s62, 400000
    buffer_load_dwordx4 v[212:215], v209, s[4:7], s66 offen sc1
    buffer_load_dwordx4 v[216:219], v209, s[4:7], s66 offen offset:1024 sc1
    s_add_u32 s94, s93, 16384
    s_mov_b32 m0, s94
    s_nop 0
    s_add_u32 s95, s90, 180224
    buffer_load_dwordx4 v3, s[4:7], s95 offen offset:0 lds
    buffer_load_dwordx4 v3, s[4:7], s95 offen offset:1024 lds
    buffer_load_dwordx4 v3, s[4:7], s95 offen offset:2048 lds
    s_waitcnt vmcnt(3)
    s_branch L_lsc_90
L_ls_88:
    buffer_load_dwordx4 v[212:215], v209, s[4:7], s66 offen sc1
    buffer_load_dwordx4 v[216:219], v209, s[4:7], s66 offen offset:1024 sc1
    s_waitcnt vmcnt(0)
L_lsc_90:
    v_cmp_ne_u32 vcc, s20, v214
    s_mov_b64 s[64:65], vcc
    v_cmp_ne_u32 vcc, s21, v215
    s_or_b64 s[64:65], s[64:65], vcc
    v_cmp_ne_u32 vcc, s20, v218
    s_or_b64 s[64:65], s[64:65], vcc
    v_cmp_ne_u32 vcc, s21, v219
    s_or_b64 s[64:65], s[64:65], vcc
    s_cmp_eq_u64 s[64:65], 0
    s_cbranch_scc1 L_lsok_89
    s_sub_u32 s62, s62, 1
    s_cmp_lg_u32 s62, 0
    s_cbranch_scc1 L_ls_88
    s_mov_b32 s28, 7
    s_branch L_fail
L_lsok_89:
    v_add_f32 v204, v212, v216
    v_add_f32 v205, v213, v217
    v_mov_b32 v208, v204
    v_mov_b32 v209, v205
    s_nop 0
    v_permlane16_swap_b32 v204, v208
    v_permlane16_swap_b32 v205, v209
    v_add_f32 v204, v204, v208
    v_add_f32 v205, v205, v209
    v_mov_b32 v208, v204
    v_mov_b32 v209, v205
    s_nop 0
    v_permlane32_swap_b32 v204, v208
    v_permlane32_swap_b32 v205, v209
    v_add_f32 v204, v204, v208
    v_add_f32 v205, v205, v209
    v_mul_f32 v230, 0.0015625, v204
    v_mul_f32 v205, 0.0015625, v205
    v_fma_f32 v205, -v230, v230, v205
    v_max_f32_e64 v205, 0, v205
    v_add_f32 v205, 0x3727c5ac, v205
    v_rsq_f32 v232, v205
    s_nop 0
    v_mul_f32 v230, -v230, v232
    v_mov_b32 v233, v232
    v_mov_b32 v231, v230
    v_pk_fma_f32 v[24:25], v[4:5], v[232:233], v[230:231]
    v_pk_fma_f32 v[24:25], v[24:25], v[160:161], v[180:181]
    v_pk_fma_f32 v[26:27], v[6:7], v[232:233], v[230:231]
    v_pk_fma_f32 v[26:27], v[26:27], v[162:163], v[182:183]
    v_pk_fma_f32 v[28:29], v[8:9], v[232:233], v[230:231]
    v_pk_fma_f32 v[28:29], v[28:29], v[164:165], v[184:185]
    v_pk_fma_f32 v[30:31], v[10:11], v[232:233], v[230:231]
    v_pk_fma_f32 v[30:31], v[30:31], v[166:167], v[186:187]
    v_pk_fma_f32 v[32:33], v[12:13], v[232:233], v[230:231]
    v_pk_fma_f32 v[32:33], v[32:33], v[168:169], v[188:189]
    v_pk_fma_f32 v[34:35], v[14:15], v[232:233], v[230:231]
    v_pk_fma_f32 v[34:35], v[34:35], v[170:171], v[190:191]
    v_pk_fma_f32 v[36:37], v[16:17], v[232:233], v[230:231]
    v_pk_fma_f32 v[36:37], v[36:37], v[172:173], v[192:193]
    v_pk_fma_f32 v[38:39], v[18:19], v[232:233], v[230:231]
    v_pk_fma_f32 v[38:39], v[38:39], v[174:175], v[194:195]
    v_pk_fma_f32 v[40:41], v[20:21], v[232:233], v[230:231]
    v_pk_fma_f32 v[40:41], v[40:41], v[176:177], v[196:197]
    v_pk_fma_f32 v[42:43], v[22:23], v[232:233], v[230:231]
    v_pk_fma_f32 v[42:43], v[42:43], v[178:179], v[198:199]
    v_pk_add_f32 v[204:205], v[24:25], v[26:27]
    v_pk_mul_f32 v[206:207], v[24:25], v[24:25]
    v_pk_fma_f32 v[206:207], v[26:27], v[26:27], v[206:207]
    v_pk_add_f32 v[204:205], v[204:205], v[28:29]
    v_pk_fma_f32 v[206:207], v[28:29], v[28:29], v[206:207]
    v_pk_add_f32 v[204:205], v[204:205], v[30:31]
    v_pk_fma_f32 v[206:207], v[30:31], v[30:31], v[206:207]
    v_pk_add_f32 v[204:205], v[204:205], v[32:33]
    v_pk_fma_f32 v[206:207], v[32:33], v[32:33], v[206:207]
    v_pk_add_f32 v[204:205], v[204:205], v[34:35]
    v_pk_fma_f32 v[206:207], v[34:35], v[34:35], v[206:207]
    v_pk_add_f32 v[204:205], v[204:205], v[36:37]
    v_pk_fma_f32 v[206:207], v[36:37], v[36:37], v[206:207]
    v_pk_add_f32 v[204:205], v[204:205], v[38:39]
    v_pk_fma_f32 v[206:207], v[38:39], v[38:39], v[206:207]
    v_pk_add_f32 v[204:205], v[204:205], v[40:41]
    v_pk_fma_f32 v[206:207], v[40:41], v[40:41], v[206:207]
    v_pk_add_f32 v[204:205], v[204:205], v[42:43]
    v_pk_fma_f32 v[206:207], v[42:43], v[42:43], v[206:207]
    v_add_f32 v204, v204, v205
    v_add_f32 v205, v206, v207
    v_mov_b32 v208, v204
    v_mov_b32 v209, v205
    s_nop 0
    v_permlane16_swap_b32 v204, v208
    v_permlane16_swap_b32 v205, v209
    v_add_f32 v204, v204, v208
    v_add_f32 v205, v205, v209
    v_mov_b32 v208, v204
    v_mov_b32 v209, v205
    s_nop 0
    v_permlane32_swap_b32 v204, v208
    v_permlane32_swap_b32 v205, v209
    v_add_f32 v204, v204, v208
    v_add_f32 v205, v205, v209
    v_mov_b32 v206, s20
    v_mov_b32_e64 v207, s21
    s_lshl_b32 s66, s24, 13
    s_lshl_b32 s67, s22, 8
    s_add_u32 s66, s66, s67
    s_add_u32 s66, s66, 393216
    s_lshl_b32 s67, s23, 10
    s_add_u32 s67, s67, s66
    v_lshlrev_b32_e64 v208, 4, v1
    s_mov_b64 exec, 0xffff
    s_cmp_eq_u32 s3, 0
    s_cbranch_scc1 L_sl_91
    buffer_store_dwordx4 v[204:207], v208, s[4:7], s67 offen
    s_branch L_sj_92
L_sl_91:
    buffer_store_dwordx4 v[204:207], v208, s[4:7], s67 offen sc1
L_sj_92:
    s_mov_b64 exec, -1
    s_mov_b64 exec, -1
    s_nop 0
    v_lshl_add_u32 v209, v2, 11, v208
    s_mov_b32 s62, 400000
    buffer_load_dwordx4 v[212:215], v209, s[4:7], s66 offen sc1
    buffer_load_dwordx4 v[216:219], v209, s[4:7], s66 offen offset:1024 sc1
    buffer_load_dwordx4 v3, s[4:7], s95 offen offset:3072 lds
    s_add_u32 s94, s93, 32768
    s_mov_b32 m0, s94
    s_nop 0
    s_add_u32 s95, s90, 196608
    buffer_load_dwordx4 v3, s[4:7], s95 offen offset:0 lds
    buffer_load_dwordx4 v3, s[4:7], s95 offen offset:1024 lds
    s_waitcnt vmcnt(3)
    s_branch L_lsc_95
L_ls_93:
    buffer_load_dwordx4 v[212:215], v209, s[4:7], s66 offen sc1
    buffer_load_dwordx4 v[216:219], v209, s[4:7], s66 offen offset:1024 sc1
    s_waitcnt vmcnt(0)
L_lsc_95:
    v_cmp_ne_u32 vcc, s20, v214
    s_mov_b64 s[64:65], vcc
    v_cmp_ne_u32 vcc, s21, v215
    s_or_b64 s[64:65], s[64:65], vcc
    v_cmp_ne_u32 vcc, s20, v218
    s_or_b64 s[64:65], s[64:65], vcc
    v_cmp_ne_u32 vcc, s21, v219
    s_or_b64 s[64:65], s[64:65], vcc
    s_cmp_eq_u64 s[64:65], 0
    s_cbranch_scc1 L_lsok_94
    s_sub_u32 s62, s62, 1
    s_cmp_lg_u32 s62, 0
    s_cbranch_scc1 L_ls_93
    s_mov_b32 s28, 8
    s_branch L_fail
L_lsok_94:
    v_add_f32 v204, v212, v216
    v_add_f32 v205, v213, v217
    v_mov_b32 v208, v204
    v_mov_b32 v209, v205
    s_nop 0
    v_permlane16_swap_b32 v204, v208
    v_permlane16_swap_b32 v205, v209
    v_add_f32 v204, v204, v208
    v_add_f32 v205, v205, v209
    v_mov_b32 v208, v204
    v_mov_b32 v209, v205
    s_nop 0
    v_permlane32_swap_b32 v204, v208
    v_permlane32_swap_b32 v205, v209
    v_add_f32 v204, v204, v208
    v_add_f32 v205, v205, v209
    v_mul_f32 v230, 0.0015625, v204
    v_mul_f32 v205, 0.0015625, v205
    v_fma_f32 v205, -v230, v230, v205
    v_max_f32_e64 v205, 0, v205
    v_add_f32 v205, 0x3727c5ac, v205
    v_rsq_f32 v232, v205
    s_nop 0
    v_mul_f32 v230, -v230, v232
    v_mov_b32 v233, v232
    v_mov_b32 v231, v230
    v_pk_fma_f32 v[44:45], v[24:25], v[232:233], v[230:231]
    v_pk_fma_f32 v[46:47], v[26:27], v[232:233], v[230:231]
    v_pk_fma_f32 v[48:49], v[28:29], v[232:233], v[230:231]
    v_pk_fma_f32 v[50:51], v[30:31], v[232:233], v[230:231]
    v_pk_fma_f32 v[52:53], v[32:33], v[232:233], v[230:231]
    v_pk_fma_f32 v[54:55], v[34:35], v[232:233], v[230:231]
    v_pk_fma_f32 v[56:57], v[36:37], v[232:233], v[230:231]
    v_pk_fma_f32 v[58:59], v[38:39], v[232:233], v[230:231]
    v_pk_fma_f32 v[60:61], v[40:41], v[232:233], v[230:231]
    v_pk_fma_f32 v[62:63], v[42:43], v[232:233], v[230:231]
    v_cvt_pk_bf16_f32 v44, v44, v45
    v_cvt_pk_bf16_f32 v45, v46, v47
    v_cvt_pk_bf16_f32 v46, v48, v49
    v_cvt_pk_bf16_f32 v47, v50, v51
    v_cvt_pk_bf16_f32 v48, v52, v53
    v_cvt_pk_bf16_f32 v49, v54, v55
    v_cvt_pk_bf16_f32 v50, v56, v57
    v_cvt_pk_bf16_f32 v51, v58, v59
    v_cvt_pk_bf16_f32 v52, v60, v61
    v_cvt_pk_bf16_f32 v53, v62, v63
    s_mul_i32 s66, s27, 20480
    s_add_u32 s66, s66, 4718592
    s_lshr_b32 s67, s29, 1
    s_lshl_b32 s67, s67, 10
    s_add_u32 s67, s67, s66
    s_bitcmp1_b32 s29, 0
    s_cbranch_scc1 L_so_96
    s_cmp_eq_u32 s3, 0
    s_cbranch_scc1 L_sl_98
    s_nop 0
    buffer_store_dwordx4 v[44:47], v3, s[4:7], s67 offen offset:0
    buffer_store_dwordx4 v[48:51], v3, s[4:7], s67 offen offset:1024
    buffer_store_dwordx2 v[52:53], v203, s[4:7], s67 offen offset:2048
    s_branch L_sj_99
L_sl_98:
    s_nop 0
    buffer_store_dwordx4 v[44:47], v3, s[4:7], s67 offen offset:0 sc1
    buffer_store_dwordx4 v[48:51], v3, s[4:7], s67 offen offset:1024 sc1
    buffer_store_dwordx2 v[52:53], v203, s[4:7], s67 offen offset:2048 sc1
L_sj_99:
    s_branch L_sj_97
L_so_96:
    s_cmp_eq_u32 s3, 0
    s_cbranch_scc1 L_sl_100
    s_nop 0
    buffer_store_dwordx2 v[44:45], v203, s[4:7], s67 offen offset:512
    buffer_store_dwordx4 v[46:49], v3, s[4:7], s67 offen offset:1024
    buffer_store_dwordx4 v[50:53], v3, s[4:7], s67 offen offset:2048
    s_branch L_sj_101
L_sl_100:
    s_nop 0
    buffer_store_dwordx2 v[44:45], v203, s[4:7], s67 offen offset:512 sc1
    buffer_store_dwordx4 v[46:49], v3, s[4:7], s67 offen offset:1024 sc1
    buffer_store_dwordx4 v[50:53], v3, s[4:7], s67 offen offset:2048 sc1
L_sj_101:
L_sj_97:
    v_mov_b32 v254, s20
    v_mov_b32_e64 v255, s21
    s_lshl_b32 s62, s27, 7
    s_lshl_b32 s63, s23, 3
    s_add_u32 s62, s62, s63
    s_add_u32 s62, s62, 27086848
    v_mov_b32_e64 v253, s62
    s_mov_b32 s63, 131072
    s_waitcnt vmcnt(0)
    s_mov_b64 exec, 1
    s_cmp_eq_u32 s3, 0
    s_cbranch_scc1 L_sl_102
    buffer_store_dwordx2 v[254:255], v253, s[4:7], s63 offen
    s_branch L_sj_103
L_sl_102:
    buffer_store_dwordx2 v[254:255], v253, s[4:7], 0 offen sc1
L_sj_103:
    s_mov_b64 exec, -1
    s_barrier
    v_mov_b32 v251, s27
    v_lshrrev_b32_e64 v250, 4, v251
    s_lshr_b32 s62, s24, 2
    v_cmp_eq_u32 vcc, s62, v250
    s_mul_i32 s62, s3, 131072
    v_mov_b32 v252, s62
    v_cndmask_b32 v250, 0, v252, vcc
    v_lshl_add_u32 v251, v251, 7, v250
    v_and_b32_e64 v252, 7, v0
    v_lshl_add_u32 v251, v252, 3, v251
    s_mov_b32 s63, 27086848
    s_mov_b32 s62, 400000
    buffer_load_dwordx2 v[254:255], v251, s[4:7], s63 offen sc1
    buffer_load_dwordx4 v3, s[4:7], s95 offen offset:2048 lds
    buffer_load_dwordx4 v3, s[4:7], s95 offen offset:3072 lds
    s_add_u32 s94, s93, 49152
    s_mov_b32 m0, s94
    s_nop 0
    s_add_u32 s95, s90, 212992
    buffer_load_dwordx4 v3, s[4:7], s95 offen offset:0 lds
    s_waitcnt vmcnt(3)
    v_cmp_ne_u32 vcc, s20, v254
    s_mov_b64 s[64:65], vcc
    v_cmp_ne_u32 vcc, s21, v255
    s_or_b64 s[64:65], s[64:65], vcc
    s_cmp_eq_u64 s[64:65], 0
    s_cbranch_scc1 L_wfok_105
    buffer_load_dwordx2 v[254:255], v251, s[4:7], s63 offen sc1
L_wfp_104:
    s_sleep 2
    buffer_load_dwordx2 v[252:253], v251, s[4:7], s63 offen sc1
    s_waitcnt vmcnt(1)
    v_cmp_ne_u32 vcc, s20, v254
    s_mov_b64 s[64:65], vcc
    v_cmp_ne_u32 vcc, s21, v255
    s_or_b64 s[64:65], s[64:65], vcc
    s_cmp_eq_u64 s[64:65], 0
    s_cbranch_scc1 L_wfo2_106
    s_sleep 2
    buffer_load_dwordx2 v[254:255], v251, s[4:7], s63 offen sc1
    s_waitcnt vmcnt(1)
    v_cmp_ne_u32 vcc, s20, v252
    s_mov_b64 s[64:65], vcc
    v_cmp_ne_u32 vcc, s21, v253
    s_or_b64 s[64:65], s[64:65], vcc
    s_cmp_eq_u64 s[64:65], 0
    s_cbranch_scc1 L_wfo2_106
    s_sub_u32 s62, s62, 1
    s_cmp_lg_u32 s62, 0
    s_cbranch_scc1 L_wfp_104
    s_mov_b32 s28, 9
    s_branch L_fail
L_wfo2_106:
L_wfok_105:
    s_mul_i32 s30, s27, 20480
    s_add_u32 s30, s30, 4718592
    buffer_load_dwordx4 v3, s[4:7], s95 offen offset:1024 lds
    buffer_load_dwordx4 v3, s[4:7], s95 offen offset:2048 lds
    buffer_load_dwordx4 v3, s[4:7], s95 offen offset:3072 lds
    s_add_u32 s88, s30, 0
    s_nop 0
    buffer_load_dwordx4 a[16:19], v3, s[4:7], s88 offen offset:0 sc1
    buffer_load_dwordx4 a[20:23], v3, s[4:7], s88 offen offset:1024 sc1
    buffer_load_dwordx2 a[24:25], v203, s[4:7], s88 offen offset:2048 sc1
    buffer_load_dwordx2 a[26:27], v203, s[4:7], s88 offen offset:2560 sc1
    buffer_load_dwordx4 a[28:31], v3, s[4:7], s88 offen offset:3072 sc1
    s_add_u32 s88, s30, 4096
    buffer_load_dwordx4 a[32:35], v3, s[4:7], s88 offen offset:0 sc1
    buffer_load_dwordx4 a[36:39], v3, s[4:7], s88 offen offset:1024 sc1
    ds_read_b128 v[100:103], v201 offset:40960
    ds_read_b128 v[104:107], v201 offset:41984
    ds_read_b128 v[108:111], v201 offset:43008
    ds_read_b128 v[112:115], v201 offset:44032
    ds_read_b128 v[116:119], v201 offset:45056
    ds_read_b128 v[120:123], v201 offset:46080
    ds_read_b128 v[124:127], v201 offset:47104
    ds_read_b128 v[128:131], v201 offset:48128
    ds_read_b128 v[132:135], v201 offset:49152
    ds_read_b128 v[136:139], v201 offset:50176
    s_waitcnt lgkmcnt(5)
    s_waitcnt vmcnt(6)
    v_mfma_f32_16x16x32_bf16 v[44:47], v[100:103], a[16:19], 0
    ds_read_b128 v[140:143], v201 offset:51200
    buffer_load_dwordx4 a[40:43], v3, s[4:7], s88 offen offset:2048 sc1
    v_mfma_f32_16x16x32_bf16 v[48:51], v[104:107], a[16:19], 0
    ds_read_b128 v[144:147], v201 offset:52224
    v_mfma_f32_16x16x32_bf16 v[52:55], v[108:111], a[16:19], 0
    ds_read_b128 v[148:151], v201 offset:53248
    v_mfma_f32_16x16x32_bf16 v[56:59], v[112:115], a[16:19], 0
    ds_read_b128 v[152:155], v201 offset:54272
    v_mfma_f32_16x16x32_bf16 v[60:63], v[116:119], a[16:19], 0
    ds_read_b128 v[156:159], v201 offset:55296
    s_waitcnt lgkmcnt(5)
    s_waitcnt vmcnt(6)
    v_mfma_f32_16x16x32_bf16 v[44:47], v[120:123], a[20:23], v[44:47]
    ds_read_b128 v[100:103], v201 offset:56320
    buffer_load_dwordx2 a[44:45], v203, s[4:7], s88 offen offset:3072 sc1
    buffer_load_dwordx2 a[46:47], v203, s[4:7], s88 offen offset:3584 sc1
    v_mfma_f32_16x16x32_bf16 v[48:51], v[124:127], a[20:23], v[48:51]
    ds_read_b128 v[104:107], v201 offset:57344
    v_mfma_f32_16x16x32_bf16 v[52:55], v[128:131], a[20:23], v[52:55]
    ds_read_b128 v[108:111], v201 offset:58368
    v_mfma_f32_16x16x32_bf16 v[56:59], v[132:135], a[20:23], v[56:59]
    ds_read_b128 v[112:115], v201 offset:59392
    v_mfma_f32_16x16x32_bf16 v[60:63], v[136:139], a[20:23], v[60:63]
    ds_read_b128 v[116:119], v201 offset:60416
    s_barrier
    s_waitcnt lgkmcnt(5)
    s_waitcnt vmcnt(6)
    s_nop 0
    v_mfma_f32_16x16x32_bf16 v[44:47], v[140:143], a[24:27], v[44:47]
    ds_read_b128 v[120:123], v202 offset:0
    s_add_u32 s88, s30, 8192
    buffer_load_dwordx4 a[48:51], v3, s[4:7], s88 offen offset:0 sc1
    v_mfma_f32_16x16x32_bf16 v[48:51], v[144:147], a[24:27], v[48:51]
    ds_read_b128 v[124:127], v202 offset:1024
    v_mfma_f32_16x16x32_bf16 v[52:55], v[148:151], a[24:27], v[52:55]
    ds_read_b128 v[128:131], v202 offset:2048
    v_mfma_f32_16x16x32_bf16 v[56:59], v[152:155], a[24:27], v[56:59]
    ds_read_b128 v[132:135], v202 offset:3072
    v_mfma_f32_16x16x32_bf16 v[60:63], v[156:159], a[24:27], v[60:63]
    ds_read_b128 v[136:139], v202 offset:4096
    s_waitcnt lgkmcnt(5)
    s_waitcnt vmcnt(6)
    v_mfma_f32_16x16x32_bf16 v[44:47], v[100:103], a[28:31], v[44:47]
    ds_read_b128 v[140:143], v202 offset:5120
    buffer_load_dwordx4 a[52:55], v3, s[4:7], s88 offen offset:1024 sc1
    v_mfma_f32_16x16x32_bf16 v[48:51], v[104:107], a[28:31], v[48:51]
    ds_read_b128 v[144:147], v202 offset:6144
    v_mfma_f32_16x16x32_bf16 v[52:55], v[108:111], a[28:31], v[52:55]
    ds_read_b128 v[148:151], v202 offset:7168
    buffer_load_dwordx4 a[56:59], v3, s[4:7], s88 offen offset:2048 sc1
    v_mfma_f32_16x16x32_bf16 v[56:59], v[112:115], a[28:31], v[56:59]
    ds_read_b128 v[152:155], v202 offset:8192
    v_mfma_f32_16x16x32_bf16 v[60:63], v[116:119], a[28:31], v[60:63]
    ds_read_b128 v[156:159], v202 offset:9216
    s_waitcnt lgkmcnt(5)
    s_waitcnt vmcnt(7)
    v_mfma_f32_16x16x32_bf16 v[44:47], v[120:123], a[32:35], v[44:47]
    ds_read_b128 v[100:103], v202 offset:10240
    buffer_load_dwordx4 a[60:63], v3, s[4:7], s88 offen offset:3072 sc1
    v_mfma_f32_16x16x32_bf16 v[48:51], v[124:127], a[32:35], v[48:51]
    ds_read_b128 v[104:107], v202 offset:11264
    v_mfma_f32_16x16x32_bf16 v[52:55], v[128:131], a[32:35], v[52:55]
    ds_read_b128 v[108:111], v202 offset:12288
    v_mfma_f32_16x16x32_bf16 v[56:59], v[132:135], a[32:35], v[56:59]
    ds_read_b128 v[112:115], v202 offset:13312
    v_mfma_f32_16x16x32_bf16 v[60:63], v[136:139], a[32:35], v[60:63]
    ds_read_b128 v[116:119], v202 offset:14336
    s_waitcnt lgkmcnt(5)
    s_waitcnt vmcnt(7)
    v_mfma_f32_16x16x32_bf16 v[44:47], v[140:143], a[36:39], v[44:47]
    ds_read_b128 v[120:123], v202 offset:15360
    s_add_u32 s88, s30, 12288
    buffer_load_dwordx2 a[64:65], v203, s[4:7], s88 offen offset:0 sc1
    buffer_load_dwordx2 a[66:67], v203, s[4:7], s88 offen offset:512 sc1
    v_mfma_f32_16x16x32_bf16 v[48:51], v[144:147], a[36:39], v[48:51]
    ds_read_b128 v[124:127], v202 offset:16384
    v_mfma_f32_16x16x32_bf16 v[52:55], v[148:151], a[36:39], v[52:55]
    ds_read_b128 v[128:131], v202 offset:17408
    v_mfma_f32_16x16x32_bf16 v[56:59], v[152:155], a[36:39], v[56:59]
    ds_read_b128 v[132:135], v202 offset:18432
    v_mfma_f32_16x16x32_bf16 v[60:63], v[156:159], a[36:39], v[60:63]
    ds_read_b128 v[136:139], v202 offset:19456
    s_barrier
    s_waitcnt lgkmcnt(5)
    s_waitcnt vmcnt(8)
    s_nop 0
    v_mfma_f32_16x16x32_bf16 v[44:47], v[100:103], a[40:43], v[44:47]
    ds_read_b128 v[140:143], v202 offset:20480
    buffer_load_dwordx4 a[68:71], v3, s[4:7], s88 offen offset:1024 sc1
    v_mfma_f32_16x16x32_bf16 v[48:51], v[104:107], a[40:43], v[48:51]
    ds_read_b128 v[144:147], v202 offset:21504
    v_mfma_f32_16x16x32_bf16 v[52:55], v[108:111], a[40:43], v[52:55]
    ds_read_b128 v[148:151], v202 offset:22528
    buffer_load_dwordx4 a[72:75], v3, s[4:7], s88 offen offset:2048 sc1
    v_mfma_f32_16x16x32_bf16 v[56:59], v[112:115], a[40:43], v[56:59]
    ds_read_b128 v[152:155], v202 offset:23552
    v_mfma_f32_16x16x32_bf16 v[60:63], v[116:119], a[40:43], v[60:63]
    ds_read_b128 v[156:159], v202 offset:24576
    s_waitcnt lgkmcnt(5)
    s_waitcnt vmcnt(8)
    v_mfma_f32_16x16x32_bf16 v[44:47], v[120:123], a[44:47], v[44:47]
    ds_read_b128 v[100:103], v202 offset:25600
    buffer_load_dwordx4 a[76:79], v3, s[4:7], s88 offen offset:3072 sc1
    v_mfma_f32_16x16x32_bf16 v[48:51], v[124:127], a[44:47], v[48:51]
    ds_read_b128 v[104:107], v202 offset:26624
    v_mfma_f32_16x16x32_bf16 v[52:55], v[128:131], a[44:47], v[52:55]
    ds_read_b128 v[108:111], v202 offset:27648
    v_mfma_f32_16x16x32_bf16 v[56:59], v[132:135], a[44:47], v[56:59]
    ds_read_b128 v[112:115], v202 offset:28672
    v_mfma_f32_16x16x32_bf16 v[60:63], v[136:139], a[44:47], v[60:63]
    ds_read_b128 v[116:119], v202 offset:29696
    s_waitcnt lgkmcnt(5)
    s_waitcnt vmcnt(8)
    v_mfma_f32_16x16x32_bf16 v[44:47], v[140:143], a[48:51], v[44:47]
    ds_read_b128 v[120:123], v202 offset:30720
    s_add_u32 s88, s30, 16384
    buffer_load_dwordx4 a[80:83], v3, s[4:7], s88 offen offset:0 sc1
    v_mfma_f32_16x16x32_bf16 v[48:51], v[144:147], a[48:51], v[48:51]
    ds_read_b128 v[124:127], v202 offset:31744
    v_mfma_f32_16x16x32_bf16 v[52:55], v[148:151], a[48:51], v[52:55]
    ds_read_b128 v[128:131], v202 offset:32768
    v_mfma_f32_16x16x32_bf16 v[56:59], v[152:155], a[48:51], v[56:59]
    ds_read_b128 v[132:135], v202 offset:33792
    v_mfma_f32_16x16x32_bf16 v[60:63], v[156:159], a[48:51], v[60:63]
    ds_read_b128 v[136:139], v202 offset:34816
    s_waitcnt lgkmcnt(5)
    s_waitcnt vmcnt(8)
    v_mfma_f32_16x16x32_bf16 v[44:47], v[100:103], a[52:55], v[44:47]
    ds_read_b128 v[140:143], v202 offset:35840
    buffer_load_dwordx2 a[84:85], v203, s[4:7], s88 offen offset:1024 sc1
    buffer_load_dwordx2 a[86:87], v203, s[4:7], s88 offen offset:1536 sc1
    v_mfma_f32_16x16x32_bf16 v[48:51], v[104:107], a[52:55], v[48:51]
    ds_read_b128 v[144:147], v202 offset:36864
    v_mfma_f32_16x16x32_bf16 v[52:55], v[108:111], a[52:55], v[52:55]
    ds_read_b128 v[148:151], v202 offset:37888
    buffer_load_dwordx4 a[88:91], v3, s[4:7], s88 offen offset:2048 sc1
    v_mfma_f32_16x16x32_bf16 v[56:59], v[112:115], a[52:55], v[56:59]
    ds_read_b128 v[152:155], v202 offset:38912
    v_mfma_f32_16x16x32_bf16 v[60:63], v[116:119], a[52:55], v[60:63]
    ds_read_b128 v[156:159], v202 offset:39936
    s_barrier
    s_waitcnt lgkmcnt(5)
    s_waitcnt vmcnt(10)
    s_nop 0
    v_mfma_f32_16x16x32_bf16 v[44:47], v[120:123], a[56:59], v[44:47]
    ds_read_b128 v[100:103], v200 offset:0
    buffer_load_dwordx4 a[92:95], v3, s[4:7], s88 offen offset:3072 sc1
    v_mfma_f32_16x16x32_bf16 v[48:51], v[124:127], a[56:59], v[48:51]
    ds_read_b128 v[104:107], v200 offset:1024
    v_mfma_f32_16x16x32_bf16 v[52:55], v[128:131], a[56:59], v[52:55]
    ds_read_b128 v[108:111], v200 offset:2048
    v_mfma_f32_16x16x32_bf16 v[56:59], v[132:135], a[56:59], v[56:59]
    ds_read_b128 v[112:115], v200 offset:3072
    v_mfma_f32_16x16x32_bf16 v[60:63], v[136:139], a[56:59], v[60:63]
    ds_read_b128 v[116:119], v200 offset:4096
    s_waitcnt lgkmcnt(5)
    s_waitcnt vmcnt(10)
    v_mfma_f32_16x16x32_bf16 v[44:47], v[140:143], a[60:63], v[44:47]
    ds_read_b128 v[120:123], v200 offset:5120
    s_add_u32 s94, s93, 65536
    s_mov_b32 m0, s94
    s_nop 0
    s_add_u32 s95, s90, 229376
    buffer_load_dwordx4 v3, s[4:7], s95 offen offset:0 lds
    v_mfma_f32_16x16x32_bf16 v[48:51], v[144:147], a[60:63], v[48:51]
    ds_read_b128 v[124:127], v200 offset:6144
    v_mfma_f32_16x16x32_bf16 v[52:55], v[148:151], a[60:63], v[52:55]
    ds_read_b128 v[128:131], v200 offset:7168
    v_mfma_f32_16x16x32_bf16 v[56:59], v[152:155], a[60:63], v[56:59]
    ds_read_b128 v[132:135], v200 offset:8192
    v_mfma_f32_16x16x32_bf16 v[60:63], v[156:159], a[60:63], v[60:63]
    ds_read_b128 v[136:139], v200 offset:9216
    s_waitcnt lgkmcnt(5)
    s_waitcnt vmcnt(9)
    v_mfma_f32_16x16x32_bf16 v[44:47], v[100:103], a[64:67], v[44:47]
    ds_read_b128 v[140:143], v200 offset:10240
    buffer_load_dwordx4 v3, s[4:7], s95 offen offset:1024 lds
    v_mfma_f32_16x16x32_bf16 v[48:51], v[104:107], a[64:67], v[48:51]
    ds_read_b128 v[144:147], v200 offset:11264
    v_mfma_f32_16x16x32_bf16 v[52:55], v[108:111], a[64:67], v[52:55]
    ds_read_b128 v[148:151], v200 offset:12288
    v_mfma_f32_16x16x32_bf16 v[56:59], v[112:115], a[64:67], v[56:59]
    ds_read_b128 v[152:155], v200 offset:13312
    v_mfma_f32_16x16x32_bf16 v[60:63], v[116:119], a[64:67], v[60:63]
    ds_read_b128 v[156:159], v200 offset:14336
    s_waitcnt lgkmcnt(5)
    s_waitcnt vmcnt(9)
    v_mfma_f32_16x16x32_bf16 v[44:47], v[120:123], a[68:71], v[44:47]
    ds_read_b128 v[100:103], v200 offset:15360
    buffer_load_dwordx4 v3, s[4:7], s95 offen offset:2048 lds
    v_mfma_f32_16x16x32_bf16 v[48:51], v[124:127], a[68:71], v[48:51]
    ds_read_b128 v[104:107], v200 offset:16384
    v_mfma_f32_16x16x32_bf16 v[52:55], v[128:131], a[68:71], v[52:55]
    ds_read_b128 v[108:111], v200 offset:17408
    buffer_load_dwordx4 v3, s[4:7], s95 offen offset:3072 lds
    v_mfma_f32_16x16x32_bf16 v[56:59], v[132:135], a[68:71], v[56:59]
    ds_read_b128 v[112:115], v200 offset:18432
    v_mfma_f32_16x16x32_bf16 v[60:63], v[136:139], a[68:71], v[60:63]
    ds_read_b128 v[116:119], v200 offset:19456
    s_barrier
    s_waitcnt lgkmcnt(5)
    s_waitcnt vmcnt(10)
    s_nop 0
    v_mfma_f32_16x16x32_bf16 v[44:47], v[140:143], a[72:75], v[44:47]
    ds_read_b128 v[120:123], v200 offset:20480
    s_add_u32 s94, s93, 81920
    s_mov_b32 m0, s94
    s_nop 0
    s_add_u32 s95, s90, 245760
    buffer_load_dwordx4 v3, s[4:7], s95 offen offset:0 lds
    v_mfma_f32_16x16x32_bf16 v[48:51], v[144:147], a[72:75], v[48:51]
    ds_read_b128 v[124:127], v200 offset:21504
    v_mfma_f32_16x16x32_bf16 v[52:55], v[148:151], a[72:75], v[52:55]
    ds_read_b128 v[128:131], v200 offset:22528
    v_mfma_f32_16x16x32_bf16 v[56:59], v[152:155], a[72:75], v[56:59]
    ds_read_b128 v[132:135], v200 offset:23552
    v_mfma_f32_16x16x32_bf16 v[60:63], v[156:159], a[72:75], v[60:63]
    ds_read_b128 v[136:139], v200 offset:24576
    s_waitcnt lgkmcnt(5)
    s_waitcnt vmcnt(10)
    v_mfma_f32_16x16x32_bf16 v[44:47], v[100:103], a[76:79], v[44:47]
    ds_read_b128 v[140:143], v200 offset:25600
    buffer_load_dwordx4 v3, s[4:7], s95 offen offset:1024 lds
    v_mfma_f32_16x16x32_bf16 v[48:51], v[104:107], a[76:79], v[48:51]
    ds_read_b128 v[144:147], v200 offset:26624
    v_mfma_f32_16x16x32_bf16 v[52:55], v[108:111], a[76:79], v[52:55]
    ds_read_b128 v[148:151], v200 offset:27648
    v_mfma_f32_16x16x32_bf16 v[56:59], v[112:115], a[76:79], v[56:59]
    ds_read_b128 v[152:155], v200 offset:28672
    v_mfma_f32_16x16x32_bf16 v[60:63], v[116:119], a[76:79], v[60:63]
    ds_read_b128 v[156:159], v200 offset:29696
    s_waitcnt lgkmcnt(5)
    s_waitcnt vmcnt(10)
    v_mfma_f32_16x16x32_bf16 v[44:47], v[120:123], a[80:83], v[44:47]
    ds_read_b128 v[100:103], v200 offset:30720
    buffer_load_dwordx4 v3, s[4:7], s95 offen offset:2048 lds
    v_mfma_f32_16x16x32_bf16 v[48:51], v[124:127], a[80:83], v[48:51]
    ds_read_b128 v[104:107], v200 offset:31744
    v_mfma_f32_16x16x32_bf16 v[52:55], v[128:131], a[80:83], v[52:55]
    ds_read_b128 v[108:111], v200 offset:32768
    buffer_load_dwordx4 v3, s[4:7], s95 offen offset:3072 lds
    v_mfma_f32_16x16x32_bf16 v[56:59], v[132:135], a[80:83], v[56:59]
    ds_read_b128 v[112:115], v200 offset:33792
    v_mfma_f32_16x16x32_bf16 v[60:63], v[136:139], a[80:83], v[60:63]
    ds_read_b128 v[116:119], v200 offset:34816
    s_waitcnt lgkmcnt(5)
    s_waitcnt vmcnt(10)
    v_mfma_f32_16x16x32_bf16 v[44:47], v[140:143], a[84:87], v[44:47]
    ds_read_b128 v[120:123], v200 offset:35840
    s_add_u32 s94, s93, 98304
    s_mov_b32 m0, s94
    s_nop 0
    s_add_u32 s95, s90, 262144
    buffer_load_dwordx4 v3, s[4:7], s95 offen offset:0 lds
    v_mfma_f32_16x16x32_bf16 v[48:51], v[144:147], a[84:87], v[48:51]
    ds_read_b128 v[124:127], v200 offset:36864
    v_mfma_f32_16x16x32_bf16 v[52:55], v[148:151], a[84:87], v[52:55]
    ds_read_b128 v[128:131], v200 offset:37888
    v_mfma_f32_16x16x32_bf16 v[56:59], v[152:155], a[84:87], v[56:59]
    ds_read_b128 v[132:135], v200 offset:38912
    v_mfma_f32_16x16x32_bf16 v[60:63], v[156:159], a[84:87], v[60:63]
    ds_read_b128 v[136:139], v200 offset:39936
    s_waitcnt lgkmcnt(5)
    s_waitcnt vmcnt(10)
    v_mfma_f32_16x16x32_bf16 v[44:47], v[100:103], a[88:91], v[44:47]
    buffer_load_dwordx4 v3, s[4:7], s95 offen offset:1024 lds
    v_mfma_f32_16x16x32_bf16 v[48:51], v[104:107], a[88:91], v[48:51]
    v_mfma_f32_16x16x32_bf16 v[52:55], v[108:111], a[88:91], v[52:55]
    v_mfma_f32_16x16x32_bf16 v[56:59], v[112:115], a[88:91], v[56:59]
    v_mfma_f32_16x16x32_bf16 v[60:63], v[116:119], a[88:91], v[60:63]
    s_waitcnt lgkmcnt(0)
    s_waitcnt vmcnt(10)
    v_mfma_f32_16x16x32_bf16 v[44:47], v[120:123], a[92:95], v[44:47]
    buffer_load_dwordx4 v3, s[4:7], s95 offen offset:2048 lds
    v_mfma_f32_16x16x32_bf16 v[48:51], v[124:127], a[92:95], v[48:51]
    v_mfma_f32_16x16x32_bf16 v[52:55], v[128:131], a[92:95], v[52:55]
    buffer_load_dwordx4 v3, s[4:7], s95 offen offset:3072 lds
    v_mfma_f32_16x16x32_bf16 v[56:59], v[132:135], a[92:95], v[56:59]
    v_mfma_f32_16x16x32_bf16 v[60:63], v[136:139], a[92:95], v[60:63]
    s_barrier
    s_mul_i32 s67, s23, 320
    v_lshlrev_b32 v244, 4, v2
    s_add_u32 s67, s67, 12800
    buffer_load_dwordx2 a[240:241], v244, s[4:7], s67 offen offset:0 sc1
    buffer_load_dwordx2 a[242:243], v244, s[4:7], s67 offen offset:64 sc1
    buffer_load_dwordx2 a[244:245], v244, s[4:7], s67 offen offset:128 sc1
    buffer_load_dwordx2 a[246:247], v244, s[4:7], s67 offen offset:192 sc1
    buffer_load_dwordx2 a[248:249], v244, s[4:7], s67 offen offset:256 sc1
    s_mov_b32 s70, 0xbdd2d3e8
    s_mov_b32 s71, 0xbdd2d3e8
    v_mov_b32 v212, 0xc0135761
    v_mov_b32 v213, 0xc0135761
    v_mov_b32 v214, 1.0
    v_mov_b32 v215, 1.0
    v_pk_mul_f32 v[204:205], v[44:45], v[44:45]
    v_pk_mul_f32 v[206:207], v[46:47], v[46:47]
    v_pk_fma_f32 v[204:205], v[204:205], s[70:71], v[212:213]
    v_pk_fma_f32 v[206:207], v[206:207], s[70:71], v[212:213]
    v_pk_mul_f32 v[204:205], v[204:205], v[44:45]
    v_pk_mul_f32 v[206:207], v[206:207], v[46:47]
    v_exp_f32 v204, v204
    v_exp_f32 v205, v205
    v_exp_f32 v206, v206
    v_exp_f32 v207, v207
    v_pk_add_f32 v[204:205], v[204:205], v[214:215]
    v_pk_add_f32 v[206:207], v[206:207], v[214:215]
    v_rcp_f32 v204, v204
    v_rcp_f32 v205, v205
    v_rcp_f32 v206, v206
    v_rcp_f32 v207, v207
    v_pk_mul_f32 v[44:45], v[44:45], v[204:205]
    v_pk_mul_f32 v[46:47], v[46:47], v[206:207]
    s_add_u32 s94, s93, 114688
    s_mov_b32 m0, s94
    s_nop 0
    s_add_u32 s95, s90, 278528
    buffer_load_dwordx4 v3, s[4:7], s95 offen offset:0 lds
    v_pk_mul_f32 v[204:205], v[48:49], v[48:49]
    v_pk_mul_f32 v[206:207], v[50:51], v[50:51]
    v_pk_fma_f32 v[204:205], v[204:205], s[70:71], v[212:213]
    v_pk_fma_f32 v[206:207], v[206:207], s[70:71], v[212:213]
    v_pk_mul_f32 v[204:205], v[204:205], v[48:49]
    v_pk_mul_f32 v[206:207], v[206:207], v[50:51]
    v_exp_f32 v204, v204
    v_exp_f32 v205, v205
    v_exp_f32 v206, v206
    v_exp_f32 v207, v207
    v_pk_add_f32 v[204:205], v[204:205], v[214:215]
    v_pk_add_f32 v[206:207], v[206:207], v[214:215]
    v_rcp_f32 v204, v204
    v_rcp_f32 v205, v205
    v_rcp_f32 v206, v206
    v_rcp_f32 v207, v207
    v_pk_mul_f32 v[48:49], v[48:49], v[204:205]
    v_pk_mul_f32 v[50:51], v[50:51], v[206:207]
    buffer_load_dwordx4 v3, s[4:7], s95 offen offset:1024 lds
    v_pk_mul_f32 v[204:205], v[52:53], v[52:53]
    v_pk_mul_f32 v[206:207], v[54:55], v[54:55]
    v_pk_fma_f32 v[204:205], v[204:205], s[70:71], v[212:213]
    v_pk_fma_f32 v[206:207], v[206:207], s[70:71], v[212:213]
    v_pk_mul_f32 v[204:205], v[204:205], v[52:53]
    v_pk_mul_f32 v[206:207], v[206:207], v[54:55]
    v_exp_f32 v204, v204
    v_exp_f32 v205, v205
    v_exp_f32 v206, v206
    v_exp_f32 v207, v207
    v_pk_add_f32 v[204:205], v[204:205], v[214:215]
    v_pk_add_f32 v[206:207], v[206:207], v[214:215]
    v_rcp_f32 v204, v204
    v_rcp_f32 v205, v205
    v_rcp_f32 v206, v206
    v_rcp_f32 v207, v207
    v_pk_mul_f32 v[52:53], v[52:53], v[204:205]
    v_pk_mul_f32 v[54:55], v[54:55], v[206:207]
    buffer_load_dwordx4 v3, s[4:7], s95 offen offset:2048 lds
    v_pk_mul_f32 v[204:205], v[56:57], v[56:57]
    v_pk_mul_f32 v[206:207], v[58:59], v[58:59]
    v_pk_fma_f32 v[204:205], v[204:205], s[70:71], v[212:213]
    v_pk_fma_f32 v[206:207], v[206:207], s[70:71], v[212:213]
    v_pk_mul_f32 v[204:205], v[204:205], v[56:57]
    v_pk_mul_f32 v[206:207], v[206:207], v[58:59]
    v_exp_f32 v204, v204
    v_exp_f32 v205, v205
    v_exp_f32 v206, v206
    v_exp_f32 v207, v207
    v_pk_add_f32 v[204:205], v[204:205], v[214:215]
    v_pk_add_f32 v[206:207], v[206:207], v[214:215]
    v_rcp_f32 v204, v204
    v_rcp_f32 v205, v205
    v_rcp_f32 v206, v206
    v_rcp_f32 v207, v207
    v_pk_mul_f32 v[56:57], v[56:57], v[204:205]
    v_pk_mul_f32 v[58:59], v[58:59], v[206:207]
    buffer_load_dwordx4 v3, s[4:7], s95 offen offset:3072 lds
    v_pk_mul_f32 v[204:205], v[60:61], v[60:61]
    v_pk_mul_f32 v[206:207], v[62:63], v[62:63]
    v_pk_fma_f32 v[204:205], v[204:205], s[70:71], v[212:213]
    v_pk_fma_f32 v[206:207], v[206:207], s[70:71], v[212:213]
    v_pk_mul_f32 v[204:205], v[204:205], v[60:61]
    v_pk_mul_f32 v[206:207], v[206:207], v[62:63]
    v_exp_f32 v204, v204
    v_exp_f32 v205, v205
    v_exp_f32 v206, v206
    v_exp_f32 v207, v207
    v_pk_add_f32 v[204:205], v[204:205], v[214:215]
    v_pk_add_f32 v[206:207], v[206:207], v[214:215]
    v_rcp_f32 v204, v204
    v_rcp_f32 v205, v205
    v_rcp_f32 v206, v206
    v_rcp_f32 v207, v207
    v_pk_mul_f32 v[60:61], v[60:61], v[204:205]
    v_pk_mul_f32 v[62:63], v[62:63], v[206:207]
    s_add_u32 s94, s93, 131072
    s_mov_b32 m0, s94
    s_nop 0
    s_add_u32 s95, s90, 294912
    buffer_load_dwordx4 v3, s[4:7], s95 offen offset:0 lds
    v_cvt_pk_bf16_f32 v44, v44, v45
    v_cvt_pk_bf16_f32 v45, v46, v47
    v_cvt_pk_bf16_f32 v46, v48, v49
    v_cvt_pk_bf16_f32 v47, v50, v51
    v_cvt_pk_bf16_f32 v48, v52, v53
    v_cvt_pk_bf16_f32 v49, v54, v55
    v_cvt_pk_bf16_f32 v50, v56, v57
    v_cvt_pk_bf16_f32 v51, v58, v59
    v_cvt_pk_bf16_f32 v52, v60, v61
    v_cvt_pk_bf16_f32 v53, v62, v63
    s_mul_i32 s66, s27, 20480
    s_add_u32 s66, s66, 2097152
    s_lshr_b32 s67, s29, 1
    s_lshl_b32 s67, s67, 10
    s_add_u32 s67, s67, s66
    s_bitcmp1_b32 s29, 0
    s_cbranch_scc1 L_so_107
    s_cmp_eq_u32 s3, 0
    s_cbranch_scc1 L_sl_109
    s_nop 0
    buffer_store_dwordx4 v[44:47], v3, s[4:7], s67 offen offset:0
    buffer_store_dwordx4 v[48:51], v3, s[4:7], s67 offen offset:1024
    buffer_store_dwordx2 v[52:53], v203, s[4:7], s67 offen offset:2048
    s_branch L_sj_110
L_sl_109:
    s_nop 0
    buffer_store_dwordx4 v[44:47], v3, s[4:7], s67 offen offset:0 sc1
    buffer_store_dwordx4 v[48:51], v3, s[4:7], s67 offen offset:1024 sc1
    buffer_store_dwordx2 v[52:53], v203, s[4:7], s67 offen offset:2048 sc1
L_sj_110:
    s_branch L_sj_108
L_so_107:
    s_cmp_eq_u32 s3, 0
    s_cbranch_scc1 L_sl_111
    s_nop 0
    buffer_store_dwordx2 v[44:45], v203, s[4:7], s67 offen offset:512
    buffer_store_dwordx4 v[46:49], v3, s[4:7], s67 offen offset:1024
    buffer_store_dwordx4 v[50:53], v3, s[4:7], s67 offen offset:2048
    s_branch L_sj_112
L_sl_111:
    s_nop 0
    buffer_store_dwordx2 v[44:45], v203, s[4:7], s67 offen offset:512 sc1
    buffer_store_dwordx4 v[46:49], v3, s[4:7], s67 offen offset:1024 sc1
    buffer_store_dwordx4 v[50:53], v3, s[4:7], s67 offen offset:2048 sc1
L_sj_112:
L_sj_108:
    s_and_b32 s68, s27, 15
    s_add_u32 s68, s68, 1
    s_and_b32 s69, s68, 14
    s_cmp_eq_u32 s69, 0
    s_cbranch_scc0 L_hal_113
    s_lshr_b32 s69, s27, 4
    s_lshl_b32 s69, s69, 1
    s_lshr_b32 s68, s68, 4
    s_add_u32 s69, s69, s68
    s_nop 0
    s_mul_i32 s66, s69, 20480
    s_add_u32 s66, s66, 26738688
    s_lshr_b32 s67, s29, 1
    s_lshl_b32 s67, s67, 10
    s_add_u32 s67, s67, s66
    s_bitcmp1_b32 s29, 0
    s_cbranch_scc1 L_so_114
    s_nop 0
    buffer_store_dwordx4 v[44:47], v3, s[4:7], s67 offen offset:0 sc1
    buffer_store_dwordx4 v[48:51], v3, s[4:7], s67 offen offset:1024 sc1
    buffer_store_dwordx2 v[52:53], v203, s[4:7], s67 offen offset:2048 sc1
    s_branch L_sj_115
L_so_114:
    s_nop 0
    buffer_store_dwordx2 v[44:45], v203, s[4:7], s67 offen offset:512 sc1
    buffer_store_dwordx4 v[46:49], v3, s[4:7], s67 offen offset:1024 sc1
    buffer_store_dwordx4 v[50:53], v3, s[4:7], s67 offen offset:2048 sc1
L_sj_115:
L_hal_113:
    v_mov_b32 v254, s20
    v_mov_b32_e64 v255, s21
    s_lshl_b32 s62, s27, 7
    s_lshl_b32 s63, s23, 3
    s_add_u32 s62, s62, s63
    s_add_u32 s62, s62, 27103232
    v_mov_b32_e64 v253, s62
    s_mov_b32 s63, 131072
    s_waitcnt vmcnt(0)
    s_mov_b64 exec, 1
    s_cmp_eq_u32 s3, 0
    s_cbranch_scc1 L_sl_116
    buffer_store_dwordx2 v[254:255], v253, s[4:7], s63 offen
    buffer_store_dwordx2 v[254:255], v253, s[4:7], 0 offen sc1
    s_branch L_sj_117
L_sl_116:
    buffer_store_dwordx2 v[254:255], v253, s[4:7], 0 offen sc1
L_sj_117:
    s_mov_b64 exec, -1
    s_sub_u32 s72, s27, 1
    s_max_i32 s72, s72, 0
    s_add_u32 s73, s27, 1
    s_min_u32 s73, s73, 127
    s_barrier
    v_mov_b32 v251, s27
    v_lshrrev_b32 v250, 3, v0
    v_and_b32 v250, 3, v250
    v_cmp_eq_u32 vcc, 1, v250
    v_mov_b32 v252, s72
    s_nop 0
    v_cndmask_b32 v251, v251, v252, vcc
    v_cmp_eq_u32 vcc, 2, v250
    v_mov_b32 v252, s73
    s_nop 0
    v_cndmask_b32 v251, v251, v252, vcc
    v_lshrrev_b32 v250, 4, v251
    s_lshr_b32 s62, s24, 2
    v_cmp_eq_u32 vcc, s62, v250
    s_mul_i32 s62, s3, 131072
    v_mov_b32 v252, s62
    v_cndmask_b32 v250, 0, v252, vcc
    v_lshl_add_u32 v251, v251, 7, v250
    v_and_b32_e64 v252, 7, v0
    v_lshl_add_u32 v251, v252, 3, v251
    s_mov_b32 s63, 27103232
    s_mov_b32 s62, 400000
    buffer_load_dwordx2 v[254:255], v251, s[4:7], s63 offen sc1
    buffer_load_dwordx4 v3, s[4:7], s95 offen offset:1024 lds
    buffer_load_dwordx4 v3, s[4:7], s95 offen offset:2048 lds
    buffer_load_dwordx4 v3, s[4:7], s95 offen offset:3072 lds
    s_lshl_b32 s66, s27, 4
    s_lshr_b32 s67, s24, 2
    v_add_u32 v212, s66, v1
    v_add_u32 v212, 4294967295, v212
    v_lshrrev_b32_e64 v213, 4, v212
    v_mul_u32_u24 v213, 20480, v213
    v_add_u32 v213, 2097152, v213
    v_lshrrev_b32 v214, 8, v212
    v_lshlrev_b32 v215, 1, v214
    v_add_u32_e64 v215, 1, v215
    v_mul_u32_u24 v215, 20480, v215
    v_add_u32 v215, 26738688, v215
    v_cmp_eq_u32 vcc, s67, v214
    s_nop 1
    v_cndmask_b32 v213, v215, v213, vcc
    v_and_b32 v214, 15, v212
    v_lshl_add_u32 v214, v2, 4, v214
    v_lshl_add_u32 v215, v214, 3, v213
    v_lshl_add_u32 v213, v214, 4, v213
    v_cmp_gt_u32 vcc, 0x800, v212
    v_mov_b32 v214, 0x80000000
    s_nop 0
    v_cndmask_b32 v208, v214, v213, vcc
    v_cndmask_b32 v220, v214, v215, vcc
    v_add_u32 v212, s66, v1
    v_add_u32 v212, 1, v212
    v_lshrrev_b32 v213, 4, v212
    v_mul_u32_u24 v213, 20480, v213
    v_add_u32 v213, 2097152, v213
    v_lshrrev_b32 v214, 8, v212
    v_lshlrev_b32 v215, 1, v214
    v_add_u32_e64 v215, 0, v215
    v_mul_u32_u24 v215, 20480, v215
    v_add_u32 v215, 26738688, v215
    v_cmp_eq_u32 vcc, s67, v214
    s_nop 1
    v_cndmask_b32 v213, v215, v213, vcc
    v_and_b32 v214, 15, v212
    v_lshl_add_u32 v214, v2, 4, v214
    v_lshl_add_u32 v215, v214, 3, v213
    v_lshl_add_u32 v213, v214, 4, v213
    v_cmp_gt_u32 vcc, 0x800, v212
    v_mov_b32 v214, 0x80000000
    s_nop 0
    v_cndmask_b32 v209, v214, v213, vcc
    v_cndmask_b32 v221, v214, v215, vcc
    v_add_u32 v212, s66, v1
    v_add_u32 v212, 4294967294, v212
    v_lshrrev_b32 v213, 4, v212
    v_mul_u32_u24 v213, 20480, v213
    v_add_u32 v213, 2097152, v213
    v_lshrrev_b32 v214, 8, v212
    v_lshlrev_b32 v215, 1, v214
    v_add_u32_e64 v215, 1, v215
    v_mul_u32_u24 v215, 20480, v215
    v_add_u32 v215, 26738688, v215
    v_cmp_eq_u32 vcc, s67, v214
    s_nop 1
    v_cndmask_b32 v213, v215, v213, vcc
    v_and_b32 v214, 15, v212
    v_lshl_add_u32 v214, v2, 4, v214
    v_lshl_add_u32 v215, v214, 3, v213
    v_lshl_add_u32 v213, v214, 4, v213
    v_cmp_gt_u32 vcc, 0x800, v212
    v_mov_b32 v214, 0x80000000
    s_nop 0
    v_cndmask_b32 v210, v214, v213, vcc
    v_cndmask_b32 v222, v214, v215, vcc
    v_add_u32 v212, s66, v1
    v_add_u32 v212, 2, v212
    v_lshrrev_b32 v213, 4, v212
    v_mul_u32_u24 v213, 20480, v213
    v_add_u32 v213, 2097152, v213
    v_lshrrev_b32 v214, 8, v212
    v_lshlrev_b32 v215, 1, v214
    v_add_u32_e64 v215, 0, v215
    v_mul_u32_u24 v215, 20480, v215
    v_add_u32 v215, 26738688, v215
    v_cmp_eq_u32 vcc, s67, v214
    s_nop 1
    v_cndmask_b32 v213, v215, v213, vcc
    v_and_b32 v214, 15, v212
    v_lshl_add_u32 v214, v2, 4, v214
    v_lshl_add_u32 v215, v214, 3, v213
    v_lshl_add_u32 v213, v214, 4, v213
    v_cmp_gt_u32 vcc, 0x800, v212
    v_mov_b32 v214, 0x80000000
    s_nop 0
    v_cndmask_b32 v211, v214, v213, vcc
    v_cndmask_b32 v223, v214, v215, vcc
    s_waitcnt vmcnt(3)
    v_cmp_ne_u32 vcc, s20, v254
    s_mov_b64 s[64:65], vcc
    v_cmp_ne_u32 vcc, s21, v255
    s_or_b64 s[64:65], s[64:65], vcc
    s_cmp_eq_u64 s[64:65], 0
    s_cbranch_scc1 L_wfok_119
    buffer_load_dwordx2 v[254:255], v251, s[4:7], s63 offen sc1
L_wfp_118:
    s_sleep 2
    buffer_load_dwordx2 v[252:253], v251, s[4:7], s63 offen sc1
    s_waitcnt vmcnt(1)
    v_cmp_ne_u32 vcc, s20, v254
    s_mov_b64 s[64:65], vcc
    v_cmp_ne_u32 vcc, s21, v255
    s_or_b64 s[64:65], s[64:65], vcc
    s_cmp_eq_u64 s[64:65], 0
    s_cbranch_scc1 L_wfo2_120
    s_sleep 2
    buffer_load_dwordx2 v[254:255], v251, s[4:7], s63 offen sc1
    s_waitcnt vmcnt(1)
    v_cmp_ne_u32 vcc, s20, v252
    s_mov_b64 s[64:65], vcc
    v_cmp_ne_u32 vcc, s21, v253
    s_or_b64 s[64:65], s[64:65], vcc
    s_cmp_eq_u64 s[64:65], 0
    s_cbranch_scc1 L_wfo2_120
    s_sub_u32 s62, s62, 1
    s_cmp_lg_u32 s62, 0
    s_cbranch_scc1 L_wfp_118
    s_mov_b32 s28, 10
    s_branch L_fail
L_wfo2_120:
L_wfok_119:
    s_mov_b32 s88, 0
    buffer_load_dwordx4 a[16:19], v208, s[4:7], s88 offen offset:0 sc1
    buffer_load_dwordx4 a[20:23], v208, s[4:7], s88 offen offset:1024 sc1
    buffer_load_dwordx2 a[24:25], v220, s[4:7], s88 offen offset:2048 sc1
    buffer_load_dwordx2 a[26:27], v220, s[4:7], s88 offen offset:2560 sc1
    buffer_load_dwordx4 a[28:31], v208, s[4:7], s88 offen offset:3072 sc1
    s_mov_b32 s88, 4096
    buffer_load_dwordx4 a[32:35], v208, s[4:7], s88 offen offset:0 sc1
    buffer_load_dwordx4 a[36:39], v209, s[4:7], s88 offen offset:1024 sc1
    ds_read_b128 v[100:103], v200 offset:40960
    ds_read_b128 v[104:107], v200 offset:41984
    ds_read_b128 v[108:111], v200 offset:43008
    ds_read_b128 v[112:115], v200 offset:44032
    ds_read_b128 v[116:119], v200 offset:45056
    ds_read_b128 v[120:123], v200 offset:46080
    ds_read_b128 v[124:127], v200 offset:47104
    ds_read_b128 v[128:131], v200 offset:48128
    ds_read_b128 v[132:135], v200 offset:49152
    ds_read_b128 v[136:139], v200 offset:50176
    s_waitcnt lgkmcnt(5)
    s_waitcnt vmcnt(6)
    v_mfma_f32_16x16x32_bf16 v[44:47], v[100:103], a[16:19], 0
    ds_read_b128 v[140:143], v200 offset:51200
    buffer_load_dwordx4 a[40:43], v209, s[4:7], s88 offen offset:2048 sc1
    v_mfma_f32_16x16x32_bf16 v[48:51], v[104:107], a[16:19], 0
    ds_read_b128 v[144:147], v200 offset:52224
    v_mfma_f32_16x16x32_bf16 v[52:55], v[108:111], a[16:19], 0
    ds_read_b128 v[148:151], v200 offset:53248
    v_mfma_f32_16x16x32_bf16 v[56:59], v[112:115], a[16:19], 0
    ds_read_b128 v[152:155], v200 offset:54272
    v_mfma_f32_16x16x32_bf16 v[60:63], v[116:119], a[16:19], 0
    ds_read_b128 v[156:159], v200 offset:55296
    s_waitcnt lgkmcnt(5)
    s_waitcnt vmcnt(6)
    v_mfma_f32_16x16x32_bf16 v[44:47], v[120:123], a[20:23], v[44:47]
    ds_read_b128 v[100:103], v200 offset:56320
    buffer_load_dwordx2 a[44:45], v221, s[4:7], s88 offen offset:3072 sc1
    buffer_load_dwordx2 a[46:47], v221, s[4:7], s88 offen offset:3584 sc1
    v_mfma_f32_16x16x32_bf16 v[48:51], v[124:127], a[20:23], v[48:51]
    ds_read_b128 v[104:107], v200 offset:57344
    v_mfma_f32_16x16x32_bf16 v[52:55], v[128:131], a[20:23], v[52:55]
    ds_read_b128 v[108:111], v200 offset:58368
    v_mfma_f32_16x16x32_bf16 v[56:59], v[132:135], a[20:23], v[56:59]
    ds_read_b128 v[112:115], v200 offset:59392
    v_mfma_f32_16x16x32_bf16 v[60:63], v[136:139], a[20:23], v[60:63]
    ds_read_b128 v[116:119], v200 offset:60416
    s_barrier
    s_waitcnt lgkmcnt(5)
    s_waitcnt vmcnt(6)
    s_nop 0
    v_mfma_f32_16x16x32_bf16 v[44:47], v[140:143], a[24:27], v[44:47]
    ds_read_b128 v[120:123], v201 offset:0
    s_mov_b32 s88, 8192
    buffer_load_dwordx4 a[48:51], v209, s[4:7], s88 offen offset:0 sc1
    v_mfma_f32_16x16x32_bf16 v[48:51], v[144:147], a[24:27], v[48:51]
    ds_read_b128 v[124:127], v201 offset:1024
    v_mfma_f32_16x16x32_bf16 v[52:55], v[148:151], a[24:27], v[52:55]
    ds_read_b128 v[128:131], v201 offset:2048
    v_mfma_f32_16x16x32_bf16 v[56:59], v[152:155], a[24:27], v[56:59]
    ds_read_b128 v[132:135], v201 offset:3072
    v_mfma_f32_16x16x32_bf16 v[60:63], v[156:159], a[24:27], v[60:63]
    ds_read_b128 v[136:139], v201 offset:4096
    s_waitcnt lgkmcnt(5)
    s_waitcnt vmcnt(6)
    v_mfma_f32_16x16x32_bf16 v[44:47], v[100:103], a[28:31], v[44:47]
    ds_read_b128 v[140:143], v201 offset:5120
    buffer_load_dwordx4 a[52:55], v209, s[4:7], s88 offen offset:1024 sc1
    v_mfma_f32_16x16x32_bf16 v[48:51], v[104:107], a[28:31], v[48:51]
    ds_read_b128 v[144:147], v201 offset:6144
    v_mfma_f32_16x16x32_bf16 v[52:55], v[108:111], a[28:31], v[52:55]
    ds_read_b128 v[148:151], v201 offset:7168
    buffer_load_dwordx4 a[56:59], v210, s[4:7], s88 offen offset:2048 sc1
    v_mfma_f32_16x16x32_bf16 v[56:59], v[112:115], a[28:31], v[56:59]
    ds_read_b128 v[152:155], v201 offset:8192
    v_mfma_f32_16x16x32_bf16 v[60:63], v[116:119], a[28:31], v[60:63]
    ds_read_b128 v[156:159], v201 offset:9216
    s_waitcnt lgkmcnt(5)
    s_waitcnt vmcnt(7)
    v_mfma_f32_16x16x32_bf16 v[44:47], v[120:123], a[32:35], v[44:47]
    ds_read_b128 v[100:103], v201 offset:10240
    buffer_load_dwordx4 a[60:63], v210, s[4:7], s88 offen offset:3072 sc1
    v_mfma_f32_16x16x32_bf16 v[48:51], v[124:127], a[32:35], v[48:51]
    ds_read_b128 v[104:107], v201 offset:11264
    v_mfma_f32_16x16x32_bf16 v[52:55], v[128:131], a[32:35], v[52:55]
    ds_read_b128 v[108:111], v201 offset:12288
    v_mfma_f32_16x16x32_bf16 v[56:59], v[132:135], a[32:35], v[56:59]
    ds_read_b128 v[112:115], v201 offset:13312
    v_mfma_f32_16x16x32_bf16 v[60:63], v[136:139], a[32:35], v[60:63]
    ds_read_b128 v[116:119], v201 offset:14336
    s_waitcnt lgkmcnt(5)
    s_waitcnt vmcnt(7)
    v_mfma_f32_16x16x32_bf16 v[44:47], v[140:143], a[36:39], v[44:47]
    ds_read_b128 v[120:123], v201 offset:15360
    s_mov_b32 s88, 12288
    buffer_load_dwordx2 a[64:65], v222, s[4:7], s88 offen offset:0 sc1
    buffer_load_dwordx2 a[66:67], v222, s[4:7], s88 offen offset:512 sc1
    v_mfma_f32_16x16x32_bf16 v[48:51], v[144:147], a[36:39], v[48:51]
    ds_read_b128 v[124:127], v201 offset:16384
    v_mfma_f32_16x16x32_bf16 v[52:55], v[148:151], a[36:39], v[52:55]
    ds_read_b128 v[128:131], v201 offset:17408
    v_mfma_f32_16x16x32_bf16 v[56:59], v[152:155], a[36:39], v[56:59]
    ds_read_b128 v[132:135], v201 offset:18432
    v_mfma_f32_16x16x32_bf16 v[60:63], v[156:159], a[36:39], v[60:63]
    ds_read_b128 v[136:139], v201 offset:19456
    s_barrier
    s_waitcnt lgkmcnt(5)
    s_waitcnt vmcnt(8)
    s_nop 0
    v_mfma_f32_16x16x32_bf16 v[44:47], v[100:103], a[40:43], v[44:47]
    ds_read_b128 v[140:143], v201 offset:20480
    buffer_load_dwordx4 a[68:71], v210, s[4:7], s88 offen offset:1024 sc1
    v_mfma_f32_16x16x32_bf16 v[48:51], v[104:107], a[40:43], v[48:51]
    ds_read_b128 v[144:147], v201 offset:21504
    v_mfma_f32_16x16x32_bf16 v[52:55], v[108:111], a[40:43], v[52:55]
    ds_read_b128 v[148:151], v201 offset:22528
    buffer_load_dwordx4 a[72:75], v210, s[4:7], s88 offen offset:2048 sc1
    v_mfma_f32_16x16x32_bf16 v[56:59], v[112:115], a[40:43], v[56:59]
    ds_read_b128 v[152:155], v201 offset:23552
    v_mfma_f32_16x16x32_bf16 v[60:63], v[116:119], a[40:43], v[60:63]
    ds_read_b128 v[156:159], v201 offset:24576
    s_waitcnt lgkmcnt(5)
    s_waitcnt vmcnt(8)
    v_mfma_f32_16x16x32_bf16 v[44:47], v[120:123], a[44:47], v[44:47]
    ds_read_b128 v[100:103], v201 offset:25600
    buffer_load_dwordx4 a[76:79], v211, s[4:7], s88 offen offset:3072 sc1
    v_mfma_f32_16x16x32_bf16 v[48:51], v[124:127], a[44:47], v[48:51]
    ds_read_b128 v[104:107], v201 offset:26624
    v_mfma_f32_16x16x32_bf16 v[52:55], v[128:131], a[44:47], v[52:55]
    ds_read_b128 v[108:111], v201 offset:27648
    v_mfma_f32_16x16x32_bf16 v[56:59], v[132:135], a[44:47], v[56:59]
    ds_read_b128 v[112:115], v201 offset:28672
    v_mfma_f32_16x16x32_bf16 v[60:63], v[136:139], a[44:47], v[60:63]
    ds_read_b128 v[116:119], v201 offset:29696
    s_waitcnt lgkmcnt(5)
    s_waitcnt vmcnt(8)
    v_mfma_f32_16x16x32_bf16 v[44:47], v[140:143], a[48:51], v[44:47]
    ds_read_b128 v[120:123], v201 offset:30720
    s_mov_b32 s88, 16384
    buffer_load_dwordx4 a[80:83], v211, s[4:7], s88 offen offset:0 sc1
    v_mfma_f32_16x16x32_bf16 v[48:51], v[144:147], a[48:51], v[48:51]
    ds_read_b128 v[124:127], v201 offset:31744
    v_mfma_f32_16x16x32_bf16 v[52:55], v[148:151], a[48:51], v[52:55]
    ds_read_b128 v[128:131], v201 offset:32768
    v_mfma_f32_16x16x32_bf16 v[56:59], v[152:155], a[48:51], v[56:59]
    ds_read_b128 v[132:135], v201 offset:33792
    v_mfma_f32_16x16x32_bf16 v[60:63], v[156:159], a[48:51], v[60:63]
    ds_read_b128 v[136:139], v201 offset:34816
    s_waitcnt lgkmcnt(5)
    s_waitcnt vmcnt(8)
    v_mfma_f32_16x16x32_bf16 v[44:47], v[100:103], a[52:55], v[44:47]
    ds_read_b128 v[140:143], v201 offset:35840
    buffer_load_dwordx2 a[84:85], v223, s[4:7], s88 offen offset:1024 sc1
    buffer_load_dwordx2 a[86:87], v223, s[4:7], s88 offen offset:1536 sc1
    v_mfma_f32_16x16x32_bf16 v[48:51], v[104:107], a[52:55], v[48:51]
    ds_read_b128 v[144:147], v201 offset:36864
    v_mfma_f32_16x16x32_bf16 v[52:55], v[108:111], a[52:55], v[52:55]
    ds_read_b128 v[148:151], v201 offset:37888
    buffer_load_dwordx4 a[88:91], v211, s[4:7], s88 offen offset:2048 sc1
    v_mfma_f32_16x16x32_bf16 v[56:59], v[112:115], a[52:55], v[56:59]
    ds_read_b128 v[152:155], v201 offset:38912
    v_mfma_f32_16x16x32_bf16 v[60:63], v[116:119], a[52:55], v[60:63]
    ds_read_b128 v[156:159], v201 offset:39936
    s_barrier
    s_waitcnt lgkmcnt(5)
    s_waitcnt vmcnt(10)
    s_nop 0
    v_mfma_f32_16x16x32_bf16 v[44:47], v[120:123], a[56:59], v[44:47]
    ds_read_b128 v[100:103], v201 offset:40960
    buffer_load_dwordx4 a[92:95], v211, s[4:7], s88 offen offset:3072 sc1
    v_mfma_f32_16x16x32_bf16 v[48:51], v[124:127], a[56:59], v[48:51]
    ds_read_b128 v[104:107], v201 offset:41984
    v_mfma_f32_16x16x32_bf16 v[52:55], v[128:131], a[56:59], v[52:55]
    ds_read_b128 v[108:111], v201 offset:43008
    v_mfma_f32_16x16x32_bf16 v[56:59], v[132:135], a[56:59], v[56:59]
    ds_read_b128 v[112:115], v201 offset:44032
    v_mfma_f32_16x16x32_bf16 v[60:63], v[136:139], a[56:59], v[60:63]
    ds_read_b128 v[116:119], v201 offset:45056
    s_waitcnt lgkmcnt(5)
    s_waitcnt vmcnt(10)
    v_mfma_f32_16x16x32_bf16 v[44:47], v[140:143], a[60:63], v[44:47]
    ds_read_b128 v[120:123], v201 offset:46080
    s_add_u32 s94, s93, 147456
    s_mov_b32 m0, s94
    s_add_u32 s95, s91, 0
    buffer_load_dwordx4 v3, s[4:7], s95 offen offset:0 lds
    v_mfma_f32_16x16x32_bf16 v[48:51], v[144:147], a[60:63], v[48:51]
    ds_read_b128 v[124:127], v201 offset:47104
    v_mfma_f32_16x16x32_bf16 v[52:55], v[148:151], a[60:63], v[52:55]
    ds_read_b128 v[128:131], v201 offset:48128
    v_mfma_f32_16x16x32_bf16 v[56:59], v[152:155], a[60:63], v[56:59]
    ds_read_b128 v[132:135], v201 offset:49152
    v_mfma_f32_16x16x32_bf16 v[60:63], v[156:159], a[60:63], v[60:63]
    ds_read_b128 v[136:139], v201 offset:50176
    s_waitcnt lgkmcnt(5)
    s_waitcnt vmcnt(9)
    v_mfma_f32_16x16x32_bf16 v[44:47], v[100:103], a[64:67], v[44:47]
    ds_read_b128 v[140:143], v201 offset:51200
    buffer_load_dwordx4 v3, s[4:7], s95 offen offset:1024 lds
    v_mfma_f32_16x16x32_bf16 v[48:51], v[104:107], a[64:67], v[48:51]
    ds_read_b128 v[144:147], v201 offset:52224
    v_mfma_f32_16x16x32_bf16 v[52:55], v[108:111], a[64:67], v[52:55]
    ds_read_b128 v[148:151], v201 offset:53248
    v_mfma_f32_16x16x32_bf16 v[56:59], v[112:115], a[64:67], v[56:59]
    ds_read_b128 v[152:155], v201 offset:54272
    v_mfma_f32_16x16x32_bf16 v[60:63], v[116:119], a[64:67], v[60:63]
    ds_read_b128 v[156:159], v201 offset:55296
    s_waitcnt lgkmcnt(5)
    s_waitcnt vmcnt(9)
    v_mfma_f32_16x16x32_bf16 v[44:47], v[120:123], a[68:71], v[44:47]
    ds_read_b128 v[100:103], v201 offset:56320
    buffer_load_dwordx4 v3, s[4:7], s95 offen offset:2048 lds
    v_mfma_f32_16x16x32_bf16 v[48:51], v[124:127], a[68:71], v[48:51]
    ds_read_b128 v[104:107], v201 offset:57344
    v_mfma_f32_16x16x32_bf16 v[52:55], v[128:131], a[68:71], v[52:55]
    ds_read_b128 v[108:111], v201 offset:58368
    buffer_load_dwordx4 v3, s[4:7], s95 offen offset:3072 lds
    v_mfma_f32_16x16x32_bf16 v[56:59], v[132:135], a[68:71], v[56:59]
    ds_read_b128 v[112:115], v201 offset:59392
    v_mfma_f32_16x16x32_bf16 v[60:63], v[136:139], a[68:71], v[60:63]
    ds_read_b128 v[116:119], v201 offset:60416
    s_barrier
    s_waitcnt lgkmcnt(5)
    s_waitcnt vmcnt(10)
    s_nop 0
    v_mfma_f32_16x16x32_bf16 v[44:47], v[140:143], a[72:75], v[44:47]
    ds_read_b128 v[120:123], v202 offset:0
    s_add_u32 s94, s93, 0
    s_mov_b32 m0, s94
    s_add_u32 s95, s91, 16384
    buffer_load_dwordx4 v3, s[4:7], s95 offen offset:0 lds
    v_mfma_f32_16x16x32_bf16 v[48:51], v[144:147], a[72:75], v[48:51]
    ds_read_b128 v[124:127], v202 offset:1024
    v_mfma_f32_16x16x32_bf16 v[52:55], v[148:151], a[72:75], v[52:55]
    ds_read_b128 v[128:131], v202 offset:2048
    v_mfma_f32_16x16x32_bf16 v[56:59], v[152:155], a[72:75], v[56:59]
    ds_read_b128 v[132:135], v202 offset:3072
    v_mfma_f32_16x16x32_bf16 v[60:63], v[156:159], a[72:75], v[60:63]
    ds_read_b128 v[136:139], v202 offset:4096
    s_waitcnt lgkmcnt(5)
    s_waitcnt vmcnt(10)
    v_mfma_f32_16x16x32_bf16 v[44:47], v[100:103], a[76:79], v[44:47]
    ds_read_b128 v[140:143], v202 offset:5120
    buffer_load_dwordx4 v3, s[4:7], s95 offen offset:1024 lds
    v_mfma_f32_16x16x32_bf16 v[48:51], v[104:107], a[76:79], v[48:51]
    ds_read_b128 v[144:147], v202 offset:6144
    v_mfma_f32_16x16x32_bf16 v[52:55], v[108:111], a[76:79], v[52:55]
    ds_read_b128 v[148:151], v202 offset:7168
    v_mfma_f32_16x16x32_bf16 v[56:59], v[112:115], a[76:79], v[56:59]
    ds_read_b128 v[152:155], v202 offset:8192
    v_mfma_f32_16x16x32_bf16 v[60:63], v[116:119], a[76:79], v[60:63]
    ds_read_b128 v[156:159], v202 offset:9216
    s_waitcnt lgkmcnt(5)
    s_waitcnt vmcnt(10)
    v_mfma_f32_16x16x32_bf16 v[44:47], v[120:123], a[80:83], v[44:47]
    ds_read_b128 v[100:103], v202 offset:10240
    buffer_load_dwordx4 v3, s[4:7], s95 offen offset:2048 lds
    v_mfma_f32_16x16x32_bf16 v[48:51], v[124:127], a[80:83], v[48:51]
    ds_read_b128 v[104:107], v202 offset:11264
    v_mfma_f32_16x16x32_bf16 v[52:55], v[128:131], a[80:83], v[52:55]
    ds_read_b128 v[108:111], v202 offset:12288
    buffer_load_dwordx4 v3, s[4:7], s95 offen offset:3072 lds
    v_mfma_f32_16x16x32_bf16 v[56:59], v[132:135], a[80:83], v[56:59]
    ds_read_b128 v[112:115], v202 offset:13312
    v_mfma_f32_16x16x32_bf16 v[60:63], v[136:139], a[80:83], v[60:63]
    ds_read_b128 v[116:119], v202 offset:14336
    s_waitcnt lgkmcnt(5)
    s_waitcnt vmcnt(10)
    v_mfma_f32_16x16x32_bf16 v[44:47], v[140:143], a[84:87], v[44:47]
    ds_read_b128 v[120:123], v202 offset:15360
    s_add_u32 s94, s93, 16384
    s_mov_b32 m0, s94
    s_nop 0
    s_add_u32 s95, s91, 32768
    buffer_load_dwordx4 v3, s[4:7], s95 offen offset:0 lds
    v_mfma_f32_16x16x32_bf16 v[48:51], v[144:147], a[84:87], v[48:51]
    ds_read_b128 v[124:127], v202 offset:16384
    v_mfma_f32_16x16x32_bf16 v[52:55], v[148:151], a[84:87], v[52:55]
    ds_read_b128 v[128:131], v202 offset:17408
    v_mfma_f32_16x16x32_bf16 v[56:59], v[152:155], a[84:87], v[56:59]
    ds_read_b128 v[132:135], v202 offset:18432
    v_mfma_f32_16x16x32_bf16 v[60:63], v[156:159], a[84:87], v[60:63]
    ds_read_b128 v[136:139], v202 offset:19456
    s_waitcnt lgkmcnt(5)
    s_waitcnt vmcnt(10)
    v_mfma_f32_16x16x32_bf16 v[44:47], v[100:103], a[88:91], v[44:47]
    buffer_load_dwordx4 v3, s[4:7], s95 offen offset:1024 lds
    v_mfma_f32_16x16x32_bf16 v[48:51], v[104:107], a[88:91], v[48:51]
    v_mfma_f32_16x16x32_bf16 v[52:55], v[108:111], a[88:91], v[52:55]
    v_mfma_f32_16x16x32_bf16 v[56:59], v[112:115], a[88:91], v[56:59]
    v_mfma_f32_16x16x32_bf16 v[60:63], v[116:119], a[88:91], v[60:63]
    s_waitcnt lgkmcnt(0)
    s_waitcnt vmcnt(10)
    v_mfma_f32_16x16x32_bf16 v[44:47], v[120:123], a[92:95], v[44:47]
    buffer_load_dwordx4 v3, s[4:7], s95 offen offset:2048 lds
    v_mfma_f32_16x16x32_bf16 v[48:51], v[124:127], a[92:95], v[48:51]
    v_mfma_f32_16x16x32_bf16 v[52:55], v[128:131], a[92:95], v[52:55]
    buffer_load_dwordx4 v3, s[4:7], s95 offen offset:3072 lds
    v_mfma_f32_16x16x32_bf16 v[56:59], v[132:135], a[92:95], v[56:59]
    v_mfma_f32_16x16x32_bf16 v[60:63], v[136:139], a[92:95], v[60:63]
    s_barrier
    s_nop 0
    v_pk_add_f32 v[24:25], v[24:25], v[44:45]
    v_pk_add_f32 v[26:27], v[26:27], v[46:47]
    v_pk_add_f32 v[28:29], v[28:29], v[48:49]
    v_pk_add_f32 v[30:31], v[30:31], v[50:51]
    v_pk_add_f32 v[32:33], v[32:33], v[52:53]
    v_pk_add_f32 v[34:35], v[34:35], v[54:55]
    v_pk_add_f32 v[36:37], v[36:37], v[56:57]
    v_pk_add_f32 v[38:39], v[38:39], v[58:59]
    v_pk_add_f32 v[40:41], v[40:41], v[60:61]
    v_pk_add_f32 v[42:43], v[42:43], v[62:63]
    v_pk_add_f32 v[204:205], v[24:25], v[26:27]
    v_pk_mul_f32 v[206:207], v[24:25], v[24:25]
    v_pk_fma_f32 v[206:207], v[26:27], v[26:27], v[206:207]
    v_pk_add_f32 v[204:205], v[204:205], v[28:29]
    v_pk_fma_f32 v[206:207], v[28:29], v[28:29], v[206:207]
    v_pk_add_f32 v[204:205], v[204:205], v[30:31]
    v_pk_fma_f32 v[206:207], v[30:31], v[30:31], v[206:207]
    v_pk_add_f32 v[204:205], v[204:205], v[32:33]
    v_pk_fma_f32 v[206:207], v[32:33], v[32:33], v[206:207]
    v_pk_add_f32 v[204:205], v[204:205], v[34:35]
    v_pk_fma_f32 v[206:207], v[34:35], v[34:35], v[206:207]
    v_pk_add_f32 v[204:205], v[204:205], v[36:37]
    v_pk_fma_f32 v[206:207], v[36:37], v[36:37], v[206:207]
    v_pk_add_f32 v[204:205], v[204:205], v[38:39]
    v_pk_fma_f32 v[206:207], v[38:39], v[38:39], v[206:207]
    v_pk_add_f32 v[204:205], v[204:205], v[40:41]
    v_pk_fma_f32 v[206:207], v[40:41], v[40:41], v[206:207]
    v_pk_add_f32 v[204:205], v[204:205], v[42:43]
    v_pk_fma_f32 v[206:207], v[42:43], v[42:43], v[206:207]
    v_add_f32 v204, v204, v205
    v_add_f32 v205, v206, v207
    v_mov_b32 v208, v204
    v_mov_b32 v209, v205
    s_nop 0
    v_permlane16_swap_b32 v204, v208
    v_permlane16_swap_b32 v205, v209
    v_add_f32 v204, v204, v208
    v_add_f32 v205, v205, v209
    v_mov_b32 v208, v204
    v_mov_b32 v209, v205
    s_nop 0
    v_permlane32_swap_b32 v204, v208
    v_permlane32_swap_b32 v205, v209
    v_add_f32 v204, v204, v208
    v_add_f32 v205, v205, v209
    v_mov_b32 v206, s20
    v_mov_b32_e64 v207, s21
    s_lshl_b32 s66, s24, 13
    s_lshl_b32 s67, s22, 8
    s_add_u32 s66, s66, s67
    s_add_u32 s66, s66, 655360
    s_lshl_b32 s67, s23, 10
    s_add_u32 s67, s67, s66
    v_lshlrev_b32_e64 v208, 4, v1
    s_mov_b64 exec, 0xffff
    s_cmp_eq_u32 s3, 0
    s_cbranch_scc1 L_sl_121
    buffer_store_dwordx4 v[204:207], v208, s[4:7], s67 offen
    s_branch L_sj_122
L_sl_121:
    buffer_store_dwordx4 v[204:207], v208, s[4:7], s67 offen sc1
L_sj_122:
    s_mov_b64 exec, -1
    s_mov_b64 exec, -1
    s_nop 0
    v_lshl_add_u32 v209, v2, 11, v208
    s_mov_b32 s62, 400000
    buffer_load_dwordx4 v[212:215], v209, s[4:7], s66 offen sc1
    buffer_load_dwordx4 v[216:219], v209, s[4:7], s66 offen offset:1024 sc1
    s_add_u32 s94, s93, 32768
    s_mov_b32 m0, s94
    s_nop 0
    s_add_u32 s95, s91, 49152
    buffer_load_dwordx4 v3, s[4:7], s95 offen offset:0 lds
    buffer_load_dwordx4 v3, s[4:7], s95 offen offset:1024 lds
    buffer_load_dwordx4 v3, s[4:7], s95 offen offset:2048 lds
    s_waitcnt vmcnt(3)
    s_branch L_lsc_125
L_ls_123:
    buffer_load_dwordx4 v[212:215], v209, s[4:7], s66 offen sc1
    buffer_load_dwordx4 v[216:219], v209, s[4:7], s66 offen offset:1024 sc1
    s_waitcnt vmcnt(0)
L_lsc_125:
    v_cmp_ne_u32 vcc, s20, v214
    s_mov_b64 s[64:65], vcc
    v_cmp_ne_u32 vcc, s21, v215
    s_or_b64 s[64:65], s[64:65], vcc
    v_cmp_ne_u32 vcc, s20, v218
    s_or_b64 s[64:65], s[64:65], vcc
    v_cmp_ne_u32 vcc, s21, v219
    s_or_b64 s[64:65], s[64:65], vcc
    s_cmp_eq_u64 s[64:65], 0
    s_cbranch_scc1 L_lsok_124
    s_sub_u32 s62, s62, 1
    s_cmp_lg_u32 s62, 0
    s_cbranch_scc1 L_ls_123
    s_mov_b32 s28, 11
    s_branch L_fail
L_lsok_124:
    v_add_f32 v204, v212, v216
    v_add_f32 v205, v213, v217
    v_mov_b32 v208, v204
    v_mov_b32 v209, v205
    s_nop 0
    v_permlane16_swap_b32 v204, v208
    v_permlane16_swap_b32 v205, v209
    v_add_f32 v204, v204, v208
    v_add_f32 v205, v205, v209
    v_mov_b32 v208, v204
    v_mov_b32 v209, v205
    s_nop 0
    v_permlane32_swap_b32 v204, v208
    v_permlane32_swap_b32 v205, v209
    v_add_f32 v204, v204, v208
    v_add_f32 v205, v205, v209
    v_mul_f32 v230, 0.0015625, v204
    v_mul_f32 v205, 0.0015625, v205
    v_fma_f32 v205, -v230, v230, v205
    v_max_f32_e64 v205, 0, v205
    v_add_f32 v205, 0x3727c5ac, v205
    v_rsq_f32 v232, v205
    s_nop 0
    v_mul_f32 v230, -v230, v232
    v_mov_b32 v233, v232
    v_mov_b32 v231, v230
    v_pk_fma_f32 v[44:45], v[24:25], v[232:233], v[230:231]
    v_pk_fma_f32 v[46:47], v[26:27], v[232:233], v[230:231]
    v_pk_fma_f32 v[48:49], v[28:29], v[232:233], v[230:231]
    v_pk_fma_f32 v[50:51], v[30:31], v[232:233], v[230:231]
    v_pk_fma_f32 v[52:53], v[32:33], v[232:233], v[230:231]
    v_pk_fma_f32 v[54:55], v[34:35], v[232:233], v[230:231]
    v_pk_fma_f32 v[56:57], v[36:37], v[232:233], v[230:231]
    v_pk_fma_f32 v[58:59], v[38:39], v[232:233], v[230:231]
    v_pk_fma_f32 v[60:61], v[40:41], v[232:233], v[230:231]
    v_pk_fma_f32 v[62:63], v[42:43], v[232:233], v[230:231]
    v_cvt_pk_bf16_f32 v44, v44, v45
    v_cvt_pk_bf16_f32 v45, v46, v47
    v_cvt_pk_bf16_f32 v46, v48, v49
    v_cvt_pk_bf16_f32 v47, v50, v51
    v_cvt_pk_bf16_f32 v48, v52, v53
    v_cvt_pk_bf16_f32 v49, v54, v55
    v_cvt_pk_bf16_f32 v50, v56, v57
    v_cvt_pk_bf16_f32 v51, v58, v59
    v_cvt_pk_bf16_f32 v52, v60, v61
    v_cvt_pk_bf16_f32 v53, v62, v63
    s_mul_i32 s66, s27, 20480
    s_add_u32 s66, s66, 4718592
    s_lshr_b32 s67, s29, 1
    s_lshl_b32 s67, s67, 10
    s_add_u32 s67, s67, s66
    s_bitcmp1_b32 s29, 0
    s_cbranch_scc1 L_so_126
    s_cmp_eq_u32 s3, 0
    s_cbranch_scc1 L_sl_128
    s_nop 0
    buffer_store_dwordx4 v[44:47], v3, s[4:7], s67 offen offset:0
    buffer_store_dwordx4 v[48:51], v3, s[4:7], s67 offen offset:1024
    buffer_store_dwordx2 v[52:53], v203, s[4:7], s67 offen offset:2048
    s_branch L_sj_129
L_sl_128:
    s_nop 0
    buffer_store_dwordx4 v[44:47], v3, s[4:7], s67 offen offset:0 sc1
    buffer_store_dwordx4 v[48:51], v3, s[4:7], s67 offen offset:1024 sc1
    buffer_store_dwordx2 v[52:53], v203, s[4:7], s67 offen offset:2048 sc1
L_sj_129:
    s_branch L_sj_127
L_so_126:
    s_cmp_eq_u32 s3, 0
    s_cbranch_scc1 L_sl_130
    s_nop 0
    buffer_store_dwordx2 v[44:45], v203, s[4:7], s67 offen offset:512
    buffer_store_dwordx4 v[46:49], v3, s[4:7], s67 offen offset:1024
    buffer_store_dwordx4 v[50:53], v3, s[4:7], s67 offen offset:2048
    s_branch L_sj_131
L_sl_130:
    s_nop 0
    buffer_store_dwordx2 v[44:45], v203, s[4:7], s67 offen offset:512 sc1
    buffer_store_dwordx4 v[46:49], v3, s[4:7], s67 offen offset:1024 sc1
    buffer_store_dwordx4 v[50:53], v3, s[4:7], s67 offen offset:2048 sc1
L_sj_131:
L_sj_127:
    v_mov_b32 v254, s20
    v_mov_b32_e64 v255, s21
    s_lshl_b32 s62, s27, 7
    s_lshl_b32 s63, s23, 3
    s_add_u32 s62, s62, s63
    s_add_u32 s62, s62, 27119616
    v_mov_b32_e64 v253, s62
    s_mov_b32 s63, 131072
    s_waitcnt vmcnt(0)
    s_mov_b64 exec, 1
    s_cmp_eq_u32 s3, 0
    s_cbranch_scc1 L_sl_132
    buffer_store_dwordx2 v[254:255], v253, s[4:7], s63 offen
    s_branch L_sj_133
L_sl_132:
    buffer_store_dwordx2 v[254:255], v253, s[4:7], 0 offen sc1
L_sj_133:
    s_mov_b64 exec, -1
    s_and_b32 s72, s24, 1
    s_lshl_b32 s72, s72, 3
    s_add_u32 s72, s72, s23
    s_mul_i32 s73, s72, 7
    s_sub_u32 s62, s72, 12
    s_max_i32 s62, s62, 0
    s_sub_u32 s73, s73, s62
    s_cmp_ge_u32 s72, 12
    s_cselect_b32 s74, 1, 0
    s_and_b32 s75, s24, 30
    s_add_u32 s76, s75, 1
    s_lshl_b32 s77, s75, 2
    s_lshl_b32 s62, s22, 1
    s_add_u32 s77, s77, s62
    s_add_u32 s75, s77, 1
    s_barrier
    v_mov_b32 v251, s77
    v_lshrrev_b32 v250, 3, v0
    v_and_b32 v250, 3, v250
    v_cmp_eq_u32 vcc, 1, v250
    v_mov_b32 v252, s75
    s_nop 0
    v_cndmask_b32 v251, v251, v252, vcc
    v_lshrrev_b32 v250, 4, v251
    s_lshr_b32 s62, s24, 2
    v_cmp_eq_u32 vcc, s62, v250
    s_mul_i32 s62, s3, 131072
    v_mov_b32 v252, s62
    v_cndmask_b32 v250, 0, v252, vcc
    v_lshl_add_u32 v251, v251, 7, v250
    v_and_b32_e64 v252, 7, v0
    v_lshl_add_u32 v251, v252, 3, v251
    s_mov_b32 s63, 27119616
    s_mov_b32 s62, 400000
    buffer_load_dwordx2 v[254:255], v251, s[4:7], s63 offen sc1
    buffer_load_dwordx4 v3, s[4:7], s95 offen offset:3072 lds
    s_add_u32 s94, s93, 49152
    s_mov_b32 m0, s94
    s_nop 0
    s_add_u32 s95, s91, 65536
    buffer_load_dwordx4 v3, s[4:7], s95 offen offset:0 lds
    buffer_load_dwordx4 v3, s[4:7], s95 offen offset:1024 lds
    s_waitcnt vmcnt(3)
    v_cmp_ne_u32 vcc, s20, v254
    s_mov_b64 s[64:65], vcc
    v_cmp_ne_u32 vcc, s21, v255
    s_or_b64 s[64:65], s[64:65], vcc
    s_cmp_eq_u64 s[64:65], 0
    s_cbranch_scc1 L_wfok_135
    buffer_load_dwordx2 v[254:255], v251, s[4:7], s63 offen sc1
L_wfp_134:
    s_sleep 2
    buffer_load_dwordx2 v[252:253], v251, s[4:7], s63 offen sc1
    s_waitcnt vmcnt(1)
    v_cmp_ne_u32 vcc, s20, v254
    s_mov_b64 s[64:65], vcc
    v_cmp_ne_u32 vcc, s21, v255
    s_or_b64 s[64:65], s[64:65], vcc
    s_cmp_eq_u64 s[64:65], 0
    s_cbranch_scc1 L_wfo2_136
    s_sleep 2
    buffer_load_dwordx2 v[254:255], v251, s[4:7], s63 offen sc1
    s_waitcnt vmcnt(1)
    v_cmp_ne_u32 vcc, s20, v252
    s_mov_b64 s[64:65], vcc
    v_cmp_ne_u32 vcc, s21, v253
    s_or_b64 s[64:65], s[64:65], vcc
    s_cmp_eq_u64 s[64:65], 0
    s_cbranch_scc1 L_wfo2_136
    s_sub_u32 s62, s62, 1
    s_cmp_lg_u32 s62, 0
    s_cbranch_scc1 L_wfp_134
    s_mov_b32 s28, 12
    s_branch L_fail
L_wfo2_136:
L_wfok_135:
    s_mul_i32 s30, s77, 20480
    s_add_u32 s30, s30, 4718592
    buffer_load_dwordx4 v3, s[4:7], s95 offen offset:2048 lds
    buffer_load_dwordx4 v3, s[4:7], s95 offen offset:3072 lds
    s_add_u32 s88, s30, 0
    s_nop 0
    buffer_load_dwordx4 a[16:19], v3, s[4:7], s88 offen offset:0 sc1
    s_add_u32 s89, s30, 20480
    buffer_load_dwordx4 a[96:99], v3, s[4:7], s89 offen offset:0 sc1
    buffer_load_dwordx4 a[20:23], v3, s[4:7], s88 offen offset:1024 sc1
    buffer_load_dwordx4 a[100:103], v3, s[4:7], s89 offen offset:1024 sc1
    buffer_load_dwordx2 a[24:25], v203, s[4:7], s88 offen offset:2048 sc1
    buffer_load_dwordx2 a[26:27], v203, s[4:7], s88 offen offset:2560 sc1
    buffer_load_dwordx2 a[104:105], v203, s[4:7], s89 offen offset:2048 sc1
    buffer_load_dwordx2 a[106:107], v203, s[4:7], s89 offen offset:2560 sc1
    buffer_load_dwordx4 a[28:31], v3, s[4:7], s88 offen offset:3072 sc1
    buffer_load_dwordx4 a[108:111], v3, s[4:7], s89 offen offset:3072 sc1
    s_add_u32 s88, s30, 4096
    buffer_load_dwordx4 a[32:35], v3, s[4:7], s88 offen offset:0 sc1
    s_add_u32 s89, s30, 24576
    buffer_load_dwordx4 a[112:115], v3, s[4:7], s89 offen offset:0 sc1
    buffer_load_dwordx4 a[36:39], v3, s[4:7], s88 offen offset:1024 sc1
    buffer_load_dwordx4 a[116:119], v3, s[4:7], s89 offen offset:1024 sc1
    ds_read_b128 v[100:103], v202 offset:24576
    ds_read_b128 v[104:107], v202 offset:25600
    ds_read_b128 v[108:111], v202 offset:26624
    ds_read_b128 v[112:115], v202 offset:27648
    ds_read_b128 v[116:119], v202 offset:28672
    ds_read_b128 v[120:123], v202 offset:29696
    ds_read_b128 v[124:127], v202 offset:30720
    ds_read_b128 v[128:131], v202 offset:31744
    ds_read_b128 v[132:135], v202 offset:32768
    ds_read_b128 v[136:139], v202 offset:33792
    ds_read_b128 v[140:143], v202 offset:34816
    ds_read_b128 v[144:147], v202 offset:35840
    ds_read_b128 v[148:151], v202 offset:36864
    ds_read_b128 v[152:155], v202 offset:37888
    s_waitcnt lgkmcnt(7)
    s_waitcnt vmcnt(13)
    s_waitcnt vmcnt(12)
    s_nop 0
    v_mfma_f32_16x16x32_bf16 v[44:47], v[100:103], a[16:19], 0
    ds_read_b128 v[156:159], v202 offset:38912
    s_add_u32 s94, s93, 65536
    s_mov_b32 m0, s94
    s_nop 0
    s_add_u32 s95, s91, 81920
    buffer_load_dwordx4 v3, s[4:7], s95 offen offset:0 lds
    v_mfma_f32_16x16x32_bf16 v[48:51], v[104:107], a[16:19], 0
    ds_read_b128 v[160:163], v202 offset:39936
    v_mfma_f32_16x16x32_bf16 v[52:55], v[108:111], a[16:19], 0
    ds_read_b128 v[164:167], v200 offset:0
    v_mfma_f32_16x16x32_bf16 v[56:59], v[112:115], a[16:19], 0
    ds_read_b128 v[168:171], v200 offset:1024
    v_mfma_f32_16x16x32_bf16 v[60:63], v[116:119], a[16:19], 0
    ds_read_b128 v[172:175], v200 offset:2048
    buffer_load_dwordx4 v3, s[4:7], s95 offen offset:1024 lds
    v_mfma_f32_16x16x32_bf16 v[64:67], v[120:123], a[16:19], 0
    ds_read_b128 v[176:179], v200 offset:3072
    v_mfma_f32_16x16x32_bf16 v[68:71], v[124:127], a[16:19], 0
    ds_read_b128 v[180:183], v200 offset:4096
    v_mfma_f32_16x16x32_bf16 v[72:75], v[100:103], a[96:99], 0
    v_mfma_f32_16x16x32_bf16 v[76:79], v[104:107], a[96:99], 0
    v_mfma_f32_16x16x32_bf16 v[80:83], v[108:111], a[96:99], 0
    buffer_load_dwordx4 v3, s[4:7], s95 offen offset:2048 lds
    v_mfma_f32_16x16x32_bf16 v[84:87], v[112:115], a[96:99], 0
    v_mfma_f32_16x16x32_bf16 v[88:91], v[116:119], a[96:99], 0
    v_mfma_f32_16x16x32_bf16 v[92:95], v[120:123], a[96:99], 0
    v_mfma_f32_16x16x32_bf16 v[96:99], v[124:127], a[96:99], 0
    s_waitcnt lgkmcnt(7)
    s_waitcnt vmcnt(14)
    s_waitcnt vmcnt(13)
    s_nop 0
    v_mfma_f32_16x16x32_bf16 v[44:47], v[128:131], a[20:23], v[44:47]
    ds_read_b128 v[100:103], v200 offset:5120
    buffer_load_dwordx4 v3, s[4:7], s95 offen offset:3072 lds
    v_mfma_f32_16x16x32_bf16 v[48:51], v[132:135], a[20:23], v[48:51]
    ds_read_b128 v[104:107], v200 offset:6144
    v_mfma_f32_16x16x32_bf16 v[52:55], v[136:139], a[20:23], v[52:55]
    ds_read_b128 v[108:111], v200 offset:7168
    v_mfma_f32_16x16x32_bf16 v[56:59], v[140:143], a[20:23], v[56:59]
    ds_read_b128 v[112:115], v200 offset:8192
    buffer_load_dwordx4 a[40:43], v3, s[4:7], s88 offen offset:2048 sc1
    v_mfma_f32_16x16x32_bf16 v[60:63], v[144:147], a[20:23], v[60:63]
    ds_read_b128 v[116:119], v200 offset:9216
    v_mfma_f32_16x16x32_bf16 v[64:67], v[148:151], a[20:23], v[64:67]
    ds_read_b128 v[120:123], v200 offset:10240
    v_mfma_f32_16x16x32_bf16 v[68:71], v[152:155], a[20:23], v[68:71]
    ds_read_b128 v[124:127], v200 offset:11264
    v_mfma_f32_16x16x32_bf16 v[72:75], v[128:131], a[100:103], v[72:75]
    buffer_load_dwordx4 a[120:123], v3, s[4:7], s89 offen offset:2048 sc1
    v_mfma_f32_16x16x32_bf16 v[76:79], v[132:135], a[100:103], v[76:79]
    v_mfma_f32_16x16x32_bf16 v[80:83], v[136:139], a[100:103], v[80:83]
    v_mfma_f32_16x16x32_bf16 v[84:87], v[140:143], a[100:103], v[84:87]
    buffer_load_dwordx2 a[44:45], v203, s[4:7], s88 offen offset:3072 sc1
    buffer_load_dwordx2 a[46:47], v203, s[4:7], s88 offen offset:3584 sc1
    v_mfma_f32_16x16x32_bf16 v[88:91], v[144:147], a[100:103], v[88:91]
    v_mfma_f32_16x16x32_bf16 v[92:95], v[148:151], a[100:103], v[92:95]
    v_mfma_f32_16x16x32_bf16 v[96:99], v[152:155], a[100:103], v[96:99]
    s_barrier
    s_waitcnt lgkmcnt(7)
    s_waitcnt vmcnt(16)
    s_waitcnt vmcnt(14)
    v_mfma_f32_16x16x32_bf16 v[44:47], v[156:159], a[24:27], v[44:47]
    ds_read_b128 v[128:131], v200 offset:12288
    buffer_load_dwordx2 a[124:125], v203, s[4:7], s89 offen offset:3072 sc1
    buffer_load_dwordx2 a[126:127], v203, s[4:7], s89 offen offset:3584 sc1
    v_mfma_f32_16x16x32_bf16 v[48:51], v[160:163], a[24:27], v[48:51]
    ds_read_b128 v[132:135], v200 offset:13312
    v_mfma_f32_16x16x32_bf16 v[52:55], v[164:167], a[24:27], v[52:55]
    ds_read_b128 v[136:139], v200 offset:14336
    v_mfma_f32_16x16x32_bf16 v[56:59], v[168:171], a[24:27], v[56:59]
    ds_read_b128 v[140:143], v200 offset:15360
    v_mfma_f32_16x16x32_bf16 v[60:63], v[172:175], a[24:27], v[60:63]
    ds_read_b128 v[144:147], v200 offset:16384
    s_add_u32 s88, s30, 8192
    buffer_load_dwordx4 a[48:51], v3, s[4:7], s88 offen offset:0 sc1
    v_mfma_f32_16x16x32_bf16 v[64:67], v[176:179], a[24:27], v[64:67]
    ds_read_b128 v[148:151], v200 offset:17408
    v_mfma_f32_16x16x32_bf16 v[68:71], v[180:183], a[24:27], v[68:71]
    ds_read_b128 v[152:155], v200 offset:18432
    v_mfma_f32_16x16x32_bf16 v[72:75], v[156:159], a[104:107], v[72:75]
    v_mfma_f32_16x16x32_bf16 v[76:79], v[160:163], a[104:107], v[76:79]
    v_mfma_f32_16x16x32_bf16 v[80:83], v[164:167], a[104:107], v[80:83]
    s_add_u32 s89, s30, 28672
    buffer_load_dwordx4 a[128:131], v3, s[4:7], s89 offen offset:0 sc1
    v_mfma_f32_16x16x32_bf16 v[84:87], v[168:171], a[104:107], v[84:87]
    v_mfma_f32_16x16x32_bf16 v[88:91], v[172:175], a[104:107], v[88:91]
    v_mfma_f32_16x16x32_bf16 v[92:95], v[176:179], a[104:107], v[92:95]
    v_mfma_f32_16x16x32_bf16 v[96:99], v[180:183], a[104:107], v[96:99]
    s_waitcnt lgkmcnt(7)
    s_waitcnt vmcnt(17)
    s_waitcnt vmcnt(16)
    s_nop 0
    v_mfma_f32_16x16x32_bf16 v[44:47], v[100:103], a[28:31], v[44:47]
    ds_read_b128 v[156:159], v200 offset:19456
    buffer_load_dwordx4 a[52:55], v3, s[4:7], s88 offen offset:1024 sc1
    v_mfma_f32_16x16x32_bf16 v[48:51], v[104:107], a[28:31], v[48:51]
    ds_read_b128 v[160:163], v200 offset:20480
    v_mfma_f32_16x16x32_bf16 v[52:55], v[108:111], a[28:31], v[52:55]
    ds_read_b128 v[164:167], v200 offset:21504
    v_mfma_f32_16x16x32_bf16 v[56:59], v[112:115], a[28:31], v[56:59]
    ds_read_b128 v[168:171], v200 offset:22528
    buffer_load_dwordx4 a[132:135], v3, s[4:7], s89 offen offset:1024 sc1
    v_mfma_f32_16x16x32_bf16 v[60:63], v[116:119], a[28:31], v[60:63]
    ds_read_b128 v[172:175], v200 offset:23552
    v_mfma_f32_16x16x32_bf16 v[64:67], v[120:123], a[28:31], v[64:67]
    ds_read_b128 v[176:179], v200 offset:24576
    v_mfma_f32_16x16x32_bf16 v[68:71], v[124:127], a[28:31], v[68:71]
    ds_read_b128 v[180:183], v200 offset:25600
    v_mfma_f32_16x16x32_bf16 v[72:75], v[100:103], a[108:111], v[72:75]
    s_add_u32 s94, s93, 81920
    s_mov_b32 m0, s94
    s_nop 0
    s_add_u32 s95, s91, 98304
    buffer_load_dwordx4 v3, s[4:7], s95 offen offset:0 lds
    v_mfma_f32_16x16x32_bf16 v[76:79], v[104:107], a[108:111], v[76:79]
    v_mfma_f32_16x16x32_bf16 v[80:83], v[108:111], a[108:111], v[80:83]
    v_mfma_f32_16x16x32_bf16 v[84:87], v[112:115], a[108:111], v[84:87]
    buffer_load_dwordx4 v3, s[4:7], s95 offen offset:1024 lds
    v_mfma_f32_16x16x32_bf16 v[88:91], v[116:119], a[108:111], v[88:91]
    v_mfma_f32_16x16x32_bf16 v[92:95], v[120:123], a[108:111], v[92:95]
    v_mfma_f32_16x16x32_bf16 v[96:99], v[124:127], a[108:111], v[96:99]
    s_waitcnt lgkmcnt(7)
    s_waitcnt vmcnt(19)
    s_waitcnt vmcnt(18)
    s_nop 0
    v_mfma_f32_16x16x32_bf16 v[44:47], v[128:131], a[32:35], v[44:47]
    ds_read_b128 v[100:103], v200 offset:26624
    buffer_load_dwordx4 v3, s[4:7], s95 offen offset:2048 lds
    v_mfma_f32_16x16x32_bf16 v[48:51], v[132:135], a[32:35], v[48:51]
    ds_read_b128 v[104:107], v200 offset:27648
    v_mfma_f32_16x16x32_bf16 v[52:55], v[136:139], a[32:35], v[52:55]
    ds_read_b128 v[108:111], v200 offset:28672
    v_mfma_f32_16x16x32_bf16 v[56:59], v[140:143], a[32:35], v[56:59]
    ds_read_b128 v[112:115], v200 offset:29696
    v_mfma_f32_16x16x32_bf16 v[60:63], v[144:147], a[32:35], v[60:63]
    ds_read_b128 v[116:119], v200 offset:30720
    buffer_load_dwordx4 v3, s[4:7], s95 offen offset:3072 lds
    v_mfma_f32_16x16x32_bf16 v[64:67], v[148:151], a[32:35], v[64:67]
    ds_read_b128 v[120:123], v200 offset:31744
    v_mfma_f32_16x16x32_bf16 v[68:71], v[152:155], a[32:35], v[68:71]
    ds_read_b128 v[124:127], v200 offset:32768
    v_mfma_f32_16x16x32_bf16 v[72:75], v[128:131], a[112:115], v[72:75]
    v_mfma_f32_16x16x32_bf16 v[76:79], v[132:135], a[112:115], v[76:79]
    v_mfma_f32_16x16x32_bf16 v[80:83], v[136:139], a[112:115], v[80:83]
    buffer_load_dwordx4 a[56:59], v3, s[4:7], s88 offen offset:2048 sc1
    v_mfma_f32_16x16x32_bf16 v[84:87], v[140:143], a[112:115], v[84:87]
    v_mfma_f32_16x16x32_bf16 v[88:91], v[144:147], a[112:115], v[88:91]
    v_mfma_f32_16x16x32_bf16 v[92:95], v[148:151], a[112:115], v[92:95]
    v_mfma_f32_16x16x32_bf16 v[96:99], v[152:155], a[112:115], v[96:99]
    s_waitcnt lgkmcnt(7)
    s_waitcnt vmcnt(20)
    s_waitcnt vmcnt(19)
    s_nop 0
    v_mfma_f32_16x16x32_bf16 v[44:47], v[156:159], a[36:39], v[44:47]
    ds_read_b128 v[128:131], v200 offset:33792
    buffer_load_dwordx4 a[136:139], v3, s[4:7], s89 offen offset:2048 sc1
    v_mfma_f32_16x16x32_bf16 v[48:51], v[160:163], a[36:39], v[48:51]
    ds_read_b128 v[132:135], v200 offset:34816
    v_mfma_f32_16x16x32_bf16 v[52:55], v[164:167], a[36:39], v[52:55]
    ds_read_b128 v[136:139], v200 offset:35840
    v_mfma_f32_16x16x32_bf16 v[56:59], v[168:171], a[36:39], v[56:59]
    ds_read_b128 v[140:143], v200 offset:36864
    buffer_load_dwordx4 a[60:63], v3, s[4:7], s88 offen offset:3072 sc1
    v_mfma_f32_16x16x32_bf16 v[60:63], v[172:175], a[36:39], v[60:63]
    ds_read_b128 v[144:147], v200 offset:37888
    v_mfma_f32_16x16x32_bf16 v[64:67], v[176:179], a[36:39], v[64:67]
    ds_read_b128 v[148:151], v200 offset:38912
    v_mfma_f32_16x16x32_bf16 v[68:71], v[180:183], a[36:39], v[68:71]
    ds_read_b128 v[152:155], v200 offset:39936
    v_mfma_f32_16x16x32_bf16 v[72:75], v[156:159], a[116:119], v[72:75]
    buffer_load_dwordx4 a[140:143], v3, s[4:7], s89 offen offset:3072 sc1
    v_mfma_f32_16x16x32_bf16 v[76:79], v[160:163], a[116:119], v[76:79]
    v_mfma_f32_16x16x32_bf16 v[80:83], v[164:167], a[116:119], v[80:83]
    v_mfma_f32_16x16x32_bf16 v[84:87], v[168:171], a[116:119], v[84:87]
    s_add_u32 s88, s30, 12288
    buffer_load_dwordx2 a[64:65], v203, s[4:7], s88 offen offset:0 sc1
    buffer_load_dwordx2 a[66:67], v203, s[4:7], s88 offen offset:512 sc1
    v_mfma_f32_16x16x32_bf16 v[88:91], v[172:175], a[116:119], v[88:91]
    v_mfma_f32_16x16x32_bf16 v[92:95], v[176:179], a[116:119], v[92:95]
    v_mfma_f32_16x16x32_bf16 v[96:99], v[180:183], a[116:119], v[96:99]
    s_waitcnt vmcnt(20)
    s_barrier
    s_waitcnt lgkmcnt(7)
    s_waitcnt vmcnt(19)
    s_waitcnt vmcnt(18)
    s_nop 0
    v_mfma_f32_16x16x32_bf16 v[44:47], v[100:103], a[40:43], v[44:47]
    ds_read_b128 v[156:159], v200 offset:40960
    s_add_u32 s89, s30, 32768
    buffer_load_dwordx2 a[144:145], v203, s[4:7], s89 offen offset:0 sc1
    buffer_load_dwordx2 a[146:147], v203, s[4:7], s89 offen offset:512 sc1
    v_mfma_f32_16x16x32_bf16 v[48:51], v[104:107], a[40:43], v[48:51]
    ds_read_b128 v[160:163], v200 offset:41984
    v_mfma_f32_16x16x32_bf16 v[52:55], v[108:111], a[40:43], v[52:55]
    ds_read_b128 v[164:167], v200 offset:43008
    v_mfma_f32_16x16x32_bf16 v[56:59], v[112:115], a[40:43], v[56:59]
    ds_read_b128 v[168:171], v200 offset:44032
    v_mfma_f32_16x16x32_bf16 v[60:63], v[116:119], a[40:43], v[60:63]
    ds_read_b128 v[172:175], v200 offset:45056
    buffer_load_dwordx4 a[68:71], v3, s[4:7], s88 offen offset:1024 sc1
    v_mfma_f32_16x16x32_bf16 v[64:67], v[120:123], a[40:43], v[64:67]
    ds_read_b128 v[176:179], v200 offset:46080
    v_mfma_f32_16x16x32_bf16 v[68:71], v[124:127], a[40:43], v[68:71]
    ds_read_b128 v[180:183], v200 offset:47104
    v_mfma_f32_16x16x32_bf16 v[72:75], v[100:103], a[120:123], v[72:75]
    v_mfma_f32_16x16x32_bf16 v[76:79], v[104:107], a[120:123], v[76:79]
    v_mfma_f32_16x16x32_bf16 v[80:83], v[108:111], a[120:123], v[80:83]
    buffer_load_dwordx4 a[148:151], v3, s[4:7], s89 offen offset:1024 sc1
    v_mfma_f32_16x16x32_bf16 v[84:87], v[112:115], a[120:123], v[84:87]
    v_mfma_f32_16x16x32_bf16 v[88:91], v[116:119], a[120:123], v[88:91]
    v_mfma_f32_16x16x32_bf16 v[92:95], v[120:123], a[120:123], v[92:95]
    v_mfma_f32_16x16x32_bf16 v[96:99], v[124:127], a[120:123], v[96:99]
    s_waitcnt lgkmcnt(7)
    s_waitcnt vmcnt(20)
    s_waitcnt vmcnt(18)
    s_nop 0
    v_mfma_f32_16x16x32_bf16 v[44:47], v[128:131], a[44:47], v[44:47]
    ds_read_b128 v[100:103], v200 offset:48128
    s_add_u32 s94, s93, 98304
    s_mov_b32 m0, s94
    s_nop 0
    s_add_u32 s95, s91, 114688
    buffer_load_dwordx4 v3, s[4:7], s95 offen offset:0 lds
    v_mfma_f32_16x16x32_bf16 v[48:51], v[132:135], a[44:47], v[48:51]
    ds_read_b128 v[104:107], v200 offset:49152
    v_mfma_f32_16x16x32_bf16 v[52:55], v[136:139], a[44:47], v[52:55]
    ds_read_b128 v[108:111], v200 offset:50176
    v_mfma_f32_16x16x32_bf16 v[56:59], v[140:143], a[44:47], v[56:59]
    ds_read_b128 v[112:115], v200 offset:51200
    buffer_load_dwordx4 v3, s[4:7], s95 offen offset:1024 lds
    v_mfma_f32_16x16x32_bf16 v[60:63], v[144:147], a[44:47], v[60:63]
    ds_read_b128 v[116:119], v200 offset:52224
    v_mfma_f32_16x16x32_bf16 v[64:67], v[148:151], a[44:47], v[64:67]
    ds_read_b128 v[120:123], v200 offset:53248
    v_mfma_f32_16x16x32_bf16 v[68:71], v[152:155], a[44:47], v[68:71]
    ds_read_b128 v[124:127], v200 offset:54272
    v_mfma_f32_16x16x32_bf16 v[72:75], v[128:131], a[124:127], v[72:75]
    buffer_load_dwordx4 v3, s[4:7], s95 offen offset:2048 lds
    v_mfma_f32_16x16x32_bf16 v[76:79], v[132:135], a[124:127], v[76:79]
    v_mfma_f32_16x16x32_bf16 v[80:83], v[136:139], a[124:127], v[80:83]
    v_mfma_f32_16x16x32_bf16 v[84:87], v[140:143], a[124:127], v[84:87]
    buffer_load_dwordx4 v3, s[4:7], s95 offen offset:3072 lds
    v_mfma_f32_16x16x32_bf16 v[88:91], v[144:147], a[124:127], v[88:91]
    v_mfma_f32_16x16x32_bf16 v[92:95], v[148:151], a[124:127], v[92:95]
    v_mfma_f32_16x16x32_bf16 v[96:99], v[152:155], a[124:127], v[96:99]
    s_waitcnt lgkmcnt(7)
    s_waitcnt vmcnt(21)
    s_waitcnt vmcnt(20)
    s_nop 0
    v_mfma_f32_16x16x32_bf16 v[44:47], v[156:159], a[48:51], v[44:47]
    ds_read_b128 v[128:131], v200 offset:55296
    s_add_u32 s94, s93, 114688
    s_mov_b32 m0, s94
    s_nop 0
    s_add_u32 s95, s91, 131072
    buffer_load_dwordx4 v3, s[4:7], s95 offen offset:0 lds
    v_mfma_f32_16x16x32_bf16 v[48:51], v[160:163], a[48:51], v[48:51]
    ds_read_b128 v[132:135], v200 offset:56320
    v_mfma_f32_16x16x32_bf16 v[52:55], v[164:167], a[48:51], v[52:55]
    ds_read_b128 v[136:139], v200 offset:57344
    v_mfma_f32_16x16x32_bf16 v[56:59], v[168:171], a[48:51], v[56:59]
    ds_read_b128 v[140:143], v200 offset:58368
    v_mfma_f32_16x16x32_bf16 v[60:63], v[172:175], a[48:51], v[60:63]
    ds_read_b128 v[144:147], v200 offset:59392
    buffer_load_dwordx4 v3, s[4:7], s95 offen offset:1024 lds
    v_mfma_f32_16x16x32_bf16 v[64:67], v[176:179], a[48:51], v[64:67]
    ds_read_b128 v[148:151], v200 offset:60416
    v_mfma_f32_16x16x32_bf16 v[68:71], v[180:183], a[48:51], v[68:71]
    ds_read_b128 v[152:155], v201 offset:0
    v_mfma_f32_16x16x32_bf16 v[72:75], v[156:159], a[128:131], v[72:75]
    v_mfma_f32_16x16x32_bf16 v[76:79], v[160:163], a[128:131], v[76:79]
    v_mfma_f32_16x16x32_bf16 v[80:83], v[164:167], a[128:131], v[80:83]
    buffer_load_dwordx4 v3, s[4:7], s95 offen offset:2048 lds
    v_mfma_f32_16x16x32_bf16 v[84:87], v[168:171], a[128:131], v[84:87]
    v_mfma_f32_16x16x32_bf16 v[88:91], v[172:175], a[128:131], v[88:91]
    v_mfma_f32_16x16x32_bf16 v[92:95], v[176:179], a[128:131], v[92:95]
    v_mfma_f32_16x16x32_bf16 v[96:99], v[180:183], a[128:131], v[96:99]
    s_waitcnt lgkmcnt(7)
    s_waitcnt vmcnt(22)
    s_waitcnt vmcnt(21)
    s_nop 0
    v_mfma_f32_16x16x32_bf16 v[44:47], v[100:103], a[52:55], v[44:47]
    ds_read_b128 v[156:159], v201 offset:1024
    buffer_load_dwordx4 v3, s[4:7], s95 offen offset:3072 lds
    v_mfma_f32_16x16x32_bf16 v[48:51], v[104:107], a[52:55], v[48:51]
    ds_read_b128 v[160:163], v201 offset:2048
    v_mfma_f32_16x16x32_bf16 v[52:55], v[108:111], a[52:55], v[52:55]
    ds_read_b128 v[164:167], v201 offset:3072
    v_mfma_f32_16x16x32_bf16 v[56:59], v[112:115], a[52:55], v[56:59]
    ds_read_b128 v[168:171], v201 offset:4096
    buffer_load_dwordx4 a[72:75], v3, s[4:7], s88 offen offset:2048 sc1
    v_mfma_f32_16x16x32_bf16 v[60:63], v[116:119], a[52:55], v[60:63]
    ds_read_b128 v[172:175], v201 offset:5120
    v_mfma_f32_16x16x32_bf16 v[64:67], v[120:123], a[52:55], v[64:67]
    ds_read_b128 v[176:179], v201 offset:6144
    v_mfma_f32_16x16x32_bf16 v[68:71], v[124:127], a[52:55], v[68:71]
    ds_read_b128 v[180:183], v201 offset:7168
    v_mfma_f32_16x16x32_bf16 v[72:75], v[100:103], a[132:135], v[72:75]
    buffer_load_dwordx4 a[152:155], v3, s[4:7], s89 offen offset:2048 sc1
    v_mfma_f32_16x16x32_bf16 v[76:79], v[104:107], a[132:135], v[76:79]
    v_mfma_f32_16x16x32_bf16 v[80:83], v[108:111], a[132:135], v[80:83]
    v_mfma_f32_16x16x32_bf16 v[84:87], v[112:115], a[132:135], v[84:87]
    buffer_load_dwordx4 a[76:79], v3, s[4:7], s88 offen offset:3072 sc1
    v_mfma_f32_16x16x32_bf16 v[88:91], v[116:119], a[132:135], v[88:91]
    v_mfma_f32_16x16x32_bf16 v[92:95], v[120:123], a[132:135], v[92:95]
    v_mfma_f32_16x16x32_bf16 v[96:99], v[124:127], a[132:135], v[96:99]
    s_waitcnt vmcnt(21)
    s_barrier
    s_waitcnt lgkmcnt(7)
    s_waitcnt vmcnt(20)
    s_waitcnt vmcnt(19)
    s_nop 0
    v_mfma_f32_16x16x32_bf16 v[44:47], v[128:131], a[56:59], v[44:47]
    ds_read_b128 v[100:103], v201 offset:8192
    buffer_load_dwordx4 a[156:159], v3, s[4:7], s89 offen offset:3072 sc1
    v_mfma_f32_16x16x32_bf16 v[48:51], v[132:135], a[56:59], v[48:51]
    ds_read_b128 v[104:107], v201 offset:9216
    v_mfma_f32_16x16x32_bf16 v[52:55], v[136:139], a[56:59], v[52:55]
    ds_read_b128 v[108:111], v201 offset:10240
    v_mfma_f32_16x16x32_bf16 v[56:59], v[140:143], a[56:59], v[56:59]
    ds_read_b128 v[112:115], v201 offset:11264
    v_mfma_f32_16x16x32_bf16 v[60:63], v[144:147], a[56:59], v[60:63]
    ds_read_b128 v[116:119], v201 offset:12288
    s_add_u32 s88, s30, 16384
    buffer_load_dwordx4 a[80:83], v3, s[4:7], s88 offen offset:0 sc1
    v_mfma_f32_16x16x32_bf16 v[64:67], v[148:151], a[56:59], v[64:67]
    ds_read_b128 v[120:123], v201 offset:13312
    v_mfma_f32_16x16x32_bf16 v[68:71], v[152:155], a[56:59], v[68:71]
    ds_read_b128 v[124:127], v201 offset:14336
    v_mfma_f32_16x16x32_bf16 v[72:75], v[128:131], a[136:139], v[72:75]
    v_mfma_f32_16x16x32_bf16 v[76:79], v[132:135], a[136:139], v[76:79]
    v_mfma_f32_16x16x32_bf16 v[80:83], v[136:139], a[136:139], v[80:83]
    s_add_u32 s89, s30, 36864
    buffer_load_dwordx4 a[160:163], v3, s[4:7], s89 offen offset:0 sc1
    v_mfma_f32_16x16x32_bf16 v[84:87], v[140:143], a[136:139], v[84:87]
    v_mfma_f32_16x16x32_bf16 v[88:91], v[144:147], a[136:139], v[88:91]
    v_mfma_f32_16x16x32_bf16 v[92:95], v[148:151], a[136:139], v[92:95]
    v_mfma_f32_16x16x32_bf16 v[96:99], v[152:155], a[136:139], v[96:99]
    s_waitcnt lgkmcnt(7)
    s_waitcnt vmcnt(21)
    s_waitcnt vmcnt(20)
    s_nop 0
    v_mfma_f32_16x16x32_bf16 v[44:47], v[156:159], a[60:63], v[44:47]
    ds_read_b128 v[128:131], v201 offset:15360
    buffer_load_dwordx2 a[84:85], v203, s[4:7], s88 offen offset:1024 sc1
    buffer_load_dwordx2 a[86:87], v203, s[4:7], s88 offen offset:1536 sc1
    v_mfma_f32_16x16x32_bf16 v[48:51], v[160:163], a[60:63], v[48:51]
    ds_read_b128 v[132:135], v201 offset:16384
    v_mfma_f32_16x16x32_bf16 v[52:55], v[164:167], a[60:63], v[52:55]
    ds_read_b128 v[136:139], v201 offset:17408
    v_mfma_f32_16x16x32_bf16 v[56:59], v[168:171], a[60:63], v[56:59]
    ds_read_b128 v[140:143], v201 offset:18432
    buffer_load_dwordx2 a[164:165], v203, s[4:7], s89 offen offset:1024 sc1
    buffer_load_dwordx2 a[166:167], v203, s[4:7], s89 offen offset:1536 sc1
    v_mfma_f32_16x16x32_bf16 v[60:63], v[172:175], a[60:63], v[60:63]
    ds_read_b128 v[144:147], v201 offset:19456
    v_mfma_f32_16x16x32_bf16 v[64:67], v[176:179], a[60:63], v[64:67]
    ds_read_b128 v[148:151], v201 offset:20480
    v_mfma_f32_16x16x32_bf16 v[68:71], v[180:183], a[60:63], v[68:71]
    ds_read_b128 v[152:155], v201 offset:21504
    v_mfma_f32_16x16x32_bf16 v[72:75], v[156:159], a[140:143], v[72:75]
    buffer_load_dwordx4 a[88:91], v3, s[4:7], s88 offen offset:2048 sc1
    v_mfma_f32_16x16x32_bf16 v[76:79], v[160:163], a[140:143], v[76:79]
    v_mfma_f32_16x16x32_bf16 v[80:83], v[164:167], a[140:143], v[80:83]
    v_mfma_f32_16x16x32_bf16 v[84:87], v[168:171], a[140:143], v[84:87]
    buffer_load_dwordx4 a[168:171], v3, s[4:7], s89 offen offset:2048 sc1
    v_mfma_f32_16x16x32_bf16 v[88:91], v[172:175], a[140:143], v[88:91]
    v_mfma_f32_16x16x32_bf16 v[92:95], v[176:179], a[140:143], v[92:95]
    v_mfma_f32_16x16x32_bf16 v[96:99], v[180:183], a[140:143], v[96:99]
    s_waitcnt lgkmcnt(7)
    s_waitcnt vmcnt(24)
    s_waitcnt vmcnt(22)
    s_nop 0
    v_mfma_f32_16x16x32_bf16 v[44:47], v[100:103], a[64:67], v[44:47]
    ds_read_b128 v[156:159], v201 offset:22528
    buffer_load_dwordx4 a[92:95], v3, s[4:7], s88 offen offset:3072 sc1
    v_mfma_f32_16x16x32_bf16 v[48:51], v[104:107], a[64:67], v[48:51]
    ds_read_b128 v[160:163], v201 offset:23552
    v_mfma_f32_16x16x32_bf16 v[52:55], v[108:111], a[64:67], v[52:55]
    ds_read_b128 v[164:167], v201 offset:24576
    v_mfma_f32_16x16x32_bf16 v[56:59], v[112:115], a[64:67], v[56:59]
    ds_read_b128 v[168:171], v201 offset:25600
    v_mfma_f32_16x16x32_bf16 v[60:63], v[116:119], a[64:67], v[60:63]
    ds_read_b128 v[172:175], v201 offset:26624
    buffer_load_dwordx4 a[172:175], v3, s[4:7], s89 offen offset:3072 sc1
    v_mfma_f32_16x16x32_bf16 v[64:67], v[120:123], a[64:67], v[64:67]
    ds_read_b128 v[176:179], v201 offset:27648
    v_mfma_f32_16x16x32_bf16 v[68:71], v[124:127], a[64:67], v[68:71]
    ds_read_b128 v[180:183], v201 offset:28672
    v_mfma_f32_16x16x32_bf16 v[72:75], v[100:103], a[144:147], v[72:75]
    v_mfma_f32_16x16x32_bf16 v[76:79], v[104:107], a[144:147], v[76:79]
    v_mfma_f32_16x16x32_bf16 v[80:83], v[108:111], a[144:147], v[80:83]
    s_add_u32 s94, s93, 131072
    s_mov_b32 m0, s94
    s_add_u32 s95, s92, 0
    buffer_load_dwordx4 v3, s[4:7], s95 offen offset:0 lds
    v_mfma_f32_16x16x32_bf16 v[84:87], v[112:115], a[144:147], v[84:87]
    v_mfma_f32_16x16x32_bf16 v[88:91], v[116:119], a[144:147], v[88:91]
    v_mfma_f32_16x16x32_bf16 v[92:95], v[120:123], a[144:147], v[92:95]
    v_mfma_f32_16x16x32_bf16 v[96:99], v[124:127], a[144:147], v[96:99]
    s_waitcnt lgkmcnt(7)
    s_waitcnt vmcnt(24)
    s_waitcnt vmcnt(23)
    s_nop 0
    v_mfma_f32_16x16x32_bf16 v[44:47], v[128:131], a[68:71], v[44:47]
    ds_read_b128 v[100:103], v201 offset:29696
    buffer_load_dwordx4 v3, s[4:7], s95 offen offset:1024 lds
    v_mfma_f32_16x16x32_bf16 v[48:51], v[132:135], a[68:71], v[48:51]
    ds_read_b128 v[104:107], v201 offset:30720
    v_mfma_f32_16x16x32_bf16 v[52:55], v[136:139], a[68:71], v[52:55]
    ds_read_b128 v[108:111], v201 offset:31744
    v_mfma_f32_16x16x32_bf16 v[56:59], v[140:143], a[68:71], v[56:59]
    ds_read_b128 v[112:115], v201 offset:32768
    buffer_load_dwordx4 v3, s[4:7], s95 offen offset:2048 lds
    v_mfma_f32_16x16x32_bf16 v[60:63], v[144:147], a[68:71], v[60:63]
    ds_read_b128 v[116:119], v201 offset:33792
    v_mfma_f32_16x16x32_bf16 v[64:67], v[148:151], a[68:71], v[64:67]
    ds_read_b128 v[120:123], v201 offset:34816
    v_mfma_f32_16x16x32_bf16 v[68:71], v[152:155], a[68:71], v[68:71]
    ds_read_b128 v[124:127], v201 offset:35840
    v_mfma_f32_16x16x32_bf16 v[72:75], v[128:131], a[148:151], v[72:75]
    buffer_load_dwordx4 v3, s[4:7], s95 offen offset:3072 lds
    v_mfma_f32_16x16x32_bf16 v[76:79], v[132:135], a[148:151], v[76:79]
    v_mfma_f32_16x16x32_bf16 v[80:83], v[136:139], a[148:151], v[80:83]
    v_mfma_f32_16x16x32_bf16 v[84:87], v[140:143], a[148:151], v[84:87]
    s_add_u32 s94, s93, 147456
    s_mov_b32 m0, s94
    s_nop 0
    s_add_u32 s95, s92, 16384
    buffer_load_dwordx4 v3, s[4:7], s95 offen offset:0 lds
    v_mfma_f32_16x16x32_bf16 v[88:91], v[144:147], a[148:151], v[88:91]
    v_mfma_f32_16x16x32_bf16 v[92:95], v[148:151], a[148:151], v[92:95]
    v_mfma_f32_16x16x32_bf16 v[96:99], v[152:155], a[148:151], v[96:99]
    s_waitcnt vmcnt(19)
    s_barrier
    s_waitcnt lgkmcnt(7)
    s_waitcnt vmcnt(18)
    s_waitcnt vmcnt(17)
    s_nop 0
    v_mfma_f32_16x16x32_bf16 v[44:47], v[156:159], a[72:75], v[44:47]
    ds_read_b128 v[128:131], v201 offset:36864
    buffer_load_dwordx4 v3, s[4:7], s95 offen offset:1024 lds
    v_mfma_f32_16x16x32_bf16 v[48:51], v[160:163], a[72:75], v[48:51]
    ds_read_b128 v[132:135], v201 offset:37888
    v_mfma_f32_16x16x32_bf16 v[52:55], v[164:167], a[72:75], v[52:55]
    ds_read_b128 v[136:139], v201 offset:38912
    v_mfma_f32_16x16x32_bf16 v[56:59], v[168:171], a[72:75], v[56:59]
    ds_read_b128 v[140:143], v201 offset:39936
    v_mfma_f32_16x16x32_bf16 v[60:63], v[172:175], a[72:75], v[60:63]
    ds_read_b128 v[144:147], v201 offset:40960
    buffer_load_dwordx4 v3, s[4:7], s95 offen offset:2048 lds
    v_mfma_f32_16x16x32_bf16 v[64:67], v[176:179], a[72:75], v[64:67]
    ds_read_b128 v[148:151], v201 offset:41984
    v_mfma_f32_16x16x32_bf16 v[68:71], v[180:183], a[72:75], v[68:71]
    ds_read_b128 v[152:155], v201 offset:43008
    v_mfma_f32_16x16x32_bf16 v[72:75], v[156:159], a[152:155], v[72:75]
    v_mfma_f32_16x16x32_bf16 v[76:79], v[160:163], a[152:155], v[76:79]
    v_mfma_f32_16x16x32_bf16 v[80:83], v[164:167], a[152:155], v[80:83]
    buffer_load_dwordx4 v3, s[4:7], s95 offen offset:3072 lds
    v_mfma_f32_16x16x32_bf16 v[84:87], v[168:171], a[152:155], v[84:87]
    v_mfma_f32_16x16x32_bf16 v[88:91], v[172:175], a[152:155], v[88:91]
    v_mfma_f32_16x16x32_bf16 v[92:95], v[176:179], a[152:155], v[92:95]
    v_mfma_f32_16x16x32_bf16 v[96:99], v[180:183], a[152:155], v[96:99]
    s_waitcnt lgkmcnt(7)
    s_waitcnt vmcnt(19)
    s_waitcnt vmcnt(18)
    s_nop 0
    v_mfma_f32_16x16x32_bf16 v[44:47], v[100:103], a[76:79], v[44:47]
    ds_read_b128 v[156:159], v201 offset:44032
    s_add_u32 s94, s93, 0
    s_mov_b32 m0, s94
    s_add_u32 s95, s92, 32768
    buffer_load_dwordx4 v3, s[4:7], s95 offen offset:0 lds
    v_mfma_f32_16x16x32_bf16 v[48:51], v[104:107], a[76:79], v[48:51]
    ds_read_b128 v[160:163], v201 offset:45056
    v_mfma_f32_16x16x32_bf16 v[52:55], v[108:111], a[76:79], v[52:55]
    ds_read_b128 v[164:167], v201 offset:46080
    v_mfma_f32_16x16x32_bf16 v[56:59], v[112:115], a[76:79], v[56:59]
    ds_read_b128 v[168:171], v201 offset:47104
    buffer_load_dwordx4 v3, s[4:7], s95 offen offset:1024 lds
    v_mfma_f32_16x16x32_bf16 v[60:63], v[116:119], a[76:79], v[60:63]
    ds_read_b128 v[172:175], v201 offset:48128
    v_mfma_f32_16x16x32_bf16 v[64:67], v[120:123], a[76:79], v[64:67]
    ds_read_b128 v[176:179], v201 offset:49152
    v_mfma_f32_16x16x32_bf16 v[68:71], v[124:127], a[76:79], v[68:71]
    ds_read_b128 v[180:183], v201 offset:50176
    v_mfma_f32_16x16x32_bf16 v[72:75], v[100:103], a[156:159], v[72:75]
    buffer_load_dwordx4 v3, s[4:7], s95 offen offset:2048 lds
    v_mfma_f32_16x16x32_bf16 v[76:79], v[104:107], a[156:159], v[76:79]
    v_mfma_f32_16x16x32_bf16 v[80:83], v[108:111], a[156:159], v[80:83]
    v_mfma_f32_16x16x32_bf16 v[84:87], v[112:115], a[156:159], v[84:87]
    buffer_load_dwordx4 v3, s[4:7], s95 offen offset:3072 lds
    v_mfma_f32_16x16x32_bf16 v[88:91], v[116:119], a[156:159], v[88:91]
    v_mfma_f32_16x16x32_bf16 v[92:95], v[120:123], a[156:159], v[92:95]
    v_mfma_f32_16x16x32_bf16 v[96:99], v[124:127], a[156:159], v[96:99]
    s_waitcnt lgkmcnt(7)
    s_waitcnt vmcnt(21)
    s_waitcnt vmcnt(20)
    s_nop 0
    v_mfma_f32_16x16x32_bf16 v[44:47], v[128:131], a[80:83], v[44:47]
    ds_read_b128 v[100:103], v201 offset:51200
    s_add_u32 s94, s93, 16384
    s_mov_b32 m0, s94
    s_nop 0
    s_add_u32 s95, s92, 49152
    buffer_load_dwordx4 v3, s[4:7], s95 offen offset:0 lds
    v_mfma_f32_16x16x32_bf16 v[48:51], v[132:135], a[80:83], v[48:51]
    ds_read_b128 v[104:107], v201 offset:52224
    v_mfma_f32_16x16x32_bf16 v[52:55], v[136:139], a[80:83], v[52:55]
    ds_read_b128 v[108:111], v201 offset:53248
    v_mfma_f32_16x16x32_bf16 v[56:59], v[140:143], a[80:83], v[56:59]
    ds_read_b128 v[112:115], v201 offset:54272
    v_mfma_f32_16x16x32_bf16 v[60:63], v[144:147], a[80:83], v[60:63]
    ds_read_b128 v[116:119], v201 offset:55296
    buffer_load_dwordx4 v3, s[4:7], s95 offen offset:1024 lds
    v_mfma_f32_16x16x32_bf16 v[64:67], v[148:151], a[80:83], v[64:67]
    ds_read_b128 v[120:123], v201 offset:56320
    v_mfma_f32_16x16x32_bf16 v[68:71], v[152:155], a[80:83], v[68:71]
    ds_read_b128 v[124:127], v201 offset:57344
    v_mfma_f32_16x16x32_bf16 v[72:75], v[128:131], a[160:163], v[72:75]
    v_mfma_f32_16x16x32_bf16 v[76:79], v[132:135], a[160:163], v[76:79]
    v_mfma_f32_16x16x32_bf16 v[80:83], v[136:139], a[160:163], v[80:83]
    buffer_load_dwordx4 v3, s[4:7], s95 offen offset:2048 lds
    v_mfma_f32_16x16x32_bf16 v[84:87], v[140:143], a[160:163], v[84:87]
    v_mfma_f32_16x16x32_bf16 v[88:91], v[144:147], a[160:163], v[88:91]
    v_mfma_f32_16x16x32_bf16 v[92:95], v[148:151], a[160:163], v[92:95]
    v_mfma_f32_16x16x32_bf16 v[96:99], v[152:155], a[160:163], v[96:99]
    s_waitcnt lgkmcnt(7)
    s_waitcnt vmcnt(21)
    s_waitcnt vmcnt(19)
    s_nop 0
    v_mfma_f32_16x16x32_bf16 v[44:47], v[156:159], a[84:87], v[44:47]
    ds_read_b128 v[128:131], v201 offset:58368
    buffer_load_dwordx4 v3, s[4:7], s95 offen offset:3072 lds
    v_mfma_f32_16x16x32_bf16 v[48:51], v[160:163], a[84:87], v[48:51]
    ds_read_b128 v[132:135], v201 offset:59392
    v_mfma_f32_16x16x32_bf16 v[52:55], v[164:167], a[84:87], v[52:55]
    ds_read_b128 v[136:139], v201 offset:60416
    v_mfma_f32_16x16x32_bf16 v[56:59], v[168:171], a[84:87], v[56:59]
    ds_read_b128 v[140:143], v202 offset:0
    s_add_u32 s94, s93, 32768
    s_mov_b32 m0, s94
    s_nop 0
    s_add_u32 s95, s92, 65536
    buffer_load_dwordx4 v3, s[4:7], s95 offen offset:0 lds
    v_mfma_f32_16x16x32_bf16 v[60:63], v[172:175], a[84:87], v[60:63]
    ds_read_b128 v[144:147], v202 offset:1024
    v_mfma_f32_16x16x32_bf16 v[64:67], v[176:179], a[84:87], v[64:67]
    ds_read_b128 v[148:151], v202 offset:2048
    v_mfma_f32_16x16x32_bf16 v[68:71], v[180:183], a[84:87], v[68:71]
    ds_read_b128 v[152:155], v202 offset:3072
    v_mfma_f32_16x16x32_bf16 v[72:75], v[156:159], a[164:167], v[72:75]
    buffer_load_dwordx4 v3, s[4:7], s95 offen offset:1024 lds
    v_mfma_f32_16x16x32_bf16 v[76:79], v[160:163], a[164:167], v[76:79]
    v_mfma_f32_16x16x32_bf16 v[80:83], v[164:167], a[164:167], v[80:83]
    v_mfma_f32_16x16x32_bf16 v[84:87], v[168:171], a[164:167], v[84:87]
    buffer_load_dwordx4 v3, s[4:7], s95 offen offset:2048 lds
    v_mfma_f32_16x16x32_bf16 v[88:91], v[172:175], a[164:167], v[88:91]
    v_mfma_f32_16x16x32_bf16 v[92:95], v[176:179], a[164:167], v[92:95]
    v_mfma_f32_16x16x32_bf16 v[96:99], v[180:183], a[164:167], v[96:99]
    s_waitcnt lgkmcnt(7)
    s_waitcnt vmcnt(22)
    s_waitcnt vmcnt(21)
    s_nop 0
    v_mfma_f32_16x16x32_bf16 v[44:47], v[100:103], a[88:91], v[44:47]
    buffer_load_dwordx4 v3, s[4:7], s95 offen offset:3072 lds
    v_mfma_f32_16x16x32_bf16 v[48:51], v[104:107], a[88:91], v[48:51]
    v_mfma_f32_16x16x32_bf16 v[52:55], v[108:111], a[88:91], v[52:55]
    v_mfma_f32_16x16x32_bf16 v[56:59], v[112:115], a[88:91], v[56:59]
    v_mfma_f32_16x16x32_bf16 v[60:63], v[116:119], a[88:91], v[60:63]
    s_add_u32 s94, s93, 49152
    s_mov_b32 m0, s94
    s_nop 0
    s_add_u32 s95, s92, 81920
    buffer_load_dwordx4 v3, s[4:7], s95 offen offset:0 lds
    v_mfma_f32_16x16x32_bf16 v[64:67], v[120:123], a[88:91], v[64:67]
    v_mfma_f32_16x16x32_bf16 v[68:71], v[124:127], a[88:91], v[68:71]
    v_mfma_f32_16x16x32_bf16 v[72:75], v[100:103], a[168:171], v[72:75]
    v_mfma_f32_16x16x32_bf16 v[76:79], v[104:107], a[168:171], v[76:79]
    v_mfma_f32_16x16x32_bf16 v[80:83], v[108:111], a[168:171], v[80:83]
    buffer_load_dwordx4 v3, s[4:7], s95 offen offset:1024 lds
    v_mfma_f32_16x16x32_bf16 v[84:87], v[112:115], a[168:171], v[84:87]
    v_mfma_f32_16x16x32_bf16 v[88:91], v[116:119], a[168:171], v[88:91]
    v_mfma_f32_16x16x32_bf16 v[92:95], v[120:123], a[168:171], v[92:95]
    v_mfma_f32_16x16x32_bf16 v[96:99], v[124:127], a[168:171], v[96:99]
    s_waitcnt lgkmcnt(0)
    s_waitcnt vmcnt(23)
    s_waitcnt vmcnt(22)
    s_nop 0
    v_mfma_f32_16x16x32_bf16 v[44:47], v[128:131], a[92:95], v[44:47]
    buffer_load_dwordx4 v3, s[4:7], s95 offen offset:2048 lds
    v_mfma_f32_16x16x32_bf16 v[48:51], v[132:135], a[92:95], v[48:51]
    v_mfma_f32_16x16x32_bf16 v[52:55], v[136:139], a[92:95], v[52:55]
    v_mfma_f32_16x16x32_bf16 v[56:59], v[140:143], a[92:95], v[56:59]
    buffer_load_dwordx4 v3, s[4:7], s95 offen offset:3072 lds
    v_mfma_f32_16x16x32_bf16 v[60:63], v[144:147], a[92:95], v[60:63]
    v_mfma_f32_16x16x32_bf16 v[64:67], v[148:151], a[92:95], v[64:67]
    v_mfma_f32_16x16x32_bf16 v[68:71], v[152:155], a[92:95], v[68:71]
    v_mfma_f32_16x16x32_bf16 v[72:75], v[128:131], a[172:175], v[72:75]
    s_add_u32 s94, s93, 65536
    s_mov_b32 m0, s94
    s_nop 0
    s_add_u32 s95, s92, 98304
    buffer_load_dwordx4 v3, s[4:7], s95 offen offset:0 lds
    v_mfma_f32_16x16x32_bf16 v[76:79], v[132:135], a[172:175], v[76:79]
    v_mfma_f32_16x16x32_bf16 v[80:83], v[136:139], a[172:175], v[80:83]
    v_mfma_f32_16x16x32_bf16 v[84:87], v[140:143], a[172:175], v[84:87]
    buffer_load_dwordx4 v3, s[4:7], s95 offen offset:1024 lds
    v_mfma_f32_16x16x32_bf16 v[88:91], v[144:147], a[172:175], v[88:91]
    v_mfma_f32_16x16x32_bf16 v[92:95], v[148:151], a[172:175], v[92:95]
    v_mfma_f32_16x16x32_bf16 v[96:99], v[152:155], a[172:175], v[96:99]
    s_barrier
    s_nop 0
    s_mov_b32 s70, 0xbdd2d3e8
    s_mov_b32 s71, 0xbdd2d3e8
    v_mov_b32 v212, 0xc0135761
    v_mov_b32 v213, 0xc0135761
    v_mov_b32 v214, 1.0
    v_mov_b32 v215, 1.0
    v_pk_mul_f32 v[204:205], v[44:45], v[44:45]
    v_pk_mul_f32 v[206:207], v[46:47], v[46:47]
    v_pk_fma_f32 v[204:205], v[204:205], s[70:71], v[212:213]
    v_pk_fma_f32 v[206:207], v[206:207], s[70:71], v[212:213]
    v_pk_mul_f32 v[204:205], v[204:205], v[44:45]
    v_pk_mul_f32 v[206:207], v[206:207], v[46:47]
    v_exp_f32 v204, v204
    v_exp_f32 v205, v205
    v_exp_f32 v206, v206
    v_exp_f32 v207, v207
    v_pk_add_f32 v[204:205], v[204:205], v[214:215]
    v_pk_add_f32 v[206:207], v[206:207], v[214:215]
    v_rcp_f32 v204, v204
    v_rcp_f32 v205, v205
    v_rcp_f32 v206, v206
    v_rcp_f32 v207, v207
    v_pk_mul_f32 v[44:45], v[44:45], v[204:205]
    v_pk_mul_f32 v[46:47], v[46:47], v[206:207]
    buffer_load_dwordx4 v3, s[4:7], s95 offen offset:2048 lds
    buffer_load_dwordx4 v3, s[4:7], s95 offen offset:3072 lds
    v_pk_mul_f32 v[204:205], v[48:49], v[48:49]
    v_pk_mul_f32 v[206:207], v[50:51], v[50:51]
    v_pk_fma_f32 v[204:205], v[204:205], s[70:71], v[212:213]
    v_pk_fma_f32 v[206:207], v[206:207], s[70:71], v[212:213]
    v_pk_mul_f32 v[204:205], v[204:205], v[48:49]
    v_pk_mul_f32 v[206:207], v[206:207], v[50:51]
    v_exp_f32 v204, v204
    v_exp_f32 v205, v205
    v_exp_f32 v206, v206
    v_exp_f32 v207, v207
    v_pk_add_f32 v[204:205], v[204:205], v[214:215]
    v_pk_add_f32 v[206:207], v[206:207], v[214:215]
    v_rcp_f32 v204, v204
    v_rcp_f32 v205, v205
    v_rcp_f32 v206, v206
    v_rcp_f32 v207, v207
    v_pk_mul_f32 v[48:49], v[48:49], v[204:205]
    v_pk_mul_f32 v[50:51], v[50:51], v[206:207]
    s_add_u32 s94, s93, 81920
    s_mov_b32 m0, s94
    s_nop 0
    s_add_u32 s95, s92, 114688
    buffer_load_dwordx4 v3, s[4:7], s95 offen offset:0 lds
    buffer_load_dwordx4 v3, s[4:7], s95 offen offset:1024 lds
    v_pk_mul_f32 v[204:205], v[52:53], v[52:53]
    v_pk_mul_f32 v[206:207], v[54:55], v[54:55]
    v_pk_fma_f32 v[204:205], v[204:205], s[70:71], v[212:213]
    v_pk_fma_f32 v[206:207], v[206:207], s[70:71], v[212:213]
    v_pk_mul_f32 v[204:205], v[204:205], v[52:53]
    v_pk_mul_f32 v[206:207], v[206:207], v[54:55]
    v_exp_f32 v204, v204
    v_exp_f32 v205, v205
    v_exp_f32 v206, v206
    v_exp_f32 v207, v207
    v_pk_add_f32 v[204:205], v[204:205], v[214:215]
    v_pk_add_f32 v[206:207], v[206:207], v[214:215]
    v_rcp_f32 v204, v204
    v_rcp_f32 v205, v205
    v_rcp_f32 v206, v206
    v_rcp_f32 v207, v207
    v_pk_mul_f32 v[52:53], v[52:53], v[204:205]
    v_pk_mul_f32 v[54:55], v[54:55], v[206:207]
    buffer_load_dwordx4 v3, s[4:7], s95 offen offset:2048 lds
    buffer_load_dwordx4 v3, s[4:7], s95 offen offset:3072 lds
    v_pk_mul_f32 v[204:205], v[56:57], v[56:57]
    v_pk_mul_f32 v[206:207], v[58:59], v[58:59]
    v_pk_fma_f32 v[204:205], v[204:205], s[70:71], v[212:213]
    v_pk_fma_f32 v[206:207], v[206:207], s[70:71], v[212:213]
    v_pk_mul_f32 v[204:205], v[204:205], v[56:57]
    v_pk_mul_f32 v[206:207], v[206:207], v[58:59]
    v_exp_f32 v204, v204
    v_exp_f32 v205, v205
    v_exp_f32 v206, v206
    v_exp_f32 v207, v207
    v_pk_add_f32 v[204:205], v[204:205], v[214:215]
    v_pk_add_f32 v[206:207], v[206:207], v[214:215]
    v_rcp_f32 v204, v204
    v_rcp_f32 v205, v205
    v_rcp_f32 v206, v206
    v_rcp_f32 v207, v207
    v_pk_mul_f32 v[56:57], v[56:57], v[204:205]
    v_pk_mul_f32 v[58:59], v[58:59], v[206:207]
    s_add_u32 s94, s93, 98304
    s_mov_b32 m0, s94
    s_nop 0
    s_add_u32 s95, s92, 131072
    buffer_load_dwordx4 v3, s[4:7], s95 offen offset:0 lds
    buffer_load_dwordx4 v3, s[4:7], s95 offen offset:1024 lds
    v_pk_mul_f32 v[204:205], v[60:61], v[60:61]
    v_pk_mul_f32 v[206:207], v[62:63], v[62:63]
    v_pk_fma_f32 v[204:205], v[204:205], s[70:71], v[212:213]
    v_pk_fma_f32 v[206:207], v[206:207], s[70:71], v[212:213]
    v_pk_mul_f32 v[204:205], v[204:205], v[60:61]
    v_pk_mul_f32 v[206:207], v[206:207], v[62:63]
    v_exp_f32 v204, v204
    v_exp_f32 v205, v205
    v_exp_f32 v206, v206
    v_exp_f32 v207, v207
    v_pk_add_f32 v[204:205], v[204:205], v[214:215]
    v_pk_add_f32 v[206:207], v[206:207], v[214:215]
    v_rcp_f32 v204, v204
    v_rcp_f32 v205, v205
    v_rcp_f32 v206, v206
    v_rcp_f32 v207, v207
    v_pk_mul_f32 v[60:61], v[60:61], v[204:205]
    v_pk_mul_f32 v[62:63], v[62:63], v[206:207]
    buffer_load_dwordx4 v3, s[4:7], s95 offen offset:2048 lds
    buffer_load_dwordx4 v3, s[4:7], s95 offen offset:3072 lds
    v_pk_mul_f32 v[204:205], v[64:65], v[64:65]
    v_pk_mul_f32 v[206:207], v[66:67], v[66:67]
    v_pk_fma_f32 v[204:205], v[204:205], s[70:71], v[212:213]
    v_pk_fma_f32 v[206:207], v[206:207], s[70:71], v[212:213]
    v_pk_mul_f32 v[204:205], v[204:205], v[64:65]
    v_pk_mul_f32 v[206:207], v[206:207], v[66:67]
    v_exp_f32 v204, v204
    v_exp_f32 v205, v205
    v_exp_f32 v206, v206
    v_exp_f32 v207, v207
    v_pk_add_f32 v[204:205], v[204:205], v[214:215]
    v_pk_add_f32 v[206:207], v[206:207], v[214:215]
    v_rcp_f32 v204, v204
    v_rcp_f32 v205, v205
    v_rcp_f32 v206, v206
    v_rcp_f32 v207, v207
    v_pk_mul_f32 v[64:65], v[64:65], v[204:205]
    v_pk_mul_f32 v[66:67], v[66:67], v[206:207]
    s_add_u32 s94, s93, 114688
    s_mov_b32 m0, s94
    s_nop 0
    s_add_u32 s95, s92, 147456
    buffer_load_dwordx4 v3, s[4:7], s95 offen offset:0 lds
    buffer_load_dwordx4 v3, s[4:7], s95 offen offset:1024 lds
    v_pk_mul_f32 v[204:205], v[68:69], v[68:69]
    v_pk_mul_f32 v[206:207], v[70:71], v[70:71]
    v_pk_fma_f32 v[204:205], v[204:205], s[70:71], v[212:213]
    v_pk_fma_f32 v[206:207], v[206:207], s[70:71], v[212:213]
    v_pk_mul_f32 v[204:205], v[204:205], v[68:69]
    v_pk_mul_f32 v[206:207], v[206:207], v[70:71]
    v_exp_f32 v204, v204
    v_exp_f32 v205, v205
    v_exp_f32 v206, v206
    v_exp_f32 v207, v207
    v_pk_add_f32 v[204:205], v[204:205], v[214:215]
    v_pk_add_f32 v[206:207], v[206:207], v[214:215]
    v_rcp_f32 v204, v204
    v_rcp_f32 v205, v205
    v_rcp_f32 v206, v206
    v_rcp_f32 v207, v207
    v_pk_mul_f32 v[68:69], v[68:69], v[204:205]
    v_pk_mul_f32 v[70:71], v[70:71], v[206:207]
    buffer_load_dwordx4 v3, s[4:7], s95 offen offset:2048 lds
    buffer_load_dwordx4 v3, s[4:7], s95 offen offset:3072 lds
    v_pk_mul_f32 v[204:205], v[72:73], v[72:73]
    v_pk_mul_f32 v[206:207], v[74:75], v[74:75]
    v_pk_fma_f32 v[204:205], v[204:205], s[70:71], v[212:213]
    v_pk_fma_f32 v[206:207], v[206:207], s[70:71], v[212:213]
    v_pk_mul_f32 v[204:205], v[204:205], v[72:73]
    v_pk_mul_f32 v[206:207], v[206:207], v[74:75]
    v_exp_f32 v204, v204
    v_exp_f32 v205, v205
    v_exp_f32 v206, v206
    v_exp_f32 v207, v207
    v_pk_add_f32 v[204:205], v[204:205], v[214:215]
    v_pk_add_f32 v[206:207], v[206:207], v[214:215]
    v_rcp_f32 v204, v204
    v_rcp_f32 v205, v205
    v_rcp_f32 v206, v206
    v_rcp_f32 v207, v207
    v_pk_mul_f32 v[72:73], v[72:73], v[204:205]
    v_pk_mul_f32 v[74:75], v[74:75], v[206:207]
    v_pk_mul_f32 v[204:205], v[76:77], v[76:77]
    v_pk_mul_f32 v[206:207], v[78:79], v[78:79]
    v_pk_fma_f32 v[204:205], v[204:205], s[70:71], v[212:213]
    v_pk_fma_f32 v[206:207], v[206:207], s[70:71], v[212:213]
    v_pk_mul_f32 v[204:205], v[204:205], v[76:77]
    v_pk_mul_f32 v[206:207], v[206:207], v[78:79]
    v_exp_f32 v204, v204
    v_exp_f32 v205, v205
    v_exp_f32 v206, v206
    v_exp_f32 v207, v207
    v_pk_add_f32 v[204:205], v[204:205], v[214:215]
    v_pk_add_f32 v[206:207], v[206:207], v[214:215]
    v_rcp_f32 v204, v204
    v_rcp_f32 v205, v205
    v_rcp_f32 v206, v206
    v_rcp_f32 v207, v207
    v_pk_mul_f32 v[76:77], v[76:77], v[204:205]
    v_pk_mul_f32 v[78:79], v[78:79], v[206:207]
    v_pk_mul_f32 v[204:205], v[80:81], v[80:81]
    v_pk_mul_f32 v[206:207], v[82:83], v[82:83]
    v_pk_fma_f32 v[204:205], v[204:205], s[70:71], v[212:213]
    v_pk_fma_f32 v[206:207], v[206:207], s[70:71], v[212:213]
    v_pk_mul_f32 v[204:205], v[204:205], v[80:81]
    v_pk_mul_f32 v[206:207], v[206:207], v[82:83]
    v_exp_f32 v204, v204
    v_exp_f32 v205, v205
    v_exp_f32 v206, v206
    v_exp_f32 v207, v207
    v_pk_add_f32 v[204:205], v[204:205], v[214:215]
    v_pk_add_f32 v[206:207], v[206:207], v[214:215]
    v_rcp_f32 v204, v204
    v_rcp_f32 v205, v205
    v_rcp_f32 v206, v206
    v_rcp_f32 v207, v207
    v_pk_mul_f32 v[80:81], v[80:81], v[204:205]
    v_pk_mul_f32 v[82:83], v[82:83], v[206:207]
    v_pk_mul_f32 v[204:205], v[84:85], v[84:85]
    v_pk_mul_f32 v[206:207], v[86:87], v[86:87]
    v_pk_fma_f32 v[204:205], v[204:205], s[70:71], v[212:213]
    v_pk_fma_f32 v[206:207], v[206:207], s[70:71], v[212:213]
    v_pk_mul_f32 v[204:205], v[204:205], v[84:85]
    v_pk_mul_f32 v[206:207], v[206:207], v[86:87]
    v_exp_f32 v204, v204
    v_exp_f32 v205, v205
    v_exp_f32 v206, v206
    v_exp_f32 v207, v207
    v_pk_add_f32 v[204:205], v[204:205], v[214:215]
    v_pk_add_f32 v[206:207], v[206:207], v[214:215]
    v_rcp_f32 v204, v204
    v_rcp_f32 v205, v205
    v_rcp_f32 v206, v206
    v_rcp_f32 v207, v207
    v_pk_mul_f32 v[84:85], v[84:85], v[204:205]
    v_pk_mul_f32 v[86:87], v[86:87], v[206:207]
    v_pk_mul_f32 v[204:205], v[88:89], v[88:89]
    v_pk_mul_f32 v[206:207], v[90:91], v[90:91]
    v_pk_fma_f32 v[204:205], v[204:205], s[70:71], v[212:213]
    v_pk_fma_f32 v[206:207], v[206:207], s[70:71], v[212:213]
    v_pk_mul_f32 v[204:205], v[204:205], v[88:89]
    v_pk_mul_f32 v[206:207], v[206:207], v[90:91]
    v_exp_f32 v204, v204
    v_exp_f32 v205, v205
    v_exp_f32 v206, v206
    v_exp_f32 v207, v207
    v_pk_add_f32 v[204:205], v[204:205], v[214:215]
    v_pk_add_f32 v[206:207], v[206:207], v[214:215]
    v_rcp_f32 v204, v204
    v_rcp_f32 v205, v205
    v_rcp_f32 v206, v206
    v_rcp_f32 v207, v207
    v_pk_mul_f32 v[88:89], v[88:89], v[204:205]
    v_pk_mul_f32 v[90:91], v[90:91], v[206:207]
    v_pk_mul_f32 v[204:205], v[92:93], v[92:93]
    v_pk_mul_f32 v[206:207], v[94:95], v[94:95]
    v_pk_fma_f32 v[204:205], v[204:205], s[70:71], v[212:213]
    v_pk_fma_f32 v[206:207], v[206:207], s[70:71], v[212:213]
    v_pk_mul_f32 v[204:205], v[204:205], v[92:93]
    v_pk_mul_f32 v[206:207], v[206:207], v[94:95]
    v_exp_f32 v204, v204
    v_exp_f32 v205, v205
    v_exp_f32 v206, v206
    v_exp_f32 v207, v207
    v_pk_add_f32 v[204:205], v[204:205], v[214:215]
    v_pk_add_f32 v[206:207], v[206:207], v[214:215]
    v_rcp_f32 v204, v204
    v_rcp_f32 v205, v205
    v_rcp_f32 v206, v206
    v_rcp_f32 v207, v207
    v_pk_mul_f32 v[92:93], v[92:93], v[204:205]
    v_pk_mul_f32 v[94:95], v[94:95], v[206:207]
    v_pk_mul_f32 v[204:205], v[96:97], v[96:97]
    v_pk_mul_f32 v[206:207], v[98:99], v[98:99]
    v_pk_fma_f32 v[204:205], v[204:205], s[70:71], v[212:213]
    v_pk_fma_f32 v[206:207], v[206:207], s[70:71], v[212:213]
    v_pk_mul_f32 v[204:205], v[204:205], v[96:97]
    v_pk_mul_f32 v[206:207], v[206:207], v[98:99]
    v_exp_f32 v204, v204
    v_exp_f32 v205, v205
    v_exp_f32 v206, v206
    v_exp_f32 v207, v207
    v_pk_add_f32 v[204:205], v[204:205], v[214:215]
    v_pk_add_f32 v[206:207], v[206:207], v[214:215]
    v_rcp_f32 v204, v204
    v_rcp_f32 v205, v205
    v_rcp_f32 v206, v206
    v_rcp_f32 v207, v207
    v_pk_mul_f32 v[96:97], v[96:97], v[204:205]
    v_pk_mul_f32 v[98:99], v[98:99], v[206:207]
    v_cvt_pk_bf16_f32 v44, v44, v45
    v_cvt_pk_bf16_f32 v45, v46, v47
    v_cvt_pk_bf16_f32 v46, v48, v49
    v_cvt_pk_bf16_f32 v47, v50, v51
    v_cvt_pk_bf16_f32 v48, v52, v53
    v_cvt_pk_bf16_f32 v49, v54, v55
    v_cvt_pk_bf16_f32 v50, v56, v57
    v_cvt_pk_bf16_f32 v51, v58, v59
    v_cvt_pk_bf16_f32 v52, v60, v61
    v_cvt_pk_bf16_f32 v53, v62, v63
    v_cvt_pk_bf16_f32 v54, v64, v65
    v_cvt_pk_bf16_f32 v55, v66, v67
    v_cvt_pk_bf16_f32 v56, v68, v69
    v_cvt_pk_bf16_f32 v57, v70, v71
    v_cvt_pk_bf16_f32 v72, v72, v73
    v_cvt_pk_bf16_f32 v73, v74, v75
    v_cvt_pk_bf16_f32 v74, v76, v77
    v_cvt_pk_bf16_f32 v75, v78, v79
    v_cvt_pk_bf16_f32 v76, v80, v81
    v_cvt_pk_bf16_f32 v77, v82, v83
    v_cvt_pk_bf16_f32 v78, v84, v85
    v_cvt_pk_bf16_f32 v79, v86, v87
    v_cvt_pk_bf16_f32 v80, v88, v89
    v_cvt_pk_bf16_f32 v81, v90, v91
    v_cvt_pk_bf16_f32 v82, v92, v93
    v_cvt_pk_bf16_f32 v83, v94, v95
    v_cvt_pk_bf16_f32 v84, v96, v97
    v_cvt_pk_bf16_f32 v85, v98, v99
    s_mul_i32 s66, s77, 55296
    s_add_u32 s66, s66, 12582912
    s_lshr_b32 s67, s73, 1
    s_lshl_b32 s67, s67, 10
    s_add_u32 s67, s67, s66
    s_bitcmp1_b32 s73, 0
    s_cbranch_scc1 L_so_137
    s_nop 0
    buffer_store_dwordx4 v[44:47], v3, s[4:7], s67 offen offset:0 sc1
    buffer_store_dwordx4 v[48:51], v3, s[4:7], s67 offen offset:1024 sc1
    buffer_store_dwordx4 v[52:55], v3, s[4:7], s67 offen offset:2048 sc1
    s_cmp_lg_u32 s74, 0
    s_cbranch_scc1 L_sk_139
    buffer_store_dwordx2 v[56:57], v203, s[4:7], s67 offen offset:3072 sc1
L_sk_139:
    s_branch L_sj_138
L_so_137:
    s_nop 0
    buffer_store_dwordx2 v[44:45], v203, s[4:7], s67 offen offset:512 sc1
    buffer_store_dwordx4 v[46:49], v3, s[4:7], s67 offen offset:1024 sc1
    buffer_store_dwordx4 v[50:53], v3, s[4:7], s67 offen offset:2048 sc1
    buffer_store_dwordx4 v[54:57], v3, s[4:7], s67 offen offset:3072 sc1
L_sj_138:
    s_add_u32 s66, s66, 55296
    s_lshr_b32 s67, s73, 1
    s_lshl_b32 s67, s67, 10
    s_add_u32 s67, s67, s66
    s_bitcmp1_b32 s73, 0
    s_cbranch_scc1 L_so_140
    s_nop 0
    buffer_store_dwordx4 v[72:75], v3, s[4:7], s67 offen offset:0 sc1
    buffer_store_dwordx4 v[76:79], v3, s[4:7], s67 offen offset:1024 sc1
    buffer_store_dwordx4 v[80:83], v3, s[4:7], s67 offen offset:2048 sc1
    s_cmp_lg_u32 s74, 0
    s_cbranch_scc1 L_sk_142
    buffer_store_dwordx2 v[84:85], v203, s[4:7], s67 offen offset:3072 sc1
L_sk_142:
    s_branch L_sj_141
L_so_140:
    s_nop 0
    buffer_store_dwordx2 v[72:73], v203, s[4:7], s67 offen offset:512 sc1
    buffer_store_dwordx4 v[74:77], v3, s[4:7], s67 offen offset:1024 sc1
    buffer_store_dwordx4 v[78:81], v3, s[4:7], s67 offen offset:2048 sc1
    buffer_store_dwordx4 v[82:85], v3, s[4:7], s67 offen offset:3072 sc1
L_sj_141:
    v_mov_b32 v254, s20
    v_mov_b32_e64 v255, s21
    s_lshl_b32 s62, s27, 7
    s_lshl_b32 s63, s23, 3
    s_add_u32 s62, s62, s63
    s_add_u32 s62, s62, 27136000
    v_mov_b32_e64 v253, s62
    s_mov_b32 s63, 131072
    s_waitcnt vmcnt(0)
    s_mov_b64 exec, 1
    s_cmp_eq_u32 s3, 0
    s_cbranch_scc1 L_sl_143
    buffer_store_dwordx2 v[254:255], v253, s[4:7], s63 offen
    s_branch L_sj_144
L_sl_143:
    buffer_store_dwordx2 v[254:255], v253, s[4:7], 0 offen sc1
L_sj_144:
    s_mov_b64 exec, -1
    s_and_b32 s75, s27, 7
    s_lshr_b32 s75, s75, 1
    s_and_b32 s76, s24, 30
    s_lshl_b32 s76, s76, 2
    s_add_u32 s75, s75, s76
    s_add_u32 s76, s75, 4
    s_barrier
    v_mov_b32 v251, s75
    v_lshrrev_b32 v250, 3, v0
    v_and_b32 v250, 3, v250
    v_cmp_eq_u32 vcc, 1, v250
    v_mov_b32 v252, s76
    s_nop 0
    v_cndmask_b32 v251, v251, v252, vcc
    v_lshrrev_b32_e64 v250, 4, v251
    s_lshr_b32 s62, s24, 2
    v_cmp_eq_u32 vcc, s62, v250
    s_mul_i32 s62, s3, 131072
    v_mov_b32 v252, s62
    v_cndmask_b32 v250, 0, v252, vcc
    v_lshl_add_u32 v251, v251, 7, v250
    v_and_b32_e64 v252, 7, v0
    v_lshl_add_u32 v251, v252, 3, v251
    s_mov_b32 s63, 27136000
    s_mov_b32 s62, 400000
    buffer_load_dwordx2 v[254:255], v251, s[4:7], s63 offen sc1
    s_waitcnt vmcnt(0)
    v_cmp_ne_u32 vcc, s20, v254
    s_mov_b64 s[64:65], vcc
    v_cmp_ne_u32 vcc, s21, v255
    s_or_b64 s[64:65], s[64:65], vcc
    s_cmp_eq_u64 s[64:65], 0
    s_cbranch_scc1 L_wfok_146
    buffer_load_dwordx2 v[254:255], v251, s[4:7], s63 offen sc1
L_wfp_145:
    s_sleep 2
    buffer_load_dwordx2 v[252:253], v251, s[4:7], s63 offen sc1
    s_waitcnt vmcnt(1)
    v_cmp_ne_u32 vcc, s20, v254
    s_mov_b64 s[64:65], vcc
    v_cmp_ne_u32 vcc, s21, v255
    s_or_b64 s[64:65], s[64:65], vcc
    s_cmp_eq_u64 s[64:65], 0
    s_cbranch_scc1 L_wfo2_147
    s_sleep 2
    buffer_load_dwordx2 v[254:255], v251, s[4:7], s63 offen sc1
    s_waitcnt vmcnt(1)
    v_cmp_ne_u32 vcc, s20, v252
    s_mov_b64 s[64:65], vcc
    v_cmp_ne_u32 vcc, s21, v253
    s_or_b64 s[64:65], s[64:65], vcc
    s_cmp_eq_u64 s[64:65], 0
    s_cbranch_scc1 L_wfo2_147
    s_sub_u32 s62, s62, 1
    s_cmp_lg_u32 s62, 0
    s_cbranch_scc1 L_wfp_145
    s_mov_b32 s28, 13
    s_branch L_fail
L_wfo2_147:
L_wfok_146:
    s_mul_i32 s30, s27, 55296
    s_add_u32 s30, s30, 12582912
    s_add_u32 s88, s30, 0
    s_nop 0
    buffer_load_dwordx4 a[16:19], v3, s[4:7], s88 offen offset:0 sc1
    buffer_load_dwordx4 a[20:23], v3, s[4:7], s88 offen offset:1024 sc1
    buffer_load_dwordx4 a[24:27], v3, s[4:7], s88 offen offset:2048 sc1
    buffer_load_dwordx2 a[28:29], v203, s[4:7], s88 offen offset:3072 sc1
    buffer_load_dwordx2 a[30:31], v203, s[4:7], s88 offen offset:3584 sc1
    s_add_u32 s88, s30, 4096
    buffer_load_dwordx4 a[32:35], v3, s[4:7], s88 offen offset:0 sc1
    buffer_load_dwordx4 a[36:39], v3, s[4:7], s88 offen offset:1024 sc1
    buffer_load_dwordx4 a[40:43], v3, s[4:7], s88 offen offset:2048 sc1
    buffer_load_dwordx4 a[44:47], v3, s[4:7], s88 offen offset:3072 sc1
    s_add_u32 s88, s30, 8192
    buffer_load_dwordx4 a[48:51], v3, s[4:7], s88 offen offset:0 sc1
    buffer_load_dwordx4 a[52:55], v3, s[4:7], s88 offen offset:1024 sc1
    ds_read_b128 v[100:103], v202 offset:8192
    ds_read_b128 v[104:107], v202 offset:9216
    ds_read_b128 v[108:111], v202 offset:10240
    ds_read_b128 v[112:115], v202 offset:11264
    ds_read_b128 v[116:119], v202 offset:12288
    ds_read_b128 v[120:123], v202 offset:13312
    ds_read_b128 v[124:127], v202 offset:14336
    ds_read_b128 v[128:131], v202 offset:15360
    ds_read_b128 v[132:135], v202 offset:16384
    ds_read_b128 v[136:139], v202 offset:17408
    s_waitcnt lgkmcnt(5)
    s_waitcnt vmcnt(10)
    v_mfma_f32_16x16x32_bf16 v[44:47], v[100:103], a[16:19], 0
    ds_read_b128 v[140:143], v202 offset:18432
    buffer_load_dwordx2 a[56:57], v203, s[4:7], s88 offen offset:2048 sc1
    buffer_load_dwordx2 a[58:59], v203, s[4:7], s88 offen offset:2560 sc1
    v_mfma_f32_16x16x32_bf16 v[48:51], v[104:107], a[16:19], 0
    ds_read_b128 v[144:147], v202 offset:19456
    v_mfma_f32_16x16x32_bf16 v[52:55], v[108:111], a[16:19], 0
    ds_read_b128 v[148:151], v202 offset:20480
    v_mfma_f32_16x16x32_bf16 v[56:59], v[112:115], a[16:19], 0
    ds_read_b128 v[152:155], v202 offset:21504
    v_mfma_f32_16x16x32_bf16 v[60:63], v[116:119], a[16:19], 0
    ds_read_b128 v[156:159], v202 offset:22528
    s_waitcnt lgkmcnt(5)
    s_waitcnt vmcnt(11)
    v_mfma_f32_16x16x32_bf16 v[44:47], v[120:123], a[20:23], v[44:47]
    ds_read_b128 v[100:103], v202 offset:23552
    buffer_load_dwordx4 a[60:63], v3, s[4:7], s88 offen offset:3072 sc1
    v_mfma_f32_16x16x32_bf16 v[48:51], v[124:127], a[20:23], v[48:51]
    ds_read_b128 v[104:107], v202 offset:24576
    v_mfma_f32_16x16x32_bf16 v[52:55], v[128:131], a[20:23], v[52:55]
    ds_read_b128 v[108:111], v202 offset:25600
    s_add_u32 s88, s30, 12288
    buffer_load_dwordx4 a[64:67], v3, s[4:7], s88 offen offset:0 sc1
    v_mfma_f32_16x16x32_bf16 v[56:59], v[132:135], a[20:23], v[56:59]
    ds_read_b128 v[112:115], v202 offset:26624
    v_mfma_f32_16x16x32_bf16 v[60:63], v[136:139], a[20:23], v[60:63]
    ds_read_b128 v[116:119], v202 offset:27648
    s_barrier
    s_waitcnt lgkmcnt(5)
    s_waitcnt vmcnt(12)
    s_nop 0
    v_mfma_f32_16x16x32_bf16 v[44:47], v[140:143], a[24:27], v[44:47]
    ds_read_b128 v[120:123], v202 offset:28672
    buffer_load_dwordx4 a[68:71], v3, s[4:7], s88 offen offset:1024 sc1
    v_mfma_f32_16x16x32_bf16 v[48:51], v[144:147], a[24:27], v[48:51]
    ds_read_b128 v[124:127], v202 offset:29696
    v_mfma_f32_16x16x32_bf16 v[52:55], v[148:151], a[24:27], v[52:55]
    ds_read_b128 v[128:131], v202 offset:30720
    v_mfma_f32_16x16x32_bf16 v[56:59], v[152:155], a[24:27], v[56:59]
    ds_read_b128 v[132:135], v202 offset:31744
    v_mfma_f32_16x16x32_bf16 v[60:63], v[156:159], a[24:27], v[60:63]
    ds_read_b128 v[136:139], v202 offset:32768
    s_waitcnt lgkmcnt(5)
    s_waitcnt vmcnt(11)
    v_mfma_f32_16x16x32_bf16 v[44:47], v[100:103], a[28:31], v[44:47]
    ds_read_b128 v[140:143], v202 offset:33792
    buffer_load_dwordx4 a[72:75], v3, s[4:7], s88 offen offset:2048 sc1
    v_mfma_f32_16x16x32_bf16 v[48:51], v[104:107], a[28:31], v[48:51]
    ds_read_b128 v[144:147], v202 offset:34816
    v_mfma_f32_16x16x32_bf16 v[52:55], v[108:111], a[28:31], v[52:55]
    ds_read_b128 v[148:151], v202 offset:35840
    buffer_load_dwordx4 a[76:79], v3, s[4:7], s88 offen offset:3072 sc1
    v_mfma_f32_16x16x32_bf16 v[56:59], v[112:115], a[28:31], v[56:59]
    ds_read_b128 v[152:155], v202 offset:36864
    v_mfma_f32_16x16x32_bf16 v[60:63], v[116:119], a[28:31], v[60:63]
    ds_read_b128 v[156:159], v202 offset:37888
    s_waitcnt lgkmcnt(5)
    s_waitcnt vmcnt(12)
    v_mfma_f32_16x16x32_bf16 v[44:47], v[120:123], a[32:35], v[44:47]
    ds_read_b128 v[100:103], v202 offset:38912
    s_add_u32 s88, s30, 16384
    buffer_load_dwordx4 a[80:83], v3, s[4:7], s88 offen offset:0 sc1
    v_mfma_f32_16x16x32_bf16 v[48:51], v[124:127], a[32:35], v[48:51]
    ds_read_b128 v[104:107], v202 offset:39936
    v_mfma_f32_16x16x32_bf16 v[52:55], v[128:131], a[32:35], v[52:55]
    ds_read_b128 v[108:111], v200 offset:0
    buffer_load_dwordx2 a[84:85], v203, s[4:7], s88 offen offset:1024 sc1
    buffer_load_dwordx2 a[86:87], v203, s[4:7], s88 offen offset:1536 sc1
    v_mfma_f32_16x16x32_bf16 v[56:59], v[132:135], a[32:35], v[56:59]
    ds_read_b128 v[112:115], v200 offset:1024
    v_mfma_f32_16x16x32_bf16 v[60:63], v[136:139], a[32:35], v[60:63]
    ds_read_b128 v[116:119], v200 offset:2048
    s_waitcnt lgkmcnt(5)
    s_waitcnt vmcnt(14)
    v_mfma_f32_16x16x32_bf16 v[44:47], v[140:143], a[36:39], v[44:47]
    ds_read_b128 v[120:123], v200 offset:3072
    buffer_load_dwordx4 a[88:91], v3, s[4:7], s88 offen offset:2048 sc1
    v_mfma_f32_16x16x32_bf16 v[48:51], v[144:147], a[36:39], v[48:51]
    ds_read_b128 v[124:127], v200 offset:4096
    v_mfma_f32_16x16x32_bf16 v[52:55], v[148:151], a[36:39], v[52:55]
    ds_read_b128 v[128:131], v200 offset:5120
    v_mfma_f32_16x16x32_bf16 v[56:59], v[152:155], a[36:39], v[56:59]
    ds_read_b128 v[132:135], v200 offset:6144
    v_mfma_f32_16x16x32_bf16 v[60:63], v[156:159], a[36:39], v[60:63]
    ds_read_b128 v[136:139], v200 offset:7168
    s_barrier
    s_waitcnt lgkmcnt(5)
    s_waitcnt vmcnt(14)
    s_nop 0
    v_mfma_f32_16x16x32_bf16 v[44:47], v[100:103], a[40:43], v[44:47]
    ds_read_b128 v[140:143], v200 offset:8192
    buffer_load_dwordx4 a[92:95], v3, s[4:7], s88 offen offset:3072 sc1
    v_mfma_f32_16x16x32_bf16 v[48:51], v[104:107], a[40:43], v[48:51]
    ds_read_b128 v[144:147], v200 offset:9216
    v_mfma_f32_16x16x32_bf16 v[52:55], v[108:111], a[40:43], v[52:55]
    ds_read_b128 v[148:151], v200 offset:10240
    s_add_u32 s88, s30, 20480
    buffer_load_dwordx4 a[96:99], v3, s[4:7], s88 offen offset:0 sc1
    v_mfma_f32_16x16x32_bf16 v[56:59], v[112:115], a[40:43], v[56:59]
    ds_read_b128 v[152:155], v200 offset:11264
    v_mfma_f32_16x16x32_bf16 v[60:63], v[116:119], a[40:43], v[60:63]
    ds_read_b128 v[156:159], v200 offset:12288
    s_waitcnt lgkmcnt(5)
    s_waitcnt vmcnt(15)
    v_mfma_f32_16x16x32_bf16 v[44:47], v[120:123], a[44:47], v[44:47]
    ds_read_b128 v[100:103], v200 offset:13312
    buffer_load_dwordx4 a[100:103], v3, s[4:7], s88 offen offset:1024 sc1
    v_mfma_f32_16x16x32_bf16 v[48:51], v[124:127], a[44:47], v[48:51]
    ds_read_b128 v[104:107], v200 offset:14336
    v_mfma_f32_16x16x32_bf16 v[52:55], v[128:131], a[44:47], v[52:55]
    ds_read_b128 v[108:111], v200 offset:15360
    v_mfma_f32_16x16x32_bf16 v[56:59], v[132:135], a[44:47], v[56:59]
    ds_read_b128 v[112:115], v200 offset:16384
    v_mfma_f32_16x16x32_bf16 v[60:63], v[136:139], a[44:47], v[60:63]
    ds_read_b128 v[116:119], v200 offset:17408
    s_waitcnt lgkmcnt(5)
    s_waitcnt vmcnt(15)
    v_mfma_f32_16x16x32_bf16 v[44:47], v[140:143], a[48:51], v[44:47]
    ds_read_b128 v[120:123], v200 offset:18432
    buffer_load_dwordx4 a[104:107], v3, s[4:7], s88 offen offset:2048 sc1
    v_mfma_f32_16x16x32_bf16 v[48:51], v[144:147], a[48:51], v[48:51]
    ds_read_b128 v[124:127], v200 offset:19456
    v_mfma_f32_16x16x32_bf16 v[52:55], v[148:151], a[48:51], v[52:55]
    ds_read_b128 v[128:131], v200 offset:20480
    buffer_load_dwordx4 a[108:111], v3, s[4:7], s88 offen offset:3072 sc1
    v_mfma_f32_16x16x32_bf16 v[56:59], v[152:155], a[48:51], v[56:59]
    ds_read_b128 v[132:135], v200 offset:21504
    v_mfma_f32_16x16x32_bf16 v[60:63], v[156:159], a[48:51], v[60:63]
    ds_read_b128 v[136:139], v200 offset:22528
    s_waitcnt lgkmcnt(5)
    s_waitcnt vmcnt(16)
    v_mfma_f32_16x16x32_bf16 v[44:47], v[100:103], a[52:55], v[44:47]
    ds_read_b128 v[140:143], v200 offset:23552
    s_add_u32 s88, s30, 24576
    buffer_load_dwordx2 a[112:113], v203, s[4:7], s88 offen offset:0 sc1
    buffer_load_dwordx2 a[114:115], v203, s[4:7], s88 offen offset:512 sc1
    v_mfma_f32_16x16x32_bf16 v[48:51], v[104:107], a[52:55], v[48:51]
    ds_read_b128 v[144:147], v200 offset:24576
    v_mfma_f32_16x16x32_bf16 v[52:55], v[108:111], a[52:55], v[52:55]
    ds_read_b128 v[148:151], v200 offset:25600
    buffer_load_dwordx4 a[116:119], v3, s[4:7], s88 offen offset:1024 sc1
    v_mfma_f32_16x16x32_bf16 v[56:59], v[112:115], a[52:55], v[56:59]
    ds_read_b128 v[152:155], v200 offset:26624
    v_mfma_f32_16x16x32_bf16 v[60:63], v[116:119], a[52:55], v[60:63]
    ds_read_b128 v[156:159], v200 offset:27648
    s_barrier
    s_waitcnt lgkmcnt(5)
    s_waitcnt vmcnt(17)
    s_nop 0
    v_mfma_f32_16x16x32_bf16 v[44:47], v[120:123], a[56:59], v[44:47]
    ds_read_b128 v[100:103], v200 offset:28672
    buffer_load_dwordx4 a[120:123], v3, s[4:7], s88 offen offset:2048 sc1
    v_mfma_f32_16x16x32_bf16 v[48:51], v[124:127], a[56:59], v[48:51]
    ds_read_b128 v[104:107], v200 offset:29696
    v_mfma_f32_16x16x32_bf16 v[52:55], v[128:131], a[56:59], v[52:55]
    ds_read_b128 v[108:111], v200 offset:30720
    v_mfma_f32_16x16x32_bf16 v[56:59], v[132:135], a[56:59], v[56:59]
    ds_read_b128 v[112:115], v200 offset:31744
    v_mfma_f32_16x16x32_bf16 v[60:63], v[136:139], a[56:59], v[60:63]
    ds_read_b128 v[116:119], v200 offset:32768
    s_waitcnt lgkmcnt(5)
    s_waitcnt vmcnt(17)
    v_mfma_f32_16x16x32_bf16 v[44:47], v[140:143], a[60:63], v[44:47]
    ds_read_b128 v[120:123], v200 offset:33792
    buffer_load_dwordx4 a[124:127], v3, s[4:7], s88 offen offset:3072 sc1
    v_mfma_f32_16x16x32_bf16 v[48:51], v[144:147], a[60:63], v[48:51]
    ds_read_b128 v[124:127], v200 offset:34816
    v_mfma_f32_16x16x32_bf16 v[52:55], v[148:151], a[60:63], v[52:55]
    ds_read_b128 v[128:131], v200 offset:35840
    s_add_u32 s88, s30, 28672
    buffer_load_dwordx4 a[128:131], v3, s[4:7], s88 offen offset:0 sc1
    v_mfma_f32_16x16x32_bf16 v[56:59], v[152:155], a[60:63], v[56:59]
    ds_read_b128 v[132:135], v200 offset:36864
    v_mfma_f32_16x16x32_bf16 v[60:63], v[156:159], a[60:63], v[60:63]
    ds_read_b128 v[136:139], v200 offset:37888
    s_waitcnt lgkmcnt(5)
    s_waitcnt vmcnt(18)
    v_mfma_f32_16x16x32_bf16 v[44:47], v[100:103], a[64:67], v[44:47]
    ds_read_b128 v[140:143], v200 offset:38912
    buffer_load_dwordx4 a[132:135], v3, s[4:7], s88 offen offset:1024 sc1
    v_mfma_f32_16x16x32_bf16 v[48:51], v[104:107], a[64:67], v[48:51]
    ds_read_b128 v[144:147], v200 offset:39936
    v_mfma_f32_16x16x32_bf16 v[52:55], v[108:111], a[64:67], v[52:55]
    ds_read_b128 v[148:151], v200 offset:40960
    v_mfma_f32_16x16x32_bf16 v[56:59], v[112:115], a[64:67], v[56:59]
    ds_read_b128 v[152:155], v200 offset:41984
    v_mfma_f32_16x16x32_bf16 v[60:63], v[116:119], a[64:67], v[60:63]
    ds_read_b128 v[156:159], v200 offset:43008
    s_waitcnt lgkmcnt(5)
    s_waitcnt vmcnt(18)
    v_mfma_f32_16x16x32_bf16 v[44:47], v[120:123], a[68:71], v[44:47]
    ds_read_b128 v[100:103], v200 offset:44032
    s_add_u32 s94, s93, 131072
    s_mov_b32 m0, s94
    s_nop 0
    s_add_u32 s95, s92, 163840
    buffer_load_dwordx4 v3, s[4:7], s95 offen offset:0 lds
    v_mfma_f32_16x16x32_bf16 v[48:51], v[124:127], a[68:71], v[48:51]
    ds_read_b128 v[104:107], v200 offset:45056
    v_mfma_f32_16x16x32_bf16 v[52:55], v[128:131], a[68:71], v[52:55]
    ds_read_b128 v[108:111], v200 offset:46080
    buffer_load_dwordx4 v3, s[4:7], s95 offen offset:1024 lds
    v_mfma_f32_16x16x32_bf16 v[56:59], v[132:135], a[68:71], v[56:59]
    ds_read_b128 v[112:115], v200 offset:47104
    v_mfma_f32_16x16x32_bf16 v[60:63], v[136:139], a[68:71], v[60:63]
    ds_read_b128 v[116:119], v200 offset:48128
    s_barrier
    s_waitcnt lgkmcnt(5)
    s_waitcnt vmcnt(19)
    s_nop 0
    v_mfma_f32_16x16x32_bf16 v[44:47], v[140:143], a[72:75], v[44:47]
    ds_read_b128 v[120:123], v200 offset:49152
    buffer_load_dwordx4 v3, s[4:7], s95 offen offset:2048 lds
    v_mfma_f32_16x16x32_bf16 v[48:51], v[144:147], a[72:75], v[48:51]
    ds_read_b128 v[124:127], v200 offset:50176
    v_mfma_f32_16x16x32_bf16 v[52:55], v[148:151], a[72:75], v[52:55]
    ds_read_b128 v[128:131], v200 offset:51200
    buffer_load_dwordx4 v3, s[4:7], s95 offen offset:3072 lds
    v_mfma_f32_16x16x32_bf16 v[56:59], v[152:155], a[72:75], v[56:59]
    ds_read_b128 v[132:135], v200 offset:52224
    v_mfma_f32_16x16x32_bf16 v[60:63], v[156:159], a[72:75], v[60:63]
    ds_read_b128 v[136:139], v200 offset:53248
    s_waitcnt lgkmcnt(5)
    s_waitcnt vmcnt(20)
    v_mfma_f32_16x16x32_bf16 v[44:47], v[100:103], a[76:79], v[44:47]
    ds_read_b128 v[140:143], v200 offset:54272
    s_add_u32 s94, s93, 147456
    s_mov_b32 m0, s94
    s_nop 0
    s_add_u32 s95, s92, 180224
    buffer_load_dwordx4 v3, s[4:7], s95 offen offset:0 lds
    v_mfma_f32_16x16x32_bf16 v[48:51], v[104:107], a[76:79], v[48:51]
    ds_read_b128 v[144:147], v200 offset:55296
    v_mfma_f32_16x16x32_bf16 v[52:55], v[108:111], a[76:79], v[52:55]
    ds_read_b128 v[148:151], v200 offset:56320
    v_mfma_f32_16x16x32_bf16 v[56:59], v[112:115], a[76:79], v[56:59]
    ds_read_b128 v[152:155], v200 offset:57344
    v_mfma_f32_16x16x32_bf16 v[60:63], v[116:119], a[76:79], v[60:63]
    ds_read_b128 v[156:159], v200 offset:58368
    s_waitcnt lgkmcnt(5)
    s_waitcnt vmcnt(20)
    v_mfma_f32_16x16x32_bf16 v[44:47], v[120:123], a[80:83], v[44:47]
    ds_read_b128 v[100:103], v200 offset:59392
    buffer_load_dwordx4 v3, s[4:7], s95 offen offset:1024 lds
    v_mfma_f32_16x16x32_bf16 v[48:51], v[124:127], a[80:83], v[48:51]
    ds_read_b128 v[104:107], v200 offset:60416
    v_mfma_f32_16x16x32_bf16 v[52:55], v[128:131], a[80:83], v[52:55]
    ds_read_b128 v[108:111], v201 offset:0
    buffer_load_dwordx4 v3, s[4:7], s95 offen offset:2048 lds
    v_mfma_f32_16x16x32_bf16 v[56:59], v[132:135], a[80:83], v[56:59]
    ds_read_b128 v[112:115], v201 offset:1024
    v_mfma_f32_16x16x32_bf16 v[60:63], v[136:139], a[80:83], v[60:63]
    ds_read_b128 v[116:119], v201 offset:2048
    s_waitcnt lgkmcnt(5)
    s_waitcnt vmcnt(20)
    v_mfma_f32_16x16x32_bf16 v[44:47], v[140:143], a[84:87], v[44:47]
    ds_read_b128 v[120:123], v201 offset:3072
    buffer_load_dwordx4 v3, s[4:7], s95 offen offset:3072 lds
    v_mfma_f32_16x16x32_bf16 v[48:51], v[144:147], a[84:87], v[48:51]
    ds_read_b128 v[124:127], v201 offset:4096
    v_mfma_f32_16x16x32_bf16 v[52:55], v[148:151], a[84:87], v[52:55]
    ds_read_b128 v[128:131], v201 offset:5120
    v_mfma_f32_16x16x32_bf16 v[56:59], v[152:155], a[84:87], v[56:59]
    ds_read_b128 v[132:135], v201 offset:6144
    v_mfma_f32_16x16x32_bf16 v[60:63], v[156:159], a[84:87], v[60:63]
    ds_read_b128 v[136:139], v201 offset:7168
    s_barrier
    s_waitcnt lgkmcnt(5)
    s_waitcnt vmcnt(20)
    s_nop 0
    v_mfma_f32_16x16x32_bf16 v[44:47], v[100:103], a[88:91], v[44:47]
    ds_read_b128 v[140:143], v201 offset:8192
    buffer_load_dwordx4 a[136:139], v3, s[4:7], s88 offen offset:2048 sc1
    v_mfma_f32_16x16x32_bf16 v[48:51], v[104:107], a[88:91], v[48:51]
    ds_read_b128 v[144:147], v201 offset:9216
    v_mfma_f32_16x16x32_bf16 v[52:55], v[108:111], a[88:91], v[52:55]
    ds_read_b128 v[148:151], v201 offset:10240
    buffer_load_dwordx2 a[140:141], v203, s[4:7], s88 offen offset:3072 sc1
    buffer_load_dwordx2 a[142:143], v203, s[4:7], s88 offen offset:3584 sc1
    v_mfma_f32_16x16x32_bf16 v[56:59], v[112:115], a[88:91], v[56:59]
    ds_read_b128 v[152:155], v201 offset:11264
    v_mfma_f32_16x16x32_bf16 v[60:63], v[116:119], a[88:91], v[60:63]
    ds_read_b128 v[156:159], v201 offset:12288
    s_waitcnt lgkmcnt(5)
    s_waitcnt vmcnt(22)
    v_mfma_f32_16x16x32_bf16 v[44:47], v[120:123], a[92:95], v[44:47]
    ds_read_b128 v[100:103], v201 offset:13312
    s_add_u32 s88, s30, 32768
    buffer_load_dwordx4 a[144:147], v3, s[4:7], s88 offen offset:0 sc1
    v_mfma_f32_16x16x32_bf16 v[48:51], v[124:127], a[92:95], v[48:51]
    ds_read_b128 v[104:107], v201 offset:14336
    v_mfma_f32_16x16x32_bf16 v[52:55], v[128:131], a[92:95], v[52:55]
    ds_read_b128 v[108:111], v201 offset:15360
    buffer_load_dwordx4 a[148:151], v3, s[4:7], s88 offen offset:1024 sc1
    v_mfma_f32_16x16x32_bf16 v[56:59], v[132:135], a[92:95], v[56:59]
    ds_read_b128 v[112:115], v201 offset:16384
    v_mfma_f32_16x16x32_bf16 v[60:63], v[136:139], a[92:95], v[60:63]
    ds_read_b128 v[116:119], v201 offset:17408
    s_waitcnt lgkmcnt(5)
    s_waitcnt vmcnt(23)
    v_mfma_f32_16x16x32_bf16 v[44:47], v[140:143], a[96:99], v[44:47]
    ds_read_b128 v[120:123], v201 offset:18432
    s_add_u32 s94, s93, 0
    s_mov_b32 m0, s94
    s_add_u32 s95, s92, 196608
    buffer_load_dwordx4 v3, s[4:7], s95 offen offset:0 lds
    v_mfma_f32_16x16x32_bf16 v[48:51], v[144:147], a[96:99], v[48:51]
    ds_read_b128 v[124:127], v201 offset:19456
    v_mfma_f32_16x16x32_bf16 v[52:55], v[148:151], a[96:99], v[52:55]
    ds_read_b128 v[128:131], v201 offset:20480
    v_mfma_f32_16x16x32_bf16 v[56:59], v[152:155], a[96:99], v[56:59]
    ds_read_b128 v[132:135], v201 offset:21504
    v_mfma_f32_16x16x32_bf16 v[60:63], v[156:159], a[96:99], v[60:63]
    ds_read_b128 v[136:139], v201 offset:22528
    s_waitcnt lgkmcnt(5)
    s_waitcnt vmcnt(23)
    v_mfma_f32_16x16x32_bf16 v[44:47], v[100:103], a[100:103], v[44:47]
    ds_read_b128 v[140:143], v201 offset:23552
    buffer_load_dwordx4 v3, s[4:7], s95 offen offset:1024 lds
    v_mfma_f32_16x16x32_bf16 v[48:51], v[104:107], a[100:103], v[48:51]
    ds_read_b128 v[144:147], v201 offset:24576
    v_mfma_f32_16x16x32_bf16 v[52:55], v[108:111], a[100:103], v[52:55]
    ds_read_b128 v[148:151], v201 offset:25600
    buffer_load_dwordx4 v3, s[4:7], s95 offen offset:2048 lds
    v_mfma_f32_16x16x32_bf16 v[56:59], v[112:115], a[100:103], v[56:59]
    ds_read_b128 v[152:155], v201 offset:26624
    v_mfma_f32_16x16x32_bf16 v[60:63], v[116:119], a[100:103], v[60:63]
    ds_read_b128 v[156:159], v201 offset:27648
    s_barrier
    s_waitcnt lgkmcnt(5)
    s_waitcnt vmcnt(24)
    s_nop 0
    v_mfma_f32_16x16x32_bf16 v[44:47], v[120:123], a[104:107], v[44:47]
    ds_read_b128 v[100:103], v201 offset:28672
    buffer_load_dwordx4 v3, s[4:7], s95 offen offset:3072 lds
    v_mfma_f32_16x16x32_bf16 v[48:51], v[124:127], a[104:107], v[48:51]
    ds_read_b128 v[104:107], v201 offset:29696
    v_mfma_f32_16x16x32_bf16 v[52:55], v[128:131], a[104:107], v[52:55]
    ds_read_b128 v[108:111], v201 offset:30720
    v_mfma_f32_16x16x32_bf16 v[56:59], v[132:135], a[104:107], v[56:59]
    ds_read_b128 v[112:115], v201 offset:31744
    v_mfma_f32_16x16x32_bf16 v[60:63], v[136:139], a[104:107], v[60:63]
    ds_read_b128 v[116:119], v201 offset:32768
    s_waitcnt lgkmcnt(5)
    s_waitcnt vmcnt(24)
    v_mfma_f32_16x16x32_bf16 v[44:47], v[140:143], a[108:111], v[44:47]
    ds_read_b128 v[120:123], v201 offset:33792
    buffer_load_dwordx4 a[152:155], v3, s[4:7], s88 offen offset:2048 sc1
    v_mfma_f32_16x16x32_bf16 v[48:51], v[144:147], a[108:111], v[48:51]
    ds_read_b128 v[124:127], v201 offset:34816
    v_mfma_f32_16x16x32_bf16 v[52:55], v[148:151], a[108:111], v[52:55]
    ds_read_b128 v[128:131], v201 offset:35840
    buffer_load_dwordx4 a[156:159], v3, s[4:7], s88 offen offset:3072 sc1
    v_mfma_f32_16x16x32_bf16 v[56:59], v[152:155], a[108:111], v[56:59]
    ds_read_b128 v[132:135], v201 offset:36864
    v_mfma_f32_16x16x32_bf16 v[60:63], v[156:159], a[108:111], v[60:63]
    ds_read_b128 v[136:139], v201 offset:37888
    s_waitcnt lgkmcnt(5)
    s_waitcnt vmcnt(24)
    v_mfma_f32_16x16x32_bf16 v[44:47], v[100:103], a[112:115], v[44:47]
    ds_read_b128 v[140:143], v201 offset:38912
    s_add_u32 s88, s30, 36864
    buffer_load_dwordx4 a[160:163], v3, s[4:7], s88 offen offset:0 sc1
    v_mfma_f32_16x16x32_bf16 v[48:51], v[104:107], a[112:115], v[48:51]
    ds_read_b128 v[144:147], v201 offset:39936
    v_mfma_f32_16x16x32_bf16 v[52:55], v[108:111], a[112:115], v[52:55]
    ds_read_b128 v[148:151], v201 offset:40960
    buffer_load_dwordx4 a[164:167], v3, s[4:7], s88 offen offset:1024 sc1
    v_mfma_f32_16x16x32_bf16 v[56:59], v[112:115], a[112:115], v[56:59]
    ds_read_b128 v[152:155], v201 offset:41984
    v_mfma_f32_16x16x32_bf16 v[60:63], v[116:119], a[112:115], v[60:63]
    ds_read_b128 v[156:159], v201 offset:43008
    s_waitcnt lgkmcnt(5)
    s_waitcnt vmcnt(25)
    v_mfma_f32_16x16x32_bf16 v[44:47], v[120:123], a[116:119], v[44:47]
    ds_read_b128 v[100:103], v201 offset:44032
    s_add_u32 s94, s93, 16384
    s_mov_b32 m0, s94
    s_nop 0
    s_add_u32 s95, s92, 212992
    buffer_load_dwordx4 v3, s[4:7], s95 offen offset:0 lds
    v_mfma_f32_16x16x32_bf16 v[48:51], v[124:127], a[116:119], v[48:51]
    ds_read_b128 v[104:107], v201 offset:45056
    v_mfma_f32_16x16x32_bf16 v[52:55], v[128:131], a[116:119], v[52:55]
    ds_read_b128 v[108:111], v201 offset:46080
    v_mfma_f32_16x16x32_bf16 v[56:59], v[132:135], a[116:119], v[56:59]
    ds_read_b128 v[112:115], v201 offset:47104
    v_mfma_f32_16x16x32_bf16 v[60:63], v[136:139], a[116:119], v[60:63]
    ds_read_b128 v[116:119], v201 offset:48128
    s_barrier
    s_waitcnt lgkmcnt(5)
    s_waitcnt vmcnt(25)
    s_nop 0
    v_mfma_f32_16x16x32_bf16 v[44:47], v[140:143], a[120:123], v[44:47]
    ds_read_b128 v[120:123], v201 offset:49152
    buffer_load_dwordx4 v3, s[4:7], s95 offen offset:1024 lds
    v_mfma_f32_16x16x32_bf16 v[48:51], v[144:147], a[120:123], v[48:51]
    ds_read_b128 v[124:127], v201 offset:50176
    v_mfma_f32_16x16x32_bf16 v[52:55], v[148:151], a[120:123], v[52:55]
    ds_read_b128 v[128:131], v201 offset:51200
    buffer_load_dwordx4 v3, s[4:7], s95 offen offset:2048 lds
    v_mfma_f32_16x16x32_bf16 v[56:59], v[152:155], a[120:123], v[56:59]
    ds_read_b128 v[132:135], v201 offset:52224
    v_mfma_f32_16x16x32_bf16 v[60:63], v[156:159], a[120:123], v[60:63]
    ds_read_b128 v[136:139], v201 offset:53248
    s_waitcnt lgkmcnt(5)
    s_waitcnt vmcnt(26)
    v_mfma_f32_16x16x32_bf16 v[44:47], v[100:103], a[124:127], v[44:47]
    ds_read_b128 v[140:143], v201 offset:54272
    buffer_load_dwordx4 v3, s[4:7], s95 offen offset:3072 lds
    v_mfma_f32_16x16x32_bf16 v[48:51], v[104:107], a[124:127], v[48:51]
    ds_read_b128 v[144:147], v201 offset:55296
    v_mfma_f32_16x16x32_bf16 v[52:55], v[108:111], a[124:127], v[52:55]
    ds_read_b128 v[148:151], v201 offset:56320
    v_mfma_f32_16x16x32_bf16 v[56:59], v[112:115], a[124:127], v[56:59]
    ds_read_b128 v[152:155], v201 offset:57344
    v_mfma_f32_16x16x32_bf16 v[60:63], v[116:119], a[124:127], v[60:63]
    ds_read_b128 v[156:159], v201 offset:58368
    s_waitcnt lgkmcnt(5)
    s_waitcnt vmcnt(26)
    v_mfma_f32_16x16x32_bf16 v[44:47], v[120:123], a[128:131], v[44:47]
    ds_read_b128 v[100:103], v201 offset:59392
    buffer_load_dwordx2 a[168:169], v203, s[4:7], s88 offen offset:2048 sc1
    buffer_load_dwordx2 a[170:171], v203, s[4:7], s88 offen offset:2560 sc1
    v_mfma_f32_16x16x32_bf16 v[48:51], v[124:127], a[128:131], v[48:51]
    ds_read_b128 v[104:107], v201 offset:60416
    v_mfma_f32_16x16x32_bf16 v[52:55], v[128:131], a[128:131], v[52:55]
    ds_read_b128 v[108:111], v202 offset:0
    buffer_load_dwordx4 a[172:175], v3, s[4:7], s88 offen offset:3072 sc1
    v_mfma_f32_16x16x32_bf16 v[56:59], v[132:135], a[128:131], v[56:59]
    ds_read_b128 v[112:115], v202 offset:1024
    v_mfma_f32_16x16x32_bf16 v[60:63], v[136:139], a[128:131], v[60:63]
    ds_read_b128 v[116:119], v202 offset:2048
    s_waitcnt lgkmcnt(5)
    s_waitcnt vmcnt(28)
    v_mfma_f32_16x16x32_bf16 v[44:47], v[140:143], a[132:135], v[44:47]
    ds_read_b128 v[120:123], v202 offset:3072
    s_add_u32 s88, s30, 40960
    buffer_load_dwordx4 a[176:179], v3, s[4:7], s88 offen offset:0 sc1
    v_mfma_f32_16x16x32_bf16 v[48:51], v[144:147], a[132:135], v[48:51]
    ds_read_b128 v[124:127], v202 offset:4096
    v_mfma_f32_16x16x32_bf16 v[52:55], v[148:151], a[132:135], v[52:55]
    ds_read_b128 v[128:131], v202 offset:5120
    buffer_load_dwordx4 a[180:183], v3, s[4:7], s88 offen offset:1024 sc1
    v_mfma_f32_16x16x32_bf16 v[56:59], v[152:155], a[132:135], v[56:59]
    ds_read_b128 v[132:135], v202 offset:6144
    v_mfma_f32_16x16x32_bf16 v[60:63], v[156:159], a[132:135], v[60:63]
    ds_read_b128 v[136:139], v202 offset:7168
    s_waitcnt vmcnt(22)
    s_barrier
    s_waitcnt lgkmcnt(5)
    s_waitcnt vmcnt(21)
    v_mfma_f32_16x16x32_bf16 v[44:47], v[100:103], a[136:139], v[44:47]
    ds_read_b128 v[140:143], v202 offset:8192
    s_add_u32 s94, s93, 32768
    s_mov_b32 m0, s94
    s_nop 0
    s_add_u32 s95, s92, 229376
    buffer_load_dwordx4 v3, s[4:7], s95 offen offset:0 lds
    v_mfma_f32_16x16x32_bf16 v[48:51], v[104:107], a[136:139], v[48:51]
    ds_read_b128 v[144:147], v202 offset:9216
    v_mfma_f32_16x16x32_bf16 v[52:55], v[108:111], a[136:139], v[52:55]
    ds_read_b128 v[148:151], v202 offset:10240
    v_mfma_f32_16x16x32_bf16 v[56:59], v[112:115], a[136:139], v[56:59]
    ds_read_b128 v[152:155], v202 offset:11264
    v_mfma_f32_16x16x32_bf16 v[60:63], v[116:119], a[136:139], v[60:63]
    ds_read_b128 v[156:159], v202 offset:12288
    s_waitcnt lgkmcnt(5)
    s_waitcnt vmcnt(20)
    v_mfma_f32_16x16x32_bf16 v[44:47], v[120:123], a[140:143], v[44:47]
    ds_read_b128 v[100:103], v202 offset:13312
    buffer_load_dwordx4 v3, s[4:7], s95 offen offset:1024 lds
    v_mfma_f32_16x16x32_bf16 v[48:51], v[124:127], a[140:143], v[48:51]
    ds_read_b128 v[104:107], v202 offset:14336
    v_mfma_f32_16x16x32_bf16 v[52:55], v[128:131], a[140:143], v[52:55]
    ds_read_b128 v[108:111], v202 offset:15360
    buffer_load_dwordx4 v3, s[4:7], s95 offen offset:2048 lds
    v_mfma_f32_16x16x32_bf16 v[56:59], v[132:135], a[140:143], v[56:59]
    ds_read_b128 v[112:115], v202 offset:16384
    v_mfma_f32_16x16x32_bf16 v[60:63], v[136:139], a[140:143], v[60:63]
    ds_read_b128 v[116:119], v202 offset:17408
    s_waitcnt lgkmcnt(5)
    s_waitcnt vmcnt(21)
    v_mfma_f32_16x16x32_bf16 v[44:47], v[140:143], a[144:147], v[44:47]
    ds_read_b128 v[120:123], v202 offset:18432
    buffer_load_dwordx4 v3, s[4:7], s95 offen offset:3072 lds
    v_mfma_f32_16x16x32_bf16 v[48:51], v[144:147], a[144:147], v[48:51]
    ds_read_b128 v[124:127], v202 offset:19456
    v_mfma_f32_16x16x32_bf16 v[52:55], v[148:151], a[144:147], v[52:55]
    ds_read_b128 v[128:131], v202 offset:20480
    v_mfma_f32_16x16x32_bf16 v[56:59], v[152:155], a[144:147], v[56:59]
    ds_read_b128 v[132:135], v202 offset:21504
    v_mfma_f32_16x16x32_bf16 v[60:63], v[156:159], a[144:147], v[60:63]
    ds_read_b128 v[136:139], v202 offset:22528
    s_waitcnt lgkmcnt(5)
    s_waitcnt vmcnt(21)
    v_mfma_f32_16x16x32_bf16 v[44:47], v[100:103], a[148:151], v[44:47]
    ds_read_b128 v[140:143], v202 offset:23552
    buffer_load_dwordx4 a[184:187], v3, s[4:7], s88 offen offset:2048 sc1
    v_mfma_f32_16x16x32_bf16 v[48:51], v[104:107], a[148:151], v[48:51]
    ds_read_b128 v[144:147], v202 offset:24576
    v_mfma_f32_16x16x32_bf16 v[52:55], v[108:111], a[148:151], v[52:55]
    ds_read_b128 v[148:151], v202 offset:25600
    buffer_load_dwordx4 a[188:191], v3, s[4:7], s88 offen offset:3072 sc1
    v_mfma_f32_16x16x32_bf16 v[56:59], v[112:115], a[148:151], v[56:59]
    ds_read_b128 v[152:155], v202 offset:26624
    v_mfma_f32_16x16x32_bf16 v[60:63], v[116:119], a[148:151], v[60:63]
    ds_read_b128 v[156:159], v202 offset:27648
    s_waitcnt vmcnt(19)
    s_barrier
    s_waitcnt lgkmcnt(5)
    s_waitcnt vmcnt(18)
    v_mfma_f32_16x16x32_bf16 v[44:47], v[120:123], a[152:155], v[44:47]
    ds_read_b128 v[100:103], v202 offset:28672
    s_add_u32 s88, s30, 45056
    buffer_load_dwordx4 a[192:195], v3, s[4:7], s88 offen offset:0 sc1
    v_mfma_f32_16x16x32_bf16 v[48:51], v[124:127], a[152:155], v[48:51]
    ds_read_b128 v[104:107], v202 offset:29696
    v_mfma_f32_16x16x32_bf16 v[52:55], v[128:131], a[152:155], v[52:55]
    ds_read_b128 v[108:111], v202 offset:30720
    buffer_load_dwordx4 a[196:199], v3, s[4:7], s88 offen offset:1024 sc1
    v_mfma_f32_16x16x32_bf16 v[56:59], v[132:135], a[152:155], v[56:59]
    ds_read_b128 v[112:115], v202 offset:31744
    v_mfma_f32_16x16x32_bf16 v[60:63], v[136:139], a[152:155], v[60:63]
    ds_read_b128 v[116:119], v202 offset:32768
    s_waitcnt lgkmcnt(5)
    s_waitcnt vmcnt(19)
    v_mfma_f32_16x16x32_bf16 v[44:47], v[140:143], a[156:159], v[44:47]
    ds_read_b128 v[120:123], v202 offset:33792
    s_add_u32 s94, s93, 49152
    s_mov_b32 m0, s94
    s_nop 0
    s_add_u32 s95, s92, 245760
    buffer_load_dwordx4 v3, s[4:7], s95 offen offset:0 lds
    v_mfma_f32_16x16x32_bf16 v[48:51], v[144:147], a[156:159], v[48:51]
    ds_read_b128 v[124:127], v202 offset:34816
    v_mfma_f32_16x16x32_bf16 v[52:55], v[148:151], a[156:159], v[52:55]
    ds_read_b128 v[128:131], v202 offset:35840
    v_mfma_f32_16x16x32_bf16 v[56:59], v[152:155], a[156:159], v[56:59]
    ds_read_b128 v[132:135], v202 offset:36864
    v_mfma_f32_16x16x32_bf16 v[60:63], v[156:159], a[156:159], v[60:63]
    ds_read_b128 v[136:139], v202 offset:37888
    s_waitcnt lgkmcnt(5)
    s_waitcnt vmcnt(19)
    v_mfma_f32_16x16x32_bf16 v[44:47], v[100:103], a[160:163], v[44:47]
    ds_read_b128 v[140:143], v202 offset:38912
    buffer_load_dwordx4 v3, s[4:7], s95 offen offset:1024 lds
    v_mfma_f32_16x16x32_bf16 v[48:51], v[104:107], a[160:163], v[48:51]
    ds_read_b128 v[144:147], v202 offset:39936
    v_mfma_f32_16x16x32_bf16 v[52:55], v[108:111], a[160:163], v[52:55]
    ds_read_b128 v[148:151], v200 offset:0
    buffer_load_dwordx4 v3, s[4:7], s95 offen offset:2048 lds
    v_mfma_f32_16x16x32_bf16 v[56:59], v[112:115], a[160:163], v[56:59]
    ds_read_b128 v[152:155], v200 offset:1024
    v_mfma_f32_16x16x32_bf16 v[60:63], v[116:119], a[160:163], v[60:63]
    ds_read_b128 v[156:159], v200 offset:2048
    s_waitcnt lgkmcnt(5)
    s_waitcnt vmcnt(20)
    v_mfma_f32_16x16x32_bf16 v[44:47], v[120:123], a[164:167], v[44:47]
    ds_read_b128 v[100:103], v200 offset:3072
    buffer_load_dwordx4 v3, s[4:7], s95 offen offset:3072 lds
    v_mfma_f32_16x16x32_bf16 v[48:51], v[124:127], a[164:167], v[48:51]
    ds_read_b128 v[104:107], v200 offset:4096
    v_mfma_f32_16x16x32_bf16 v[52:55], v[128:131], a[164:167], v[52:55]
    ds_read_b128 v[108:111], v200 offset:5120
    v_mfma_f32_16x16x32_bf16 v[56:59], v[132:135], a[164:167], v[56:59]
    ds_read_b128 v[112:115], v200 offset:6144
    v_mfma_f32_16x16x32_bf16 v[60:63], v[136:139], a[164:167], v[60:63]
    ds_read_b128 v[116:119], v200 offset:7168
    s_waitcnt vmcnt(17)
    s_barrier
    s_waitcnt lgkmcnt(5)
    s_waitcnt vmcnt(15)
    v_mfma_f32_16x16x32_bf16 v[44:47], v[140:143], a[168:171], v[44:47]
    ds_read_b128 v[120:123], v200 offset:8192
    s_add_u32 s94, s93, 65536
    s_mov_b32 m0, s94
    s_nop 0
    s_add_u32 s95, s92, 262144
    buffer_load_dwordx4 v3, s[4:7], s95 offen offset:0 lds
    v_mfma_f32_16x16x32_bf16 v[48:51], v[144:147], a[168:171], v[48:51]
    ds_read_b128 v[124:127], v200 offset:9216
    v_mfma_f32_16x16x32_bf16 v[52:55], v[148:151], a[168:171], v[52:55]
    ds_read_b128 v[128:131], v200 offset:10240
    buffer_load_dwordx4 v3, s[4:7], s95 offen offset:1024 lds
    v_mfma_f32_16x16x32_bf16 v[56:59], v[152:155], a[168:171], v[56:59]
    ds_read_b128 v[132:135], v200 offset:11264
    v_mfma_f32_16x16x32_bf16 v[60:63], v[156:159], a[168:171], v[60:63]
    ds_read_b128 v[136:139], v200 offset:12288
    s_waitcnt lgkmcnt(5)
    s_waitcnt vmcnt(16)
    v_mfma_f32_16x16x32_bf16 v[44:47], v[100:103], a[172:175], v[44:47]
    ds_read_b128 v[140:143], v200 offset:13312
    buffer_load_dwordx4 v3, s[4:7], s95 offen offset:2048 lds
    v_mfma_f32_16x16x32_bf16 v[48:51], v[104:107], a[172:175], v[48:51]
    ds_read_b128 v[144:147], v200 offset:14336
    v_mfma_f32_16x16x32_bf16 v[52:55], v[108:111], a[172:175], v[52:55]
    ds_read_b128 v[148:151], v200 offset:15360
    buffer_load_dwordx4 v3, s[4:7], s95 offen offset:3072 lds
    v_mfma_f32_16x16x32_bf16 v[56:59], v[112:115], a[172:175], v[56:59]
    ds_read_b128 v[152:155], v200 offset:16384
    v_mfma_f32_16x16x32_bf16 v[60:63], v[116:119], a[172:175], v[60:63]
    ds_read_b128 v[156:159], v200 offset:17408
    s_waitcnt lgkmcnt(5)
    s_waitcnt vmcnt(17)
    v_mfma_f32_16x16x32_bf16 v[44:47], v[120:123], a[176:179], v[44:47]
    ds_read_b128 v[100:103], v200 offset:18432
    buffer_load_dwordx4 a[200:203], v3, s[4:7], s88 offen offset:2048 sc1
    v_mfma_f32_16x16x32_bf16 v[48:51], v[124:127], a[176:179], v[48:51]
    ds_read_b128 v[104:107], v200 offset:19456
    v_mfma_f32_16x16x32_bf16 v[52:55], v[128:131], a[176:179], v[52:55]
    ds_read_b128 v[108:111], v200 offset:20480
    v_mfma_f32_16x16x32_bf16 v[56:59], v[132:135], a[176:179], v[56:59]
    ds_read_b128 v[112:115], v200 offset:21504
    v_mfma_f32_16x16x32_bf16 v[60:63], v[136:139], a[176:179], v[60:63]
    ds_read_b128 v[116:119], v200 offset:22528
    s_waitcnt lgkmcnt(5)
    s_waitcnt vmcnt(17)
    v_mfma_f32_16x16x32_bf16 v[44:47], v[140:143], a[180:183], v[44:47]
    ds_read_b128 v[120:123], v200 offset:23552
    buffer_load_dwordx4 a[204:207], v3, s[4:7], s88 offen offset:3072 sc1
    v_mfma_f32_16x16x32_bf16 v[48:51], v[144:147], a[180:183], v[48:51]
    ds_read_b128 v[124:127], v200 offset:24576
    v_mfma_f32_16x16x32_bf16 v[52:55], v[148:151], a[180:183], v[52:55]
    ds_read_b128 v[128:131], v200 offset:25600
    s_add_u32 s88, s30, 49152
    buffer_load_dwordx4 a[208:211], v3, s[4:7], s88 offen offset:0 sc1
    v_mfma_f32_16x16x32_bf16 v[56:59], v[152:155], a[180:183], v[56:59]
    ds_read_b128 v[132:135], v200 offset:26624
    v_mfma_f32_16x16x32_bf16 v[60:63], v[156:159], a[180:183], v[60:63]
    ds_read_b128 v[136:139], v200 offset:27648
    s_waitcnt vmcnt(15)
    s_barrier
    s_waitcnt lgkmcnt(5)
    s_waitcnt vmcnt(14)
    v_mfma_f32_16x16x32_bf16 v[44:47], v[100:103], a[184:187], v[44:47]
    ds_read_b128 v[140:143], v200 offset:28672
    buffer_load_dwordx4 a[212:215], v3, s[4:7], s88 offen offset:1024 sc1
    v_mfma_f32_16x16x32_bf16 v[48:51], v[104:107], a[184:187], v[48:51]
    ds_read_b128 v[144:147], v200 offset:29696
    v_mfma_f32_16x16x32_bf16 v[52:55], v[108:111], a[184:187], v[52:55]
    ds_read_b128 v[148:151], v200 offset:30720
    v_mfma_f32_16x16x32_bf16 v[56:59], v[112:115], a[184:187], v[56:59]
    ds_read_b128 v[152:155], v200 offset:31744
    v_mfma_f32_16x16x32_bf16 v[60:63], v[116:119], a[184:187], v[60:63]
    ds_read_b128 v[156:159], v200 offset:32768
    s_waitcnt lgkmcnt(5)
    s_waitcnt vmcnt(14)
    v_mfma_f32_16x16x32_bf16 v[44:47], v[120:123], a[188:191], v[44:47]
    ds_read_b128 v[100:103], v200 offset:33792
    buffer_load_dwordx4 a[216:219], v3, s[4:7], s88 offen offset:2048 sc1
    v_mfma_f32_16x16x32_bf16 v[48:51], v[124:127], a[188:191], v[48:51]
    ds_read_b128 v[104:107], v200 offset:34816
    v_mfma_f32_16x16x32_bf16 v[52:55], v[128:131], a[188:191], v[52:55]
    ds_read_b128 v[108:111], v200 offset:35840
    buffer_load_dwordx4 a[220:223], v3, s[4:7], s88 offen offset:3072 sc1
    v_mfma_f32_16x16x32_bf16 v[56:59], v[132:135], a[188:191], v[56:59]
    ds_read_b128 v[112:115], v200 offset:36864
    v_mfma_f32_16x16x32_bf16 v[60:63], v[136:139], a[188:191], v[60:63]
    ds_read_b128 v[116:119], v200 offset:37888
    s_waitcnt lgkmcnt(5)
    s_waitcnt vmcnt(15)
    v_mfma_f32_16x16x32_bf16 v[44:47], v[140:143], a[192:195], v[44:47]
    ds_read_b128 v[120:123], v200 offset:38912
    s_add_u32 s88, s30, 53248
    buffer_load_dwordx4 a[224:227], v3, s[4:7], s88 offen offset:0 sc1
    v_mfma_f32_16x16x32_bf16 v[48:51], v[144:147], a[192:195], v[48:51]
    ds_read_b128 v[124:127], v200 offset:39936
    v_mfma_f32_16x16x32_bf16 v[52:55], v[148:151], a[192:195], v[52:55]
    ds_read_b128 v[128:131], v200 offset:40960
    buffer_load_dwordx4 a[228:231], v3, s[4:7], s88 offen offset:1024 sc1
    v_mfma_f32_16x16x32_bf16 v[56:59], v[152:155], a[192:195], v[56:59]
    ds_read_b128 v[132:135], v200 offset:41984
    v_mfma_f32_16x16x32_bf16 v[60:63], v[156:159], a[192:195], v[60:63]
    ds_read_b128 v[136:139], v200 offset:43008
    s_waitcnt lgkmcnt(5)
    s_waitcnt vmcnt(16)
    v_mfma_f32_16x16x32_bf16 v[44:47], v[100:103], a[196:199], v[44:47]
    ds_read_b128 v[140:143], v200 offset:44032
    v_mfma_f32_16x16x32_bf16 v[48:51], v[104:107], a[196:199], v[48:51]
    ds_read_b128 v[144:147], v200 offset:45056
    v_mfma_f32_16x16x32_bf16 v[52:55], v[108:111], a[196:199], v[52:55]
    ds_read_b128 v[148:151], v200 offset:46080
    v_mfma_f32_16x16x32_bf16 v[56:59], v[112:115], a[196:199], v[56:59]
    ds_read_b128 v[152:155], v200 offset:47104
    v_mfma_f32_16x16x32_bf16 v[60:63], v[116:119], a[196:199], v[60:63]
    ds_read_b128 v[156:159], v200 offset:48128
    s_waitcnt vmcnt(8)
    s_barrier
    s_waitcnt lgkmcnt(5)
    s_waitcnt vmcnt(7)
    v_mfma_f32_16x16x32_bf16 v[44:47], v[120:123], a[200:203], v[44:47]
    ds_read_b128 v[100:103], v200 offset:49152
    v_mfma_f32_16x16x32_bf16 v[48:51], v[124:127], a[200:203], v[48:51]
    ds_read_b128 v[104:107], v200 offset:50176
    v_mfma_f32_16x16x32_bf16 v[52:55], v[128:131], a[200:203], v[52:55]
    ds_read_b128 v[108:111], v200 offset:51200
    v_mfma_f32_16x16x32_bf16 v[56:59], v[132:135], a[200:203], v[56:59]
    ds_read_b128 v[112:115], v200 offset:52224
    v_mfma_f32_16x16x32_bf16 v[60:63], v[136:139], a[200:203], v[60:63]
    ds_read_b128 v[116:119], v200 offset:53248
    s_waitcnt lgkmcnt(5)
    s_waitcnt vmcnt(6)
    v_mfma_f32_16x16x32_bf16 v[44:47], v[140:143], a[204:207], v[44:47]
    ds_read_b128 v[120:123], v200 offset:54272
    v_mfma_f32_16x16x32_bf16 v[48:51], v[144:147], a[204:207], v[48:51]
    ds_read_b128 v[124:127], v200 offset:55296
    v_mfma_f32_16x16x32_bf16 v[52:55], v[148:151], a[204:207], v[52:55]
    ds_read_b128 v[128:131], v200 offset:56320
    v_mfma_f32_16x16x32_bf16 v[56:59], v[152:155], a[204:207], v[56:59]
    ds_read_b128 v[132:135], v200 offset:57344
    v_mfma_f32_16x16x32_bf16 v[60:63], v[156:159], a[204:207], v[60:63]
    ds_read_b128 v[136:139], v200 offset:58368
    s_waitcnt lgkmcnt(5)
    s_waitcnt vmcnt(5)
    v_mfma_f32_16x16x32_bf16 v[44:47], v[100:103], a[208:211], v[44:47]
    ds_read_b128 v[140:143], v200 offset:59392
    v_mfma_f32_16x16x32_bf16 v[48:51], v[104:107], a[208:211], v[48:51]
    ds_read_b128 v[144:147], v200 offset:60416
    v_mfma_f32_16x16x32_bf16 v[52:55], v[108:111], a[208:211], v[52:55]
    ds_read_b128 v[148:151], v201 offset:0
    v_mfma_f32_16x16x32_bf16 v[56:59], v[112:115], a[208:211], v[56:59]
    ds_read_b128 v[152:155], v201 offset:1024
    v_mfma_f32_16x16x32_bf16 v[60:63], v[116:119], a[208:211], v[60:63]
    ds_read_b128 v[156:159], v201 offset:2048
    s_waitcnt lgkmcnt(5)
    s_waitcnt vmcnt(4)
    v_mfma_f32_16x16x32_bf16 v[44:47], v[120:123], a[212:215], v[44:47]
    ds_read_b128 v[100:103], v201 offset:3072
    v_mfma_f32_16x16x32_bf16 v[48:51], v[124:127], a[212:215], v[48:51]
    ds_read_b128 v[104:107], v201 offset:4096
    v_mfma_f32_16x16x32_bf16 v[52:55], v[128:131], a[212:215], v[52:55]
    ds_read_b128 v[108:111], v201 offset:5120
    v_mfma_f32_16x16x32_bf16 v[56:59], v[132:135], a[212:215], v[56:59]
    ds_read_b128 v[112:115], v201 offset:6144
    v_mfma_f32_16x16x32_bf16 v[60:63], v[136:139], a[212:215], v[60:63]
    ds_read_b128 v[116:119], v201 offset:7168
    s_barrier
    s_waitcnt lgkmcnt(5)
    s_waitcnt vmcnt(3)
    s_nop 0
    v_mfma_f32_16x16x32_bf16 v[44:47], v[140:143], a[216:219], v[44:47]
    ds_read_b128 v[120:123], v201 offset:8192
    v_mfma_f32_16x16x32_bf16 v[48:51], v[144:147], a[216:219], v[48:51]
    ds_read_b128 v[124:127], v201 offset:9216
    v_mfma_f32_16x16x32_bf16 v[52:55], v[148:151], a[216:219], v[52:55]
    ds_read_b128 v[128:131], v201 offset:10240
    v_mfma_f32_16x16x32_bf16 v[56:59], v[152:155], a[216:219], v[56:59]
    ds_read_b128 v[132:135], v201 offset:11264
    v_mfma_f32_16x16x32_bf16 v[60:63], v[156:159], a[216:219], v[60:63]
    ds_read_b128 v[136:139], v201 offset:12288
    s_waitcnt lgkmcnt(5)
    s_waitcnt vmcnt(2)
    v_mfma_f32_16x16x32_bf16 v[44:47], v[100:103], a[220:223], v[44:47]
    ds_read_b128 v[140:143], v201 offset:13312
    v_mfma_f32_16x16x32_bf16 v[48:51], v[104:107], a[220:223], v[48:51]
    ds_read_b128 v[144:147], v201 offset:14336
    v_mfma_f32_16x16x32_bf16 v[52:55], v[108:111], a[220:223], v[52:55]
    ds_read_b128 v[148:151], v201 offset:15360
    v_mfma_f32_16x16x32_bf16 v[56:59], v[112:115], a[220:223], v[56:59]
    ds_read_b128 v[152:155], v201 offset:16384
    v_mfma_f32_16x16x32_bf16 v[60:63], v[116:119], a[220:223], v[60:63]
    ds_read_b128 v[156:159], v201 offset:17408
    s_waitcnt lgkmcnt(5)
    s_waitcnt vmcnt(1)
    v_mfma_f32_16x16x32_bf16 v[44:47], v[120:123], a[224:227], v[44:47]
    v_mfma_f32_16x16x32_bf16 v[48:51], v[124:127], a[224:227], v[48:51]
    v_mfma_f32_16x16x32_bf16 v[52:55], v[128:131], a[224:227], v[52:55]
    v_mfma_f32_16x16x32_bf16 v[56:59], v[132:135], a[224:227], v[56:59]
    v_mfma_f32_16x16x32_bf16 v[60:63], v[136:139], a[224:227], v[60:63]
    s_waitcnt lgkmcnt(0)
    s_waitcnt vmcnt(0)
    v_mfma_f32_16x16x32_bf16 v[44:47], v[140:143], a[228:231], v[44:47]
    v_mfma_f32_16x16x32_bf16 v[48:51], v[144:147], a[228:231], v[48:51]
    v_mfma_f32_16x16x32_bf16 v[52:55], v[148:151], a[228:231], v[52:55]
    v_mfma_f32_16x16x32_bf16 v[56:59], v[152:155], a[228:231], v[56:59]
    v_mfma_f32_16x16x32_bf16 v[60:63], v[156:159], a[228:231], v[60:63]
    v_accvgpr_read_b32 v204, a240
    v_accvgpr_read_b32 v205, a241
    v_lshlrev_b32_e64 v100, 16, v204
    v_and_b32 v101, 0xffff0000, v204
    v_lshlrev_b32_e64 v102, 16, v205
    v_and_b32 v103, 0xffff0000, v205
    v_accvgpr_read_b32 v204, a242
    v_accvgpr_read_b32 v205, a243
    v_lshlrev_b32_e64 v104, 16, v204
    v_and_b32 v105, 0xffff0000, v204
    v_lshlrev_b32_e64 v106, 16, v205
    v_and_b32 v107, 0xffff0000, v205
    v_accvgpr_read_b32 v204, a244
    v_accvgpr_read_b32 v205, a245
    v_lshlrev_b32_e64 v108, 16, v204
    v_and_b32 v109, 0xffff0000, v204
    v_lshlrev_b32_e64 v110, 16, v205
    v_and_b32 v111, 0xffff0000, v205
    v_accvgpr_read_b32 v204, a246
    v_accvgpr_read_b32 v205, a247
    v_lshlrev_b32_e64 v112, 16, v204
    v_and_b32 v113, 0xffff0000, v204
    v_lshlrev_b32_e64 v114, 16, v205
    v_and_b32 v115, 0xffff0000, v205
    v_accvgpr_read_b32 v204, a248
    v_accvgpr_read_b32 v205, a249
    v_lshlrev_b32_e64 v116, 16, v204
    v_and_b32 v117, 0xffff0000, v204
    v_lshlrev_b32_e64 v118, 16, v205
    v_and_b32 v119, 0xffff0000, v205
    v_pk_add_f32 v[44:45], v[44:45], v[24:25]
    v_pk_fma_f32 v[44:45], v[44:45], v[100:101], v[4:5]
    v_pk_add_f32 v[46:47], v[46:47], v[26:27]
    v_pk_fma_f32 v[46:47], v[46:47], v[102:103], v[6:7]
    v_pk_add_f32 v[48:49], v[48:49], v[28:29]
    v_pk_fma_f32 v[48:49], v[48:49], v[104:105], v[8:9]
    v_pk_add_f32 v[50:51], v[50:51], v[30:31]
    v_pk_fma_f32 v[50:51], v[50:51], v[106:107], v[10:11]
    v_pk_add_f32 v[52:53], v[52:53], v[32:33]
    v_pk_fma_f32 v[52:53], v[52:53], v[108:109], v[12:13]
    v_pk_add_f32 v[54:55], v[54:55], v[34:35]
    v_pk_fma_f32 v[54:55], v[54:55], v[110:111], v[14:15]
    v_pk_add_f32 v[56:57], v[56:57], v[36:37]
    v_pk_fma_f32 v[56:57], v[56:57], v[112:113], v[16:17]
    v_pk_add_f32 v[58:59], v[58:59], v[38:39]
    v_pk_fma_f32 v[58:59], v[58:59], v[114:115], v[18:19]
    v_pk_add_f32 v[60:61], v[60:61], v[40:41]
    v_pk_fma_f32 v[60:61], v[60:61], v[116:117], v[20:21]
    v_pk_add_f32 v[62:63], v[62:63], v[42:43]
    v_pk_fma_f32 v[62:63], v[62:63], v[118:119], v[22:23]
    s_mov_b32 s8, s56
    s_mov_b32 s9, s57
    s_mov_b32 s10, 2621440
    s_mov_b32 s11, 0x20000
    s_lshl_b32 s62, s27, 4
    v_add_u32 v204, s62, v1
    v_mul_u32_u24 v204, 1280, v204
    v_lshl_add_u32 v204, v2, 3, v204
    s_mul_i32 s62, s23, 160
    v_cvt_pk_bf16_f32 v44, v44, v45
    v_cvt_pk_bf16_f32 v45, v46, v47
    v_cvt_pk_bf16_f32 v46, v48, v49
    v_cvt_pk_bf16_f32 v47, v50, v51
    v_cvt_pk_bf16_f32 v48, v52, v53
    v_cvt_pk_bf16_f32 v49, v54, v55
    v_cvt_pk_bf16_f32 v50, v56, v57
    v_cvt_pk_bf16_f32 v51, v58, v59
    v_cvt_pk_bf16_f32 v52, v60, v61
    v_cvt_pk_bf16_f32 v53, v62, v63
    buffer_store_dwordx2 v[44:45], v204, s[8:11], s62 offen offset:0
    buffer_store_dwordx2 v[46:47], v204, s[8:11], s62 offen offset:32
    buffer_store_dwordx2 v[48:49], v204, s[8:11], s62 offen offset:64
    buffer_store_dwordx2 v[50:51], v204, s[8:11], s62 offen offset:96
    buffer_store_dwordx2 v[52:53], v204, s[8:11], s62 offen offset:128
    s_waitcnt vmcnt(0) lgkmcnt(0)
    s_endpgm
L_fail:
    s_waitcnt vmcnt(0) lgkmcnt(0)
    s_mov_b32 s16, s58
    s_mov_b32 s17, s59
    s_nop 0
    s_mov_b32 s18, 256
    s_mov_b32 s19, 0x20000
    v_mov_b32 v254, s28
    v_mov_b32 v255, s25
    v_mov_b32_e64 v253, 16
    buffer_store_dwordx2 v[254:255], v253, s[16:19], 0 offen sc1
    s_waitcnt vmcnt(0)
L_end:
    s_endpgm
L_code_end:
.section .rodata,"a"
.p2align 6
.amdhsa_kernel adaLN_cond__grouped_kv_mqa__mixer_s_mlp__prompt_kernel
  .amdhsa_next_free_vgpr 512
  .amdhsa_next_free_sgpr 102
  .amdhsa_accum_offset 256
  .amdhsa_group_segment_fixed_size 0
  .amdhsa_kernarg_size 120
  .amdhsa_user_sgpr_count 2
  .amdhsa_user_sgpr_kernarg_segment_ptr 1
  .amdhsa_system_sgpr_workgroup_id_x 1
.end_amdhsa_kernel
```
